```python
import torch

def _softmax(x, axis=-1):
    return torch.softmax(x, dim=axis)

def _gelu(x):
    return torch.nn.functional.gelu(x, approximate='tanh')

def _silu(x):
    return torch.nn.functional.silu(x)

def _sigmoid(x):
    return torch.sigmoid(x)

def _layernorm(x, axis=-1, eps=1e-05):
    m = x.mean(dim=axis, keepdim=True)
    v = x.var(dim=axis, keepdim=True, unbiased=False)
    return (x - m) / torch.sqrt(v + eps)

def _scatter_add(tgt, idx, src, axis=0):
    return tgt.clone().index_add_(axis, idx, src)

def _segment_sum(src, seg, n):
    out = torch.zeros((n,) + src.shape[1:], dtype=src.dtype)
    return out.index_add_(0, seg, src)

def _pad(x, pw):
    flat = tuple((v for pair in reversed(pw) for v in pair))
    return torch.nn.functional.pad(x, flat)
kernel_name = 'adaLN_cond__sliding_block_cached__dense_activation_squared_relu__prompt'

def setup_inputs():

    _w = lambda a: (lambda t: t.to(torch.bfloat16) if t.is_floating_point() else t)(torch.as_tensor(a))

    def _A_setup():
        B, Sq, D = (1, 2048, 512)
        Hq, Hkv, Sk, Dh = (32, 8, 2048, 128)
        assert Hq % Hkv == 0, (Hq, Hkv)
        return {'x': _w((lambda *s: torch.randn(*s, dtype=torch.bfloat16) * 0.05)(B, Sq, D)), 'k_cache': _w((lambda *s: torch.randn(*s, dtype=torch.bfloat16) * 3.2)(B, Hkv, Sk, Dh)), 'v_cache': _w((lambda *s: torch.randn(*s, dtype=torch.bfloat16) * 0.4)(B, Hkv, Sk, Dh)), 'wq': _w((lambda *s: torch.randn(*s, dtype=torch.bfloat16) * 3.2)(D, Hq * Dh) * D ** (-0.5)), 'wo': _w((lambda *s: torch.randn(*s, dtype=torch.bfloat16) * 0.4)(Hq * Dh, D) * (Hq * Dh) ** (-0.5))}
    _A_in = _A_setup()

    def _B_setup():
        B, S, D, F = (1, 2048, 512, 1792)
        return {'x': _w((lambda *s: torch.randn(*s, dtype=torch.bfloat16) * 0.05)(B, S, D)), 'w1': _w((lambda *s: torch.randn(*s, dtype=torch.bfloat16) * 0.05)(D, F)), 'b1': _w((lambda *s: torch.randn(*s, dtype=torch.bfloat16) * 0.4)(F)), 'w2': _w((lambda *s: torch.randn(*s, dtype=torch.bfloat16) * 0.05)(F, D)), 'b2': _w((lambda *s: torch.randn(*s, dtype=torch.bfloat16) * 6.4)(D))}
    _B_in = _B_setup()
    return {'A_x': _A_in['x'], 'A_k_cache': _A_in['k_cache'], 'A_v_cache': _A_in['v_cache'], 'A_wq': _A_in['wq'], 'A_wo': _A_in['wo'], 'B_x': _B_in['x'], 'B_w1': _B_in['w1'], 'B_b1': _B_in['b1'], 'B_w2': _B_in['w2'], 'B_b2': _B_in['b2'], 'c': _w((lambda *s: torch.randn(*s, dtype=torch.bfloat16) * 0.1)(1, 512) * 8.0), 'w_mod': _w((lambda *s: torch.randn(*s, dtype=torch.bfloat16) * 0.1)(512, 6 * 512) * 512 ** (-0.5) * 8.0)}

def reference(A_x, A_k_cache, A_v_cache, A_wq, A_wo, B_x, B_w1, B_b1, B_w2, B_b2, c, w_mod):

    def _A_ref(x, k_cache, v_cache, wq, wo):
        B, Sq, D = x.shape
        Hq, Dh = (32, 128)
        Hkv, Sk = (k_cache.shape[1], k_cache.shape[2])
        W = min(4096, max(256, Sk // 4))
        rep = Hq // Hkv
        q = (lambda x, *d: x.permute(*d))((x @ wq).reshape(B, Sq, Hq, Dh), 0, 2, 1, 3)
        k = (lambda x, n, axis: torch.repeat_interleave(x, n, dim=axis))(k_cache[:, :, Sk - W:, :], rep, axis=1)
        v = (lambda x, n, axis: torch.repeat_interleave(x, n, dim=axis))(v_cache[:, :, Sk - W:, :], rep, axis=1)
        scores = torch.einsum('bhqd,bhkd->bhqk', q, k) * Dh ** (-0.5)
        p = _softmax(scores, axis=-1)
        o = torch.einsum('bhqk,bhkd->bhqd', p, v)
        return (lambda x, *d: x.permute(*d))(o, 0, 2, 1, 3).reshape(B, Sq, Hq * Dh) @ wo

    def _B_ref(x, w1, b1, w2, b2):
        h = torch.einsum('bsd,df->bsf', x, w1) + b1
        zero = torch.zeros_like(h)
        r = torch.where(h > zero, h, zero)
        h = r * r
        out = torch.einsum('bsf,fd->bsd', h, w2) + b2
        return out
    x = A_x
    mod = (_silu(c) @ w_mod).reshape(c.shape[0], 6, 1, -1)
    sa, ca, ga, sb, cb, gb = (mod[:, 0].clone(), mod[:, 1].clone(), mod[:, 2].clone(), mod[:, 3].clone(), mod[:, 4].clone(), mod[:, 5].clone())
    h = _layernorm(x, axis=-1) * (1 + ca) + sa
    x = x + ga * _A_ref(h, A_k_cache, A_v_cache, A_wq, A_wo)
    h = _layernorm(x, axis=-1) * (1 + cb) + sb
    x = x + gb * _B_ref(h, B_w1, B_b1, B_w2, B_b2)
    return x
```

```asm
; @launch grid=(256,1,1) block=(256,1,1) lds=163840
.amdgcn_target "amdgcn-amd-amdhsa--gfx950"
.text
.globl adaLN_cond__sliding_block_cached__dense_activation_squared_relu__prompt_kernel
.p2align 8
.type adaLN_cond__sliding_block_cached__dense_activation_squared_relu__prompt_kernel,@function
adaLN_cond__sliding_block_cached__dense_activation_squared_relu__prompt_kernel:
  s_load_dwordx4 s[80:83], s[0:1], 80
  s_load_dwordx4 s[4:7], s[0:1], 0
  s_load_dwordx4 s[8:11], s[0:1], 16
  s_load_dwordx2 s[12:13], s[0:1], 32
  s_load_dwordx4 s[84:87], s[0:1], 104
  s_cmp_ge_u32 s2, 256
  s_cbranch_scc1 k2_end
  v_lshrrev_b32 v2, 6, v0
  v_and_b32 v1, 63, v0
  v_readfirstlane_b32 s44, v2
  s_and_b32 s50, s2, 7
  s_lshr_b32 s56, s2, 3
  s_and_b32 s46, s50, 3
  s_lshl_b32 s46, s46, 1
  s_and_b32 s45, s56, 1
  s_add_u32 s46, s46, s45
  s_lshr_b32 s61, s56, 1
  s_lshr_b32 s45, s50, 2
  s_mul_i32 s45, s45, 16
  s_add_u32 s45, s45, s61
  s_lshl_b32 s3, s45, 3
  s_add_u32 s3, s3, s46
  s_lshr_b32 s65, s2, 2
  s_lshl_b32 s66, s65, 7
  s_and_b32 s49, s2, 3
  s_mul_i32 s50, s49, 786432
  s_add_u32 s66, s66, s50
  s_lshl_b32 s50, s49, 8
  v_lshrrev_b32 v23, 3, v0
  v_and_b32 v24, 7, v0
  v_lshl_add_u32 v21, v23, 1, s50
  s_movk_i32 s61, 6144
  v_mul_lo_u32 v22, v23, s61
  v_lshl_add_u32 v22, v24, 4, v22
  s_waitcnt lgkmcnt(0)
  s_mov_b32 s72, s82
  s_mov_b32 s73, s83
  s_mov_b32 s74, 0x300000
  s_mov_b32 s75, 0x20000
  s_mov_b32 s68, s80
  s_mov_b32 s69, s81
  s_mov_b32 s70, 0x400
  s_mov_b32 s71, 0x20000
  s_cmp_ge_u32 s2, 64
  s_cbranch_scc1 k2_ng1
  s_add_u32 s61, s66, 0
  buffer_load_dwordx4 a[0:3], v22, s[72:75], s61 offen
  s_add_u32 s61, s66, 196608
  buffer_load_dwordx4 a[4:7], v22, s[72:75], s61 offen
  s_add_u32 s61, s66, 393216
  buffer_load_dwordx4 a[8:11], v22, s[72:75], s61 offen
  s_add_u32 s61, s66, 589824
  buffer_load_dwordx4 a[12:15], v22, s[72:75], s61 offen
  buffer_load_ushort a16, v21, s[68:71], 0 offen offset:0
  buffer_load_ushort a17, v21, s[68:71], 0 offen offset:64
  buffer_load_ushort a18, v21, s[68:71], 0 offen offset:128
  buffer_load_ushort a19, v21, s[68:71], 0 offen offset:192
k2_ng1:
  s_getpc_b64 s[88:89]
k2_pc:
  v_lshlrev_b32 v2, 7, v0
  global_load_dword v28, v2, s[88:89]
  v_add_u32 v2, 32768, v2
  v_cmp_gt_u32 vcc, code_end-k2_pc-4, v2
  s_nop 0
  s_and_b64 exec, exec, vcc
  s_cbranch_execz k2_pf
  global_load_dword v29, v2, s[88:89]
k2_pf:
  s_mov_b64 exec, -1
  s_mov_b32 s14, s86
  s_mov_b32 s15, s87
  s_mov_b32 s100, s84
  s_mov_b32 s101, s85
  s_mov_b32 s16, s4
  s_mov_b32 s17, s5
  s_mov_b32 s18, 0x200000
  s_mov_b32 s19, 0x20000
  s_mov_b32 s20, s10
  s_mov_b32 s21, s11
  s_mov_b32 s22, 0x400000
  s_mov_b32 s23, 0x20000
  s_mov_b32 s24, s6
  s_mov_b32 s25, s7
  s_mov_b32 s26, 0x400000
  s_mov_b32 s27, 0x20000
  s_mov_b32 s28, s8
  s_mov_b32 s29, s9
  s_mov_b32 s30, 0x400000
  s_mov_b32 s31, 0x20000
  s_mov_b32 s36, s14
  s_mov_b32 s37, s15
  s_mov_b32 s38, 0x500000
  s_mov_b32 s39, 0x20000
  s_lshl_b32 s63, s45, 7
  s_add_u32 s63, s63, 131072
  s_lshl_b32 s50, s46, 2
  s_add_u32 s50, s50, s63
  v_lshlrev_b32 v2, 12, v0
  v_mov_b32 v3, 0
  v_cmp_gt_u32 vcc, 6, v0
  s_nop 0
  s_and_b64 exec, exec, vcc
  buffer_store_dword v3, v2, s[36:39], s50 offen sc1
  s_mov_b64 exec, -1
  v_lshlrev_b32 v20, 4, v1
  v_lshlrev_b32 v26, 5, v1
  s_lshl_b32 s62, s45, 16
  s_lshl_b32 s56, s44, 14
  s_add_u32 s62, s62, s56
  v_lshrrev_b32 v10, 5, v1
  v_bfe_u32 v2, v1, 2, 2
  v_lshl_add_u32 v10, v10, 2, v2
  v_bfe_u32 v2, v1, 4, 1
  v_and_b32 v11, 3, v1
  v_lshlrev_b32 v11, 4, v11
  v_lshl_add_u32 v11, v2, 6, v11
  v_lshl_add_u32 v8, v10, 13, v11
  v_add_u32 v9, 65536, v8
  s_lshl_b32 s51, s44, 12
  s_add_u32 s51, s51, 65536
  s_lshl_b32 s52, s46, 2
  s_add_u32 s52, s52, s44
  s_lshl_b32 s52, s52, 8
  s_mov_b32 s32, s12
  s_mov_b32 s33, s13
  s_mov_b32 s34, 0x400000
  s_mov_b32 s35, 0x20000
  s_add_u32 s40, s14, 0x1000000
  s_addc_u32 s41, s15, 0
  s_mov_b32 s42, 0x2000000
  s_mov_b32 s43, 0x20000
  s_lshl_b32 s54, s46, 19
  s_lshl_b32 s50, s44, 8
  s_add_u32 s53, s54, s50
  s_add_u32 s54, s54, 393216
  v_lshl_add_u32 v13, v10, 8, v11
  v_lshl_add_u32 v10, v10, 10, v11
  v_add_u32 v11, 8192, v10
  s_lshr_b32 s50, s44, 1
  s_lshl_b32 s50, s50, 12
  s_and_b32 s56, s44, 1
  s_lshl_b32 s56, s56, 7
  s_add_u32 s50, s50, s56
  v_add_u32 v13, s50, v13
  v_add_u32 v14, 2048, v13
  v_lshrrev_b32 v2, 4, v1
  v_lshlrev_b32 v27, 14, v2
  v_and_b32 v2, 15, v1
  v_lshl_add_u32 v27, v2, 4, v27
  s_lshl_b32 s50, s44, 12
  v_add_u32 v27, s50, v27
  v_lshrrev_b32 v2, 5, v1
  v_lshlrev_b32 v4, 10, v2
  v_bfe_u32 v3, v1, 2, 2
  v_lshl_add_u32 v4, v3, 6, v4
  v_bfe_u32 v3, v1, 4, 1
  v_lshl_add_u32 v4, v3, 5, v4
  v_and_b32 v3, 1, v1
  v_lshl_add_u32 v4, v3, 4, v4
  v_bfe_u32 v3, v1, 1, 1
  v_lshl_add_u32 v4, v3, 3, v4
  v_and_b32 v3, 15, v1
  v_xor_b32 v3, v3, v2
  v_lshlrev_b32 v6, 4, v3
  v_and_b32 v3, 31, v1
  v_lshl_add_u32 v6, v3, 8, v6
  v_add_u32 v18, 67584, v4
  v_add_u32 v4, s51, v4
  v_mov_b32 v5, v4
  v_bfe_u32 v2, v1, 2, 2
  v_bfe_u32 v3, v1, 4, 1
  v_lshl_add_u32 v2, v3, 3, v2
  v_bfe_u32 v3, v1, 5, 1
  v_lshl_add_u32 v2, v3, 2, v2
  v_lshlrev_b32 v12, 8, v2
  v_lshrrev_b32 v2, 4, v1
  v_xor_b32 v2, v2, v1
  v_and_b32 v2, 3, v2
  v_lshl_add_u32 v12, v2, 4, v12
  s_lshl_b32 s50, s44, 6
  v_add_u32 v12, s50, v12
  v_bfe_u32 v2, v1, 4, 1
  v_lshlrev_b32 v15, 10, v2
  v_and_b32 v2, 15, v1
  v_lshl_add_u32 v15, v2, 6, v15
  v_bfe_u32 v2, v1, 2, 2
  v_lshrrev_b32 v3, 5, v1
  v_xor_b32 v2, v2, v3
  v_lshl_add_u32 v15, v2, 4, v15
  v_add_u32 v15, 65536, v15
  s_mov_b32 s60, 0
  s_lshl_b32 s64, s46, 21
  s_lshl_b32 s56, s45, 16
  s_add_u32 s64, s64, s56
  s_lshl_b32 s56, s44, 14
  s_add_u32 s64, s64, s56
  s_load_dwordx8 s[4:11], s[0:1], 48
  s_load_dwordx2 s[12:13], s[0:1], 96
  s_cmp_ge_u32 s2, 64
  s_cbranch_scc1 k2_gea
  s_waitcnt vmcnt(0)
  v_accvgpr_read_b32 v32, a0
  v_accvgpr_read_b32 v33, a1
  v_accvgpr_read_b32 v34, a2
  v_accvgpr_read_b32 v35, a3
  v_accvgpr_read_b32 v36, a4
  v_accvgpr_read_b32 v37, a5
  v_accvgpr_read_b32 v38, a6
  v_accvgpr_read_b32 v39, a7
  v_accvgpr_read_b32 v40, a8
  v_accvgpr_read_b32 v41, a9
  v_accvgpr_read_b32 v42, a10
  v_accvgpr_read_b32 v43, a11
  v_accvgpr_read_b32 v44, a12
  v_accvgpr_read_b32 v45, a13
  v_accvgpr_read_b32 v46, a14
  v_accvgpr_read_b32 v47, a15
  v_accvgpr_read_b32 v56, a16
  v_accvgpr_read_b32 v57, a17
  v_accvgpr_read_b32 v58, a18
  v_accvgpr_read_b32 v59, a19
  v_lshlrev_b32 v56, 16, v56
  v_lshlrev_b32 v57, 16, v57
  v_lshlrev_b32 v58, 16, v58
  v_lshlrev_b32 v59, 16, v59
  v_mul_f32 v60, 0xbfb8aa3b, v56
  v_mul_f32 v61, 0xbfb8aa3b, v57
  v_mul_f32 v62, 0xbfb8aa3b, v58
  v_mul_f32 v63, 0xbfb8aa3b, v59
  v_exp_f32 v60, v60
  v_exp_f32 v61, v61
  v_exp_f32 v62, v62
  v_exp_f32 v63, v63
  v_add_f32 v60, 1.0, v60
  v_add_f32 v61, 1.0, v61
  v_add_f32 v62, 1.0, v62
  v_add_f32 v63, 1.0, v63
  v_rcp_f32 v60, v60
  v_rcp_f32 v61, v61
  v_rcp_f32 v62, v62
  v_rcp_f32 v63, v63
  v_mul_f32 v56, v56, v60
  v_mul_f32 v57, v57, v61
  v_mul_f32 v58, v58, v62
  v_mul_f32 v59, v59, v63
  v_cvt_pk_bf16_f32 v56, v56, v56
  v_lshlrev_b32 v56, 16, v56
  v_cvt_pk_bf16_f32 v57, v57, v57
  v_lshlrev_b32 v57, 16, v57
  v_cvt_pk_bf16_f32 v58, v58, v58
  v_lshlrev_b32 v58, 16, v58
  v_cvt_pk_bf16_f32 v59, v59, v59
  v_lshlrev_b32 v59, 16, v59
  v_lshlrev_b32 v28, 16, v32
  v_and_b32 v29, 0xffff0000, v32
  v_mul_f32 v48, v56, v28
  v_mul_f32 v49, v56, v29
  v_lshlrev_b32 v28, 16, v33
  v_and_b32 v29, 0xffff0000, v33
  v_mul_f32 v50, v56, v28
  v_mul_f32 v51, v56, v29
  v_lshlrev_b32 v28, 16, v34
  v_and_b32 v29, 0xffff0000, v34
  v_mul_f32 v52, v56, v28
  v_mul_f32 v53, v56, v29
  v_lshlrev_b32 v28, 16, v35
  v_and_b32 v29, 0xffff0000, v35
  v_mul_f32 v54, v56, v28
  v_mul_f32 v55, v56, v29
  v_lshlrev_b32 v28, 16, v36
  v_and_b32 v29, 0xffff0000, v36
  v_fmac_f32 v48, v57, v28
  v_fmac_f32 v49, v57, v29
  v_lshlrev_b32 v28, 16, v37
  v_and_b32 v29, 0xffff0000, v37
  v_fmac_f32 v50, v57, v28
  v_fmac_f32 v51, v57, v29
  v_lshlrev_b32 v28, 16, v38
  v_and_b32 v29, 0xffff0000, v38
  v_fmac_f32 v52, v57, v28
  v_fmac_f32 v53, v57, v29
  v_lshlrev_b32 v28, 16, v39
  v_and_b32 v29, 0xffff0000, v39
  v_fmac_f32 v54, v57, v28
  v_fmac_f32 v55, v57, v29
  v_lshlrev_b32 v28, 16, v40
  v_and_b32 v29, 0xffff0000, v40
  v_fmac_f32 v48, v58, v28
  v_fmac_f32 v49, v58, v29
  v_lshlrev_b32 v28, 16, v41
  v_and_b32 v29, 0xffff0000, v41
  v_fmac_f32 v50, v58, v28
  v_fmac_f32 v51, v58, v29
  v_lshlrev_b32 v28, 16, v42
  v_and_b32 v29, 0xffff0000, v42
  v_fmac_f32 v52, v58, v28
  v_fmac_f32 v53, v58, v29
  v_lshlrev_b32 v28, 16, v43
  v_and_b32 v29, 0xffff0000, v43
  v_fmac_f32 v54, v58, v28
  v_fmac_f32 v55, v58, v29
  v_lshlrev_b32 v28, 16, v44
  v_and_b32 v29, 0xffff0000, v44
  v_fmac_f32 v48, v59, v28
  v_fmac_f32 v49, v59, v29
  v_lshlrev_b32 v28, 16, v45
  v_and_b32 v29, 0xffff0000, v45
  v_fmac_f32 v50, v59, v28
  v_fmac_f32 v51, v59, v29
  v_lshlrev_b32 v28, 16, v46
  v_and_b32 v29, 0xffff0000, v46
  v_fmac_f32 v52, v59, v28
  v_fmac_f32 v53, v59, v29
  v_lshlrev_b32 v28, 16, v47
  v_and_b32 v29, 0xffff0000, v47
  v_fmac_f32 v54, v59, v28
  v_fmac_f32 v55, v59, v29
  v_permlane32_swap_b32 v48, v52
  v_permlane32_swap_b32 v49, v53
  v_permlane32_swap_b32 v50, v54
  v_permlane32_swap_b32 v51, v55
  v_add_f32 v48, v48, v52
  v_add_f32 v49, v49, v53
  v_add_f32 v50, v50, v54
  v_add_f32 v51, v51, v55
  s_nop 0
  v_permlane16_swap_b32 v48, v50
  v_permlane16_swap_b32 v49, v51
  v_add_f32 v48, v48, v50
  v_add_f32 v49, v49, v51
  v_lshrrev_b32 v2, 3, v1
  v_add_f32 v50, v48, v48 row_ror:8 row_mask:0xf bank_mask:0x3
  v_lshl_add_u32 v2, v24, 3, v2
  s_lshl_b32 s56, s44, 6
  v_add_f32 v50, v49, v49 row_ror:8 row_mask:0xf bank_mask:0xc
  v_add_u32 v2, s56, v2
  v_lshlrev_b32 v2, 2, v2
  ds_write_b32 v2, v50
  s_waitcnt lgkmcnt(0)
  s_barrier
  s_cmp_eq_u32 s44, 0
  s_cbranch_scc0 k2_gea
  v_lshlrev_b32 v2, 2, v1
  ds_read_b32 v48, v2 offset:0
  ds_read_b32 v49, v2 offset:256
  ds_read_b32 v50, v2 offset:512
  ds_read_b32 v51, v2 offset:768
  s_lshl_b32 s56, s65, 8
  s_mul_i32 s61, s49, 16384
  s_add_u32 s56, s56, s61
  s_waitcnt lgkmcnt(2)
  v_add_f32 v48, v48, v49
  s_waitcnt lgkmcnt(0)
  v_add_f32 v50, v50, v51
  v_add_f32 v48, v48, v50
  buffer_store_dword v48, v2, s[36:39], s56 offen sc1
  s_mov_b32 s76, s100
  s_mov_b32 s77, s101
  s_mov_b32 s78, 0x100
  s_mov_b32 s79, 0x20000
  v_mov_b32 v49, 1
  s_waitcnt vmcnt(0)
  s_mov_b64 exec, 1
  buffer_atomic_add v49, v2, s[76:79], 0 offen sc1
  s_mov_b64 exec, -1
k2_gea:
  s_lshl_b32 s50, s46, 11
  s_add_u32 s56, s62, s50
  buffer_load_dwordx4 v[64:67], v20, s[16:19], s56 offen
  s_add_u32 s50, s50, 1024
  s_and_b32 s50, s50, 0x3fff
  s_add_u32 s56, s62, s50
  buffer_load_dwordx4 v[68:71], v20, s[16:19], s56 offen
  s_add_u32 s50, s50, 1024
  s_and_b32 s50, s50, 0x3fff
  s_add_u32 s56, s62, s50
  buffer_load_dwordx4 v[72:75], v20, s[16:19], s56 offen
  s_add_u32 s50, s50, 1024
  s_and_b32 s50, s50, 0x3fff
  s_add_u32 s56, s62, s50
  buffer_load_dwordx4 v[76:79], v20, s[16:19], s56 offen
  s_add_u32 s50, s50, 1024
  s_and_b32 s50, s50, 0x3fff
  s_add_u32 s56, s62, s50
  buffer_load_dwordx4 v[80:83], v20, s[16:19], s56 offen
  s_add_u32 s50, s50, 1024
  s_and_b32 s50, s50, 0x3fff
  s_add_u32 s56, s62, s50
  buffer_load_dwordx4 v[84:87], v20, s[16:19], s56 offen
  s_add_u32 s50, s50, 1024
  s_and_b32 s50, s50, 0x3fff
  s_add_u32 s56, s62, s50
  buffer_load_dwordx4 v[88:91], v20, s[16:19], s56 offen
  s_add_u32 s50, s50, 1024
  s_and_b32 s50, s50, 0x3fff
  s_add_u32 s56, s62, s50
  buffer_load_dwordx4 v[92:95], v20, s[16:19], s56 offen
  s_add_u32 s50, s50, 1024
  s_and_b32 s50, s50, 0x3fff
  s_add_u32 s56, s62, s50
  buffer_load_dwordx4 v[96:99], v20, s[16:19], s56 offen
  s_add_u32 s50, s50, 1024
  s_and_b32 s50, s50, 0x3fff
  s_add_u32 s56, s62, s50
  buffer_load_dwordx4 v[100:103], v20, s[16:19], s56 offen
  s_add_u32 s50, s50, 1024
  s_and_b32 s50, s50, 0x3fff
  s_add_u32 s56, s62, s50
  buffer_load_dwordx4 v[104:107], v20, s[16:19], s56 offen
  s_add_u32 s50, s50, 1024
  s_and_b32 s50, s50, 0x3fff
  s_add_u32 s56, s62, s50
  buffer_load_dwordx4 v[108:111], v20, s[16:19], s56 offen
  s_add_u32 s50, s50, 1024
  s_and_b32 s50, s50, 0x3fff
  s_add_u32 s56, s62, s50
  buffer_load_dwordx4 v[112:115], v20, s[16:19], s56 offen
  s_add_u32 s50, s50, 1024
  s_and_b32 s50, s50, 0x3fff
  s_add_u32 s56, s62, s50
  buffer_load_dwordx4 v[116:119], v20, s[16:19], s56 offen
  s_add_u32 s50, s50, 1024
  s_and_b32 s50, s50, 0x3fff
  s_add_u32 s56, s62, s50
  buffer_load_dwordx4 v[120:123], v20, s[16:19], s56 offen
  s_add_u32 s50, s50, 1024
  s_and_b32 s50, s50, 0x3fff
  s_add_u32 s56, s62, s50
  buffer_load_dwordx4 v[124:127], v20, s[16:19], s56 offen
  s_add_u32 s50, s50, 1024
  s_and_b32 s50, s50, 0x3fff
  s_sub_u32 s67, s2, 64
  s_lshr_b32 s50, s67, 3
  s_lshr_b32 s65, s50, 2
  s_lshl_b32 s65, s65, 5
  s_and_b32 s50, s50, 3
  s_add_u32 s65, s65, s50
  s_and_b32 s50, s2, 7
  s_lshl_b32 s50, s50, 2
  s_add_u32 s65, s65, s50
  s_add_u32 s65, s65, 64
  s_and_b32 s65, s65, 255
  s_lshl_b32 s66, s65, 5
  v_lshrrev_b32 v23, 1, v0
  v_and_b32 v24, 1, v0
  v_lshlrev_b32 v21, 1, v23
  s_movk_i32 s61, 6144
  v_mul_lo_u32 v22, v23, s61
  v_lshl_add_u32 v22, v24, 4, v22
  s_cmp_lt_u32 s67, 128
  s_cselect_b64 exec, -1, 0
  s_add_u32 s61, s66, 0
  buffer_load_dwordx4 a[0:3], v22, s[72:75], s61 offen
  s_add_u32 s61, s66, 786432
  buffer_load_dwordx4 a[4:7], v22, s[72:75], s61 offen
  s_add_u32 s61, s66, 1572864
  buffer_load_dwordx4 a[8:11], v22, s[72:75], s61 offen
  s_add_u32 s61, s66, 2359296
  buffer_load_dwordx4 a[12:15], v22, s[72:75], s61 offen
  buffer_load_ushort a16, v21, s[68:71], 0 offen offset:0
  buffer_load_ushort a17, v21, s[68:71], 0 offen offset:256
  buffer_load_ushort a18, v21, s[68:71], 0 offen offset:512
  buffer_load_ushort a19, v21, s[68:71], 0 offen offset:768
  s_mov_b64 exec, -1
  v_subrev_u32 v2, 64, v0
  v_cmp_gt_u32 vcc, 128, v2
  v_lshrrev_b32 v3, 3, v2
  v_lshlrev_b32 v3, 13, v3
  v_and_b32 v2, 7, v2
  v_lshl_add_u32 v3, v2, 7, v3
  s_and_b32 s56, s45, 15
  s_lshl_b32 s56, s56, 17
  s_lshl_b32 s61, s46, 10
  s_add_u32 s56, s56, s61
  s_mov_b64 exec, vcc
  s_add_u32 s61, s56, 0
  buffer_load_dword a40, v3, s[20:23], s61 offen
  s_mov_b64 exec, -1
  v_mov_b32 v7, 0x3f803f80
  s_waitcnt vmcnt(24)
  v_dot2_f32_bf16 v32, v64, v7, 0
  v_dot2_f32_bf16 v48, v64, v64, 0
  v_dot2_f32_bf16 v32, v65, v7, v32
  v_dot2_f32_bf16 v48, v65, v65, v48
  v_dot2_f32_bf16 v32, v66, v7, v32
  v_dot2_f32_bf16 v48, v66, v66, v48
  v_dot2_f32_bf16 v32, v67, v7, v32
  v_dot2_f32_bf16 v48, v67, v67, v48
  s_waitcnt vmcnt(23)
  v_dot2_f32_bf16 v33, v68, v7, 0
  v_dot2_f32_bf16 v49, v68, v68, 0
  v_dot2_f32_bf16 v33, v69, v7, v33
  v_dot2_f32_bf16 v49, v69, v69, v49
  v_dot2_f32_bf16 v33, v70, v7, v33
  v_dot2_f32_bf16 v49, v70, v70, v49
  v_dot2_f32_bf16 v33, v71, v7, v33
  v_dot2_f32_bf16 v49, v71, v71, v49
  s_waitcnt vmcnt(22)
  v_dot2_f32_bf16 v34, v72, v7, 0
  v_dot2_f32_bf16 v50, v72, v72, 0
  v_dot2_f32_bf16 v34, v73, v7, v34
  v_dot2_f32_bf16 v50, v73, v73, v50
  v_dot2_f32_bf16 v34, v74, v7, v34
  v_dot2_f32_bf16 v50, v74, v74, v50
  v_dot2_f32_bf16 v34, v75, v7, v34
  v_dot2_f32_bf16 v50, v75, v75, v50
  s_waitcnt vmcnt(21)
  v_dot2_f32_bf16 v35, v76, v7, 0
  v_dot2_f32_bf16 v51, v76, v76, 0
  v_dot2_f32_bf16 v35, v77, v7, v35
  v_dot2_f32_bf16 v51, v77, v77, v51
  v_dot2_f32_bf16 v35, v78, v7, v35
  v_dot2_f32_bf16 v51, v78, v78, v51
  v_dot2_f32_bf16 v35, v79, v7, v35
  v_dot2_f32_bf16 v51, v79, v79, v51
  s_waitcnt vmcnt(20)
  v_dot2_f32_bf16 v36, v80, v7, 0
  v_dot2_f32_bf16 v52, v80, v80, 0
  v_dot2_f32_bf16 v36, v81, v7, v36
  v_dot2_f32_bf16 v52, v81, v81, v52
  v_dot2_f32_bf16 v36, v82, v7, v36
  v_dot2_f32_bf16 v52, v82, v82, v52
  v_dot2_f32_bf16 v36, v83, v7, v36
  v_dot2_f32_bf16 v52, v83, v83, v52
  s_waitcnt vmcnt(19)
  v_dot2_f32_bf16 v37, v84, v7, 0
  v_dot2_f32_bf16 v53, v84, v84, 0
  v_dot2_f32_bf16 v37, v85, v7, v37
  v_dot2_f32_bf16 v53, v85, v85, v53
  v_dot2_f32_bf16 v37, v86, v7, v37
  v_dot2_f32_bf16 v53, v86, v86, v53
  v_dot2_f32_bf16 v37, v87, v7, v37
  v_dot2_f32_bf16 v53, v87, v87, v53
  s_waitcnt vmcnt(18)
  v_dot2_f32_bf16 v38, v88, v7, 0
  v_dot2_f32_bf16 v54, v88, v88, 0
  v_dot2_f32_bf16 v38, v89, v7, v38
  v_dot2_f32_bf16 v54, v89, v89, v54
  v_dot2_f32_bf16 v38, v90, v7, v38
  v_dot2_f32_bf16 v54, v90, v90, v54
  v_dot2_f32_bf16 v38, v91, v7, v38
  v_dot2_f32_bf16 v54, v91, v91, v54
  s_waitcnt vmcnt(17)
  v_dot2_f32_bf16 v39, v92, v7, 0
  v_dot2_f32_bf16 v55, v92, v92, 0
  v_dot2_f32_bf16 v39, v93, v7, v39
  v_dot2_f32_bf16 v55, v93, v93, v55
  v_dot2_f32_bf16 v39, v94, v7, v39
  v_dot2_f32_bf16 v55, v94, v94, v55
  v_dot2_f32_bf16 v39, v95, v7, v39
  v_dot2_f32_bf16 v55, v95, v95, v55
  s_waitcnt vmcnt(16)
  v_dot2_f32_bf16 v40, v96, v7, 0
  v_dot2_f32_bf16 v56, v96, v96, 0
  v_dot2_f32_bf16 v40, v97, v7, v40
  v_dot2_f32_bf16 v56, v97, v97, v56
  v_dot2_f32_bf16 v40, v98, v7, v40
  v_dot2_f32_bf16 v56, v98, v98, v56
  v_dot2_f32_bf16 v40, v99, v7, v40
  v_dot2_f32_bf16 v56, v99, v99, v56
  s_waitcnt vmcnt(15)
  v_dot2_f32_bf16 v41, v100, v7, 0
  v_dot2_f32_bf16 v57, v100, v100, 0
  v_dot2_f32_bf16 v41, v101, v7, v41
  v_dot2_f32_bf16 v57, v101, v101, v57
  v_dot2_f32_bf16 v41, v102, v7, v41
  v_dot2_f32_bf16 v57, v102, v102, v57
  v_dot2_f32_bf16 v41, v103, v7, v41
  v_dot2_f32_bf16 v57, v103, v103, v57
  s_waitcnt vmcnt(14)
  v_dot2_f32_bf16 v42, v104, v7, 0
  v_dot2_f32_bf16 v58, v104, v104, 0
  v_dot2_f32_bf16 v42, v105, v7, v42
  v_dot2_f32_bf16 v58, v105, v105, v58
  v_dot2_f32_bf16 v42, v106, v7, v42
  v_dot2_f32_bf16 v58, v106, v106, v58
  v_dot2_f32_bf16 v42, v107, v7, v42
  v_dot2_f32_bf16 v58, v107, v107, v58
  s_waitcnt vmcnt(13)
  v_dot2_f32_bf16 v43, v108, v7, 0
  v_dot2_f32_bf16 v59, v108, v108, 0
  v_dot2_f32_bf16 v43, v109, v7, v43
  v_dot2_f32_bf16 v59, v109, v109, v59
  v_dot2_f32_bf16 v43, v110, v7, v43
  v_dot2_f32_bf16 v59, v110, v110, v59
  v_dot2_f32_bf16 v43, v111, v7, v43
  v_dot2_f32_bf16 v59, v111, v111, v59
  s_waitcnt vmcnt(12)
  v_dot2_f32_bf16 v44, v112, v7, 0
  v_dot2_f32_bf16 v60, v112, v112, 0
  v_dot2_f32_bf16 v44, v113, v7, v44
  v_dot2_f32_bf16 v60, v113, v113, v60
  v_dot2_f32_bf16 v44, v114, v7, v44
  v_dot2_f32_bf16 v60, v114, v114, v60
  v_dot2_f32_bf16 v44, v115, v7, v44
  v_dot2_f32_bf16 v60, v115, v115, v60
  s_waitcnt vmcnt(11)
  v_dot2_f32_bf16 v45, v116, v7, 0
  v_dot2_f32_bf16 v61, v116, v116, 0
  v_dot2_f32_bf16 v45, v117, v7, v45
  v_dot2_f32_bf16 v61, v117, v117, v61
  v_dot2_f32_bf16 v45, v118, v7, v45
  v_dot2_f32_bf16 v61, v118, v118, v61
  v_dot2_f32_bf16 v45, v119, v7, v45
  v_dot2_f32_bf16 v61, v119, v119, v61
  s_waitcnt vmcnt(10)
  v_dot2_f32_bf16 v46, v120, v7, 0
  v_dot2_f32_bf16 v62, v120, v120, 0
  v_dot2_f32_bf16 v46, v121, v7, v46
  v_dot2_f32_bf16 v62, v121, v121, v62
  v_dot2_f32_bf16 v46, v122, v7, v46
  v_dot2_f32_bf16 v62, v122, v122, v62
  v_dot2_f32_bf16 v46, v123, v7, v46
  v_dot2_f32_bf16 v62, v123, v123, v62
  s_waitcnt vmcnt(9)
  v_dot2_f32_bf16 v47, v124, v7, 0
  v_dot2_f32_bf16 v63, v124, v124, 0
  v_dot2_f32_bf16 v47, v125, v7, v47
  v_dot2_f32_bf16 v63, v125, v125, v63
  v_dot2_f32_bf16 v47, v126, v7, v47
  v_dot2_f32_bf16 v63, v126, v126, v63
  v_dot2_f32_bf16 v47, v127, v7, v47
  v_dot2_f32_bf16 v63, v127, v127, v63
  s_mov_b32 s48, 0
  s_add_u32 m0, s48, s51
  s_nop 0
  buffer_load_dwordx4 v8, s[20:23], s52 offen lds
  v_permlane32_swap_b32 v32, v40
  v_permlane32_swap_b32 v33, v41
  v_permlane32_swap_b32 v34, v42
  v_permlane32_swap_b32 v35, v43
  v_permlane32_swap_b32 v36, v44
  v_permlane32_swap_b32 v37, v45
  v_permlane32_swap_b32 v38, v46
  v_permlane32_swap_b32 v39, v47
  v_add_f32 v32, v32, v40
  v_add_f32 v33, v33, v41
  s_add_u32 m0, m0, 1024
  s_nop 0
  buffer_load_dwordx4 v9, s[20:23], s52 offen lds
  v_add_f32 v34, v34, v42
  v_add_f32 v35, v35, v43
  v_add_f32 v36, v36, v44
  v_add_f32 v37, v37, v45
  v_add_f32 v38, v38, v46
  v_add_f32 v39, v39, v47
  v_permlane16_swap_b32 v32, v36
  v_permlane16_swap_b32 v33, v37
  v_permlane16_swap_b32 v34, v38
  v_permlane16_swap_b32 v35, v39
  s_add_u32 m0, m0, 896
  s_nop 0
  buffer_load_dwordx4 v8, s[20:23], s52 offen offset:128 lds
  v_add_f32 v32, v32, v36
  v_add_f32 v33, v33, v37
  v_add_f32 v34, v34, v38
  v_add_f32 v35, v35, v39
  v_add_f32 v36, v32, v32 row_ror:8 row_mask:0xf bank_mask:0x3
  s_nop 1
  v_add_f32 v36, v34, v34 row_ror:8 row_mask:0xf bank_mask:0xc
  v_add_f32 v37, v33, v33 row_ror:8 row_mask:0xf bank_mask:0x3
  s_nop 1
  v_add_f32 v37, v35, v35 row_ror:8 row_mask:0xf bank_mask:0xc
  v_add_f32 v16, v36, v36 row_shl:4 row_mask:0xf bank_mask:0x5
  s_nop 1
  v_add_f32 v16, v37, v37 row_shr:4 row_mask:0xf bank_mask:0xa
  s_add_u32 m0, m0, 1024
  s_nop 0
  buffer_load_dwordx4 v9, s[20:23], s52 offen offset:128 lds
  s_add_u32 s52, s52, 131072
  v_add_f32 v16, v16, v16 quad_perm:[1,0,3,2] row_mask:0xf bank_mask:0xf
  s_nop 1
  v_add_f32 v16, v16, v16 quad_perm:[2,3,0,1] row_mask:0xf bank_mask:0xf
  v_permlane32_swap_b32 v48, v56
  v_permlane32_swap_b32 v49, v57
  v_permlane32_swap_b32 v50, v58
  v_permlane32_swap_b32 v51, v59
  v_permlane32_swap_b32 v52, v60
  v_permlane32_swap_b32 v53, v61
  v_permlane32_swap_b32 v54, v62
  v_permlane32_swap_b32 v55, v63
  s_mov_b32 s48, 16384
  s_add_u32 m0, s48, s51
  s_nop 0
  buffer_load_dwordx4 v8, s[20:23], s52 offen lds
  v_add_f32 v48, v48, v56
  v_add_f32 v49, v49, v57
  v_add_f32 v50, v50, v58
  v_add_f32 v51, v51, v59
  v_add_f32 v52, v52, v60
  v_add_f32 v53, v53, v61
  v_add_f32 v54, v54, v62
  v_add_f32 v55, v55, v63
  v_permlane16_swap_b32 v48, v52
  v_permlane16_swap_b32 v49, v53
  s_add_u32 m0, m0, 1024
  s_nop 0
  buffer_load_dwordx4 v9, s[20:23], s52 offen lds
  v_permlane16_swap_b32 v50, v54
  v_permlane16_swap_b32 v51, v55
  v_add_f32 v48, v48, v52
  v_add_f32 v49, v49, v53
  v_add_f32 v50, v50, v54
  v_add_f32 v51, v51, v55
  v_add_f32 v52, v48, v48 row_ror:8 row_mask:0xf bank_mask:0x3
  s_nop 1
  v_add_f32 v52, v50, v50 row_ror:8 row_mask:0xf bank_mask:0xc
  v_add_f32 v53, v49, v49 row_ror:8 row_mask:0xf bank_mask:0x3
  s_nop 1
  v_add_f32 v53, v51, v51 row_ror:8 row_mask:0xf bank_mask:0xc
  s_add_u32 m0, m0, 896
  s_nop 0
  buffer_load_dwordx4 v8, s[20:23], s52 offen offset:128 lds
  v_add_f32 v19, v52, v52 row_shl:4 row_mask:0xf bank_mask:0x5
  s_nop 1
  v_add_f32 v19, v53, v53 row_shr:4 row_mask:0xf bank_mask:0xa
  s_nop 1
  v_add_f32 v19, v19, v19 quad_perm:[1,0,3,2] row_mask:0xf bank_mask:0xf
  s_nop 1
  v_add_f32 v19, v19, v19 quad_perm:[2,3,0,1] row_mask:0xf bank_mask:0xf
  v_mul_f32 v16, 0x3b000000, v16
  v_cvt_pk_bf16_f32 v17, v16, v16
  v_lshlrev_b32 v17, 16, v17
  v_mul_f32 v16, v16, v16
  v_mov_b32 v7, 0x3b000000
  v_fma_f32 v19, v19, v7, -v16
  s_add_u32 m0, m0, 1024
  s_nop 0
  buffer_load_dwordx4 v9, s[20:23], s52 offen offset:128 lds
  s_add_u32 s52, s52, 131072
  v_max_f32 v19, 0, v19
  v_cvt_pk_bf16_f32 v19, v19, v19
  v_lshlrev_b32 v19, 16, v19
  v_add_f32 v19, 0x3727c5ac, v19
  v_cvt_pk_bf16_f32 v19, v19, v19
  v_lshlrev_b32 v19, 16, v19
  v_sqrt_f32 v19, v19
  s_nop 0
  v_cvt_pk_bf16_f32 v19, v19, v19
  v_lshlrev_b32 v19, 16, v19
  v_rcp_f32 v19, v19
  s_mov_b32 s48, 32768
  s_add_u32 m0, s48, s51
  s_nop 0
  buffer_load_dwordx4 v8, s[20:23], s52 offen lds
  v_mul_f32 v17, v17, v19
  v_sub_f32 v17, 0, v17
  v_lshlrev_b32 v128, 16, v64
  v_and_b32 v129, 0xffff0000, v64
  v_lshlrev_b32 v130, 16, v65
  v_and_b32 v131, 0xffff0000, v65
  v_lshlrev_b32 v132, 16, v66
  v_and_b32 v133, 0xffff0000, v66
  v_lshlrev_b32 v134, 16, v67
  v_and_b32 v135, 0xffff0000, v67
  s_add_u32 m0, m0, 1024
  s_nop 0
  buffer_load_dwordx4 v9, s[20:23], s52 offen lds
  v_lshlrev_b32 v136, 16, v68
  v_and_b32 v137, 0xffff0000, v68
  v_lshlrev_b32 v138, 16, v69
  v_and_b32 v139, 0xffff0000, v69
  v_lshlrev_b32 v140, 16, v70
  v_and_b32 v141, 0xffff0000, v70
  v_lshlrev_b32 v142, 16, v71
  v_and_b32 v143, 0xffff0000, v71
  v_lshlrev_b32 v144, 16, v72
  v_and_b32 v145, 0xffff0000, v72
  s_add_u32 m0, m0, 896
  s_nop 0
  buffer_load_dwordx4 v8, s[20:23], s52 offen offset:128 lds
  v_lshlrev_b32 v146, 16, v73
  v_and_b32 v147, 0xffff0000, v73
  v_lshlrev_b32 v148, 16, v74
  v_and_b32 v149, 0xffff0000, v74
  v_lshlrev_b32 v150, 16, v75
  v_and_b32 v151, 0xffff0000, v75
  v_lshlrev_b32 v152, 16, v76
  v_and_b32 v153, 0xffff0000, v76
  v_lshlrev_b32 v154, 16, v77
  v_and_b32 v155, 0xffff0000, v77
  s_add_u32 m0, m0, 1024
  s_nop 0
  buffer_load_dwordx4 v9, s[20:23], s52 offen offset:128 lds
  s_add_u32 s52, s52, 131072
  v_lshlrev_b32 v156, 16, v78
  v_and_b32 v157, 0xffff0000, v78
  v_lshlrev_b32 v158, 16, v79
  v_and_b32 v159, 0xffff0000, v79
  v_lshlrev_b32 v160, 16, v80
  v_and_b32 v161, 0xffff0000, v80
  v_lshlrev_b32 v162, 16, v81
  v_and_b32 v163, 0xffff0000, v81
  v_lshlrev_b32 v164, 16, v82
  v_and_b32 v165, 0xffff0000, v82
  s_mov_b32 s48, 49152
  s_add_u32 m0, s48, s51
  s_nop 0
  buffer_load_dwordx4 v8, s[20:23], s52 offen lds
  v_lshlrev_b32 v166, 16, v83
  v_and_b32 v167, 0xffff0000, v83
  v_lshlrev_b32 v168, 16, v84
  v_and_b32 v169, 0xffff0000, v84
  v_lshlrev_b32 v170, 16, v85
  v_and_b32 v171, 0xffff0000, v85
  v_lshlrev_b32 v172, 16, v86
  v_and_b32 v173, 0xffff0000, v86
  v_lshlrev_b32 v174, 16, v87
  v_and_b32 v175, 0xffff0000, v87
  s_add_u32 m0, m0, 1024
  s_nop 0
  buffer_load_dwordx4 v9, s[20:23], s52 offen lds
  v_lshlrev_b32 v176, 16, v88
  v_and_b32 v177, 0xffff0000, v88
  v_lshlrev_b32 v178, 16, v89
  v_and_b32 v179, 0xffff0000, v89
  v_lshlrev_b32 v180, 16, v90
  v_and_b32 v181, 0xffff0000, v90
  v_lshlrev_b32 v182, 16, v91
  v_and_b32 v183, 0xffff0000, v91
  v_lshlrev_b32 v184, 16, v92
  v_and_b32 v185, 0xffff0000, v92
  s_add_u32 m0, m0, 896
  s_nop 0
  buffer_load_dwordx4 v8, s[20:23], s52 offen offset:128 lds
  v_lshlrev_b32 v186, 16, v93
  v_and_b32 v187, 0xffff0000, v93
  v_lshlrev_b32 v188, 16, v94
  v_and_b32 v189, 0xffff0000, v94
  v_lshlrev_b32 v190, 16, v95
  v_and_b32 v191, 0xffff0000, v95
  v_lshlrev_b32 v192, 16, v96
  v_and_b32 v193, 0xffff0000, v96
  v_lshlrev_b32 v194, 16, v97
  v_and_b32 v195, 0xffff0000, v97
  s_add_u32 m0, m0, 1024
  s_nop 0
  buffer_load_dwordx4 v9, s[20:23], s52 offen offset:128 lds
  s_add_u32 s52, s52, 131072
  v_lshlrev_b32 v196, 16, v98
  v_and_b32 v197, 0xffff0000, v98
  v_lshlrev_b32 v198, 16, v99
  v_and_b32 v199, 0xffff0000, v99
  v_lshlrev_b32 v200, 16, v100
  v_and_b32 v201, 0xffff0000, v100
  v_lshlrev_b32 v202, 16, v101
  v_and_b32 v203, 0xffff0000, v101
  v_lshlrev_b32 v204, 16, v102
  v_and_b32 v205, 0xffff0000, v102
  s_mov_b32 s48, 65536
  s_add_u32 m0, s48, s51
  s_nop 0
  buffer_load_dwordx4 v8, s[20:23], s52 offen lds
  v_lshlrev_b32 v206, 16, v103
  v_and_b32 v207, 0xffff0000, v103
  v_lshlrev_b32 v208, 16, v104
  v_and_b32 v209, 0xffff0000, v104
  v_lshlrev_b32 v210, 16, v105
  v_and_b32 v211, 0xffff0000, v105
  v_lshlrev_b32 v212, 16, v106
  v_and_b32 v213, 0xffff0000, v106
  v_lshlrev_b32 v214, 16, v107
  v_and_b32 v215, 0xffff0000, v107
  s_add_u32 m0, m0, 1024
  s_nop 0
  buffer_load_dwordx4 v9, s[20:23], s52 offen lds
  v_lshlrev_b32 v216, 16, v108
  v_and_b32 v217, 0xffff0000, v108
  v_lshlrev_b32 v218, 16, v109
  v_and_b32 v219, 0xffff0000, v109
  v_lshlrev_b32 v220, 16, v110
  v_and_b32 v221, 0xffff0000, v110
  v_lshlrev_b32 v222, 16, v111
  v_and_b32 v223, 0xffff0000, v111
  v_lshlrev_b32 v224, 16, v112
  v_and_b32 v225, 0xffff0000, v112
  s_add_u32 m0, m0, 896
  s_nop 0
  buffer_load_dwordx4 v8, s[20:23], s52 offen offset:128 lds
  v_lshlrev_b32 v226, 16, v113
  v_and_b32 v227, 0xffff0000, v113
  v_lshlrev_b32 v228, 16, v114
  v_and_b32 v229, 0xffff0000, v114
  v_lshlrev_b32 v230, 16, v115
  v_and_b32 v231, 0xffff0000, v115
  v_lshlrev_b32 v232, 16, v116
  v_and_b32 v233, 0xffff0000, v116
  v_lshlrev_b32 v234, 16, v117
  v_and_b32 v235, 0xffff0000, v117
  s_add_u32 m0, m0, 1024
  s_nop 0
  buffer_load_dwordx4 v9, s[20:23], s52 offen offset:128 lds
  s_add_u32 s52, s52, 131072
  v_lshlrev_b32 v236, 16, v118
  v_and_b32 v237, 0xffff0000, v118
  v_lshlrev_b32 v238, 16, v119
  v_and_b32 v239, 0xffff0000, v119
  v_lshlrev_b32 v240, 16, v120
  v_and_b32 v241, 0xffff0000, v120
  v_lshlrev_b32 v242, 16, v121
  v_and_b32 v243, 0xffff0000, v121
  v_lshlrev_b32 v244, 16, v122
  v_and_b32 v245, 0xffff0000, v122
  v_lshlrev_b32 v246, 16, v123
  v_and_b32 v247, 0xffff0000, v123
  v_lshlrev_b32 v248, 16, v124
  v_and_b32 v249, 0xffff0000, v124
  v_lshlrev_b32 v250, 16, v125
  v_and_b32 v251, 0xffff0000, v125
  v_lshlrev_b32 v252, 16, v126
  v_and_b32 v253, 0xffff0000, v126
  v_lshlrev_b32 v254, 16, v127
  v_and_b32 v255, 0xffff0000, v127
  v_subrev_u32 v2, 64, v0
  v_cmp_gt_u32 vcc, 128, v2
  v_lshrrev_b32 v3, 3, v2
  v_lshlrev_b32 v3, 13, v3
  v_and_b32 v2, 7, v2
  v_lshl_add_u32 v3, v2, 7, v3
  s_and_b32 s56, s45, 15
  s_lshl_b32 s56, s56, 17
  s_lshl_b32 s61, s46, 10
  s_add_u32 s56, s56, s61
  s_mov_b64 exec, vcc
  s_add_u32 s61, s56, 2097152
  buffer_load_dword a41, v3, s[20:23], s61 offen
  s_mov_b64 exec, -1
  v_lshlrev_b32 v2, 6, v1
  s_and_b32 s61, s45, 15
  s_lshl_b32 s61, s61, 12
  s_add_u32 s56, s54, s61
  s_cmp_eq_u32 s44, 3
  s_cselect_b64 exec, -1, 0
  buffer_load_dword a24, v2, s[24:27], s56 offen
  buffer_load_dword a25, v2, s[28:31], s56 offen
  s_add_u32 s56, s56, 65536
  buffer_load_dword a26, v2, s[24:27], s56 offen
  buffer_load_dword a27, v2, s[28:31], s56 offen
  s_add_u32 s56, s56, 65536
  s_mov_b64 exec, -1
  s_cmp_ge_u32 s67, 128
  s_cbranch_scc1 k2_geb
  s_waitcnt vmcnt(33)
  v_accvgpr_read_b32 v32, a0
  v_accvgpr_read_b32 v33, a1
  v_accvgpr_read_b32 v34, a2
  v_accvgpr_read_b32 v35, a3
  s_waitcnt vmcnt(32)
  v_accvgpr_read_b32 v36, a4
  v_accvgpr_read_b32 v37, a5
  v_accvgpr_read_b32 v38, a6
  v_accvgpr_read_b32 v39, a7
  s_waitcnt vmcnt(31)
  v_accvgpr_read_b32 v40, a8
  v_accvgpr_read_b32 v41, a9
  v_accvgpr_read_b32 v42, a10
  v_accvgpr_read_b32 v43, a11
  s_waitcnt vmcnt(30)
  v_accvgpr_read_b32 v44, a12
  v_accvgpr_read_b32 v45, a13
  v_accvgpr_read_b32 v46, a14
  v_accvgpr_read_b32 v47, a15
  s_waitcnt vmcnt(29)
  v_accvgpr_read_b32 v56, a16
  s_waitcnt vmcnt(28)
  v_accvgpr_read_b32 v57, a17
  s_waitcnt vmcnt(27)
  v_accvgpr_read_b32 v58, a18
  s_waitcnt vmcnt(26)
  v_accvgpr_read_b32 v59, a19
  v_lshlrev_b32 v56, 16, v56
  v_lshlrev_b32 v57, 16, v57
  v_lshlrev_b32 v58, 16, v58
  v_lshlrev_b32 v59, 16, v59
  v_mul_f32 v60, 0xbfb8aa3b, v56
  v_mul_f32 v61, 0xbfb8aa3b, v57
  v_mul_f32 v62, 0xbfb8aa3b, v58
  v_mul_f32 v63, 0xbfb8aa3b, v59
  v_exp_f32 v60, v60
  v_exp_f32 v61, v61
  v_exp_f32 v62, v62
  v_exp_f32 v63, v63
  v_add_f32 v60, 1.0, v60
  v_add_f32 v61, 1.0, v61
  v_add_f32 v62, 1.0, v62
  v_add_f32 v63, 1.0, v63
  v_rcp_f32 v60, v60
  v_rcp_f32 v61, v61
  v_rcp_f32 v62, v62
  v_rcp_f32 v63, v63
  v_mul_f32 v56, v56, v60
  v_mul_f32 v57, v57, v61
  v_mul_f32 v58, v58, v62
  v_mul_f32 v59, v59, v63
  v_cvt_pk_bf16_f32 v56, v56, v56
  v_lshlrev_b32 v56, 16, v56
  v_cvt_pk_bf16_f32 v57, v57, v57
  v_lshlrev_b32 v57, 16, v57
  v_cvt_pk_bf16_f32 v58, v58, v58
  v_lshlrev_b32 v58, 16, v58
  v_cvt_pk_bf16_f32 v59, v59, v59
  v_lshlrev_b32 v59, 16, v59
  v_lshlrev_b32 v28, 16, v32
  v_and_b32 v29, 0xffff0000, v32
  v_mul_f32 v48, v56, v28
  v_mul_f32 v49, v56, v29
  v_lshlrev_b32 v28, 16, v33
  v_and_b32 v29, 0xffff0000, v33
  v_mul_f32 v50, v56, v28
  v_mul_f32 v51, v56, v29
  v_lshlrev_b32 v28, 16, v34
  v_and_b32 v29, 0xffff0000, v34
  v_mul_f32 v52, v56, v28
  v_mul_f32 v53, v56, v29
  v_lshlrev_b32 v28, 16, v35
  v_and_b32 v29, 0xffff0000, v35
  v_mul_f32 v54, v56, v28
  v_mul_f32 v55, v56, v29
  v_lshlrev_b32 v28, 16, v36
  v_and_b32 v29, 0xffff0000, v36
  v_fmac_f32 v48, v57, v28
  v_fmac_f32 v49, v57, v29
  v_lshlrev_b32 v28, 16, v37
  v_and_b32 v29, 0xffff0000, v37
  v_fmac_f32 v50, v57, v28
  v_fmac_f32 v51, v57, v29
  v_lshlrev_b32 v28, 16, v38
  v_and_b32 v29, 0xffff0000, v38
  v_fmac_f32 v52, v57, v28
  v_fmac_f32 v53, v57, v29
  v_lshlrev_b32 v28, 16, v39
  v_and_b32 v29, 0xffff0000, v39
  v_fmac_f32 v54, v57, v28
  v_fmac_f32 v55, v57, v29
  v_lshlrev_b32 v28, 16, v40
  v_and_b32 v29, 0xffff0000, v40
  v_fmac_f32 v48, v58, v28
  v_fmac_f32 v49, v58, v29
  v_lshlrev_b32 v28, 16, v41
  v_and_b32 v29, 0xffff0000, v41
  v_fmac_f32 v50, v58, v28
  v_fmac_f32 v51, v58, v29
  v_lshlrev_b32 v28, 16, v42
  v_and_b32 v29, 0xffff0000, v42
  v_fmac_f32 v52, v58, v28
  v_fmac_f32 v53, v58, v29
  v_lshlrev_b32 v28, 16, v43
  v_and_b32 v29, 0xffff0000, v43
  v_fmac_f32 v54, v58, v28
  v_fmac_f32 v55, v58, v29
  v_lshlrev_b32 v28, 16, v44
  v_and_b32 v29, 0xffff0000, v44
  v_fmac_f32 v48, v59, v28
  v_fmac_f32 v49, v59, v29
  v_lshlrev_b32 v28, 16, v45
  v_and_b32 v29, 0xffff0000, v45
  v_fmac_f32 v50, v59, v28
  v_fmac_f32 v51, v59, v29
  v_lshlrev_b32 v28, 16, v46
  v_and_b32 v29, 0xffff0000, v46
  v_fmac_f32 v52, v59, v28
  v_fmac_f32 v53, v59, v29
  v_lshlrev_b32 v28, 16, v47
  v_and_b32 v29, 0xffff0000, v47
  v_fmac_f32 v54, v59, v28
  v_fmac_f32 v55, v59, v29
  v_permlane32_swap_b32 v48, v52
  v_permlane32_swap_b32 v49, v53
  v_permlane32_swap_b32 v50, v54
  v_permlane32_swap_b32 v51, v55
  v_add_f32 v48, v48, v52
  v_add_f32 v49, v49, v53
  v_add_f32 v50, v50, v54
  v_add_f32 v51, v51, v55
  s_nop 0
  v_permlane16_swap_b32 v48, v50
  v_permlane16_swap_b32 v49, v51
  v_add_f32 v48, v48, v50
  v_add_f32 v49, v49, v51
  v_lshrrev_b32 v2, 3, v1
  v_add_f32 v50, v48, v48 row_ror:8 row_mask:0xf bank_mask:0x3
  v_lshl_add_u32 v2, v24, 3, v2
  s_lshl_b32 s56, s44, 6
  v_add_f32 v50, v49, v49 row_ror:8 row_mask:0xf bank_mask:0xc
  v_add_u32 v2, s56, v2
  v_lshlrev_b32 v2, 2, v2
  v_add_f32 v51, v50, v50 row_shl:4 row_mask:0xf bank_mask:0x5
  s_nop 1
  v_add_f32 v51, v50, v50 row_shr:4 row_mask:0xf bank_mask:0xa
  s_nop 1
  v_add_f32 v50, v51, v51 quad_perm:[2,3,0,1] row_mask:0xf bank_mask:0xf
  ds_write_b32 v2, v50
  s_waitcnt lgkmcnt(0)
  s_barrier
  s_cmp_eq_u32 s44, 0
  s_cbranch_scc0 k2_geb
  v_lshlrev_b32 v2, 2, v1
  ds_read_b32 v48, v2 offset:0
  ds_read_b32 v49, v2 offset:256
  ds_read_b32 v50, v2 offset:512
  ds_read_b32 v51, v2 offset:768
  s_lshr_b32 s56, s65, 5
  s_cmp_eq_u32 s56, 4
  s_cselect_b32 s61, 1.0, 0
  s_add_u32 s56, s66, 194560
  s_waitcnt lgkmcnt(2)
  v_add_f32 v48, v48, v49
  s_waitcnt lgkmcnt(0)
  v_add_f32 v50, v50, v51
  v_add_f32 v48, v48, v50
  v_cvt_pk_bf16_f32 v48, v48, v48
  v_lshlrev_b32 v48, 16, v48
  v_add_f32 v48, s61, v48
  v_cvt_pk_bf16_f32 v48, v48, v48
  v_lshlrev_b32 v2, 1, v1
  s_mov_b64 exec, 0xffff
  buffer_store_short v48, v2, s[36:39], s56 offen sc1
  s_mov_b64 exec, -1
k2_geb:
  s_cmp_eq_u32 s44, 0
  s_cbranch_scc0 k2_pw
  s_mov_b32 s76, s100
  s_mov_b32 s77, s101
  s_mov_b32 s78, 0x100
  s_mov_b32 s79, 0x20000
  v_mov_b32 v2, 0
  s_mov_b32 s50, 0
  s_mov_b64 exec, 1
k2_poll:
  buffer_load_dword v3, v2, s[76:79], 0 offen sc1
  s_add_u32 s50, s50, 1
  s_waitcnt vmcnt(0)
  v_readfirstlane_b32 s56, v3
  s_nop 0
  s_cmp_ge_u32 s56, 64
  s_cbranch_scc1 k2_pd
  s_sleep 4
  s_cmp_lt_u32 s50, 0x80000
  s_cbranch_scc1 k2_poll
k2_pd:
  s_mov_b64 exec, -1
k2_pw:
  s_barrier
  v_lshlrev_b32 v2, 4, v0
  s_mov_b32 s50, 0
  buffer_load_dwordx4 v[32:35], v2, s[36:39], s50 offen sc1
  s_mov_b32 s50, 16384
  buffer_load_dwordx4 v[36:39], v2, s[36:39], s50 offen sc1
  s_mov_b32 s50, 32768
  buffer_load_dwordx4 v[40:43], v2, s[36:39], s50 offen sc1
  s_mov_b32 s50, 49152
  buffer_load_dwordx4 v[44:47], v2, s[36:39], s50 offen sc1
  v_readlane_b32 s68, v19, 0
  v_readlane_b32 s69, v17, 0
  v_readlane_b32 s70, v19, 4
  v_readlane_b32 s71, v17, 4
  v_readlane_b32 s72, v19, 8
  v_readlane_b32 s73, v17, 8
  v_readlane_b32 s74, v19, 12
  v_readlane_b32 s75, v17, 12
  v_readlane_b32 s76, v19, 16
  v_readlane_b32 s77, v17, 16
  v_readlane_b32 s78, v19, 20
  v_readlane_b32 s79, v17, 20
  v_readlane_b32 s80, v19, 24
  v_readlane_b32 s81, v17, 24
  v_readlane_b32 s82, v19, 28
  v_readlane_b32 s83, v17, 28
  v_readlane_b32 s84, v19, 32
  v_readlane_b32 s85, v17, 32
  v_readlane_b32 s86, v19, 36
  v_readlane_b32 s87, v17, 36
  v_readlane_b32 s88, v19, 40
  v_readlane_b32 s89, v17, 40
  v_readlane_b32 s90, v19, 44
  v_readlane_b32 s91, v17, 44
  v_readlane_b32 s92, v19, 48
  v_readlane_b32 s93, v17, 48
  v_readlane_b32 s94, v19, 52
  v_readlane_b32 s95, v17, 52
  v_readlane_b32 s96, v19, 56
  v_readlane_b32 s97, v17, 56
  v_readlane_b32 s98, v19, 60
  v_readlane_b32 s99, v17, 60
  v_pk_fma_f32 v[128:129], v[128:129], s[68:69], s[68:69] op_sel:[0,0,1] op_sel_hi:[1,0,1]
  v_pk_fma_f32 v[130:131], v[130:131], s[68:69], s[68:69] op_sel:[0,0,1] op_sel_hi:[1,0,1]
  v_pk_fma_f32 v[132:133], v[132:133], s[68:69], s[68:69] op_sel:[0,0,1] op_sel_hi:[1,0,1]
  v_pk_fma_f32 v[134:135], v[134:135], s[68:69], s[68:69] op_sel:[0,0,1] op_sel_hi:[1,0,1]
  v_pk_fma_f32 v[136:137], v[136:137], s[70:71], s[70:71] op_sel:[0,0,1] op_sel_hi:[1,0,1]
  v_pk_fma_f32 v[138:139], v[138:139], s[70:71], s[70:71] op_sel:[0,0,1] op_sel_hi:[1,0,1]
  v_pk_fma_f32 v[140:141], v[140:141], s[70:71], s[70:71] op_sel:[0,0,1] op_sel_hi:[1,0,1]
  v_pk_fma_f32 v[142:143], v[142:143], s[70:71], s[70:71] op_sel:[0,0,1] op_sel_hi:[1,0,1]
  v_pk_fma_f32 v[144:145], v[144:145], s[72:73], s[72:73] op_sel:[0,0,1] op_sel_hi:[1,0,1]
  v_pk_fma_f32 v[146:147], v[146:147], s[72:73], s[72:73] op_sel:[0,0,1] op_sel_hi:[1,0,1]
  v_pk_fma_f32 v[148:149], v[148:149], s[72:73], s[72:73] op_sel:[0,0,1] op_sel_hi:[1,0,1]
  v_pk_fma_f32 v[150:151], v[150:151], s[72:73], s[72:73] op_sel:[0,0,1] op_sel_hi:[1,0,1]
  v_pk_fma_f32 v[152:153], v[152:153], s[74:75], s[74:75] op_sel:[0,0,1] op_sel_hi:[1,0,1]
  v_pk_fma_f32 v[154:155], v[154:155], s[74:75], s[74:75] op_sel:[0,0,1] op_sel_hi:[1,0,1]
  v_pk_fma_f32 v[156:157], v[156:157], s[74:75], s[74:75] op_sel:[0,0,1] op_sel_hi:[1,0,1]
  v_pk_fma_f32 v[158:159], v[158:159], s[74:75], s[74:75] op_sel:[0,0,1] op_sel_hi:[1,0,1]
  v_pk_fma_f32 v[160:161], v[160:161], s[76:77], s[76:77] op_sel:[0,0,1] op_sel_hi:[1,0,1]
  v_pk_fma_f32 v[162:163], v[162:163], s[76:77], s[76:77] op_sel:[0,0,1] op_sel_hi:[1,0,1]
  v_pk_fma_f32 v[164:165], v[164:165], s[76:77], s[76:77] op_sel:[0,0,1] op_sel_hi:[1,0,1]
  v_pk_fma_f32 v[166:167], v[166:167], s[76:77], s[76:77] op_sel:[0,0,1] op_sel_hi:[1,0,1]
  v_pk_fma_f32 v[168:169], v[168:169], s[78:79], s[78:79] op_sel:[0,0,1] op_sel_hi:[1,0,1]
  v_pk_fma_f32 v[170:171], v[170:171], s[78:79], s[78:79] op_sel:[0,0,1] op_sel_hi:[1,0,1]
  v_pk_fma_f32 v[172:173], v[172:173], s[78:79], s[78:79] op_sel:[0,0,1] op_sel_hi:[1,0,1]
  v_pk_fma_f32 v[174:175], v[174:175], s[78:79], s[78:79] op_sel:[0,0,1] op_sel_hi:[1,0,1]
  v_pk_fma_f32 v[176:177], v[176:177], s[80:81], s[80:81] op_sel:[0,0,1] op_sel_hi:[1,0,1]
  v_pk_fma_f32 v[178:179], v[178:179], s[80:81], s[80:81] op_sel:[0,0,1] op_sel_hi:[1,0,1]
  v_pk_fma_f32 v[180:181], v[180:181], s[80:81], s[80:81] op_sel:[0,0,1] op_sel_hi:[1,0,1]
  v_pk_fma_f32 v[182:183], v[182:183], s[80:81], s[80:81] op_sel:[0,0,1] op_sel_hi:[1,0,1]
  v_pk_fma_f32 v[184:185], v[184:185], s[82:83], s[82:83] op_sel:[0,0,1] op_sel_hi:[1,0,1]
  v_pk_fma_f32 v[186:187], v[186:187], s[82:83], s[82:83] op_sel:[0,0,1] op_sel_hi:[1,0,1]
  v_pk_fma_f32 v[188:189], v[188:189], s[82:83], s[82:83] op_sel:[0,0,1] op_sel_hi:[1,0,1]
  v_pk_fma_f32 v[190:191], v[190:191], s[82:83], s[82:83] op_sel:[0,0,1] op_sel_hi:[1,0,1]
  v_pk_fma_f32 v[192:193], v[192:193], s[84:85], s[84:85] op_sel:[0,0,1] op_sel_hi:[1,0,1]
  v_pk_fma_f32 v[194:195], v[194:195], s[84:85], s[84:85] op_sel:[0,0,1] op_sel_hi:[1,0,1]
  v_pk_fma_f32 v[196:197], v[196:197], s[84:85], s[84:85] op_sel:[0,0,1] op_sel_hi:[1,0,1]
  v_pk_fma_f32 v[198:199], v[198:199], s[84:85], s[84:85] op_sel:[0,0,1] op_sel_hi:[1,0,1]
  v_pk_fma_f32 v[200:201], v[200:201], s[86:87], s[86:87] op_sel:[0,0,1] op_sel_hi:[1,0,1]
  v_pk_fma_f32 v[202:203], v[202:203], s[86:87], s[86:87] op_sel:[0,0,1] op_sel_hi:[1,0,1]
  v_pk_fma_f32 v[204:205], v[204:205], s[86:87], s[86:87] op_sel:[0,0,1] op_sel_hi:[1,0,1]
  v_pk_fma_f32 v[206:207], v[206:207], s[86:87], s[86:87] op_sel:[0,0,1] op_sel_hi:[1,0,1]
  v_pk_fma_f32 v[208:209], v[208:209], s[88:89], s[88:89] op_sel:[0,0,1] op_sel_hi:[1,0,1]
  v_pk_fma_f32 v[210:211], v[210:211], s[88:89], s[88:89] op_sel:[0,0,1] op_sel_hi:[1,0,1]
  v_pk_fma_f32 v[212:213], v[212:213], s[88:89], s[88:89] op_sel:[0,0,1] op_sel_hi:[1,0,1]
  v_pk_fma_f32 v[214:215], v[214:215], s[88:89], s[88:89] op_sel:[0,0,1] op_sel_hi:[1,0,1]
  v_pk_fma_f32 v[216:217], v[216:217], s[90:91], s[90:91] op_sel:[0,0,1] op_sel_hi:[1,0,1]
  v_pk_fma_f32 v[218:219], v[218:219], s[90:91], s[90:91] op_sel:[0,0,1] op_sel_hi:[1,0,1]
  v_pk_fma_f32 v[220:221], v[220:221], s[90:91], s[90:91] op_sel:[0,0,1] op_sel_hi:[1,0,1]
  v_pk_fma_f32 v[222:223], v[222:223], s[90:91], s[90:91] op_sel:[0,0,1] op_sel_hi:[1,0,1]
  v_pk_fma_f32 v[224:225], v[224:225], s[92:93], s[92:93] op_sel:[0,0,1] op_sel_hi:[1,0,1]
  v_pk_fma_f32 v[226:227], v[226:227], s[92:93], s[92:93] op_sel:[0,0,1] op_sel_hi:[1,0,1]
  v_pk_fma_f32 v[228:229], v[228:229], s[92:93], s[92:93] op_sel:[0,0,1] op_sel_hi:[1,0,1]
  v_pk_fma_f32 v[230:231], v[230:231], s[92:93], s[92:93] op_sel:[0,0,1] op_sel_hi:[1,0,1]
  v_pk_fma_f32 v[232:233], v[232:233], s[94:95], s[94:95] op_sel:[0,0,1] op_sel_hi:[1,0,1]
  v_pk_fma_f32 v[234:235], v[234:235], s[94:95], s[94:95] op_sel:[0,0,1] op_sel_hi:[1,0,1]
  v_pk_fma_f32 v[236:237], v[236:237], s[94:95], s[94:95] op_sel:[0,0,1] op_sel_hi:[1,0,1]
  v_pk_fma_f32 v[238:239], v[238:239], s[94:95], s[94:95] op_sel:[0,0,1] op_sel_hi:[1,0,1]
  v_pk_fma_f32 v[240:241], v[240:241], s[96:97], s[96:97] op_sel:[0,0,1] op_sel_hi:[1,0,1]
  v_pk_fma_f32 v[242:243], v[242:243], s[96:97], s[96:97] op_sel:[0,0,1] op_sel_hi:[1,0,1]
  v_pk_fma_f32 v[244:245], v[244:245], s[96:97], s[96:97] op_sel:[0,0,1] op_sel_hi:[1,0,1]
  v_pk_fma_f32 v[246:247], v[246:247], s[96:97], s[96:97] op_sel:[0,0,1] op_sel_hi:[1,0,1]
  v_pk_fma_f32 v[248:249], v[248:249], s[98:99], s[98:99] op_sel:[0,0,1] op_sel_hi:[1,0,1]
  v_pk_fma_f32 v[250:251], v[250:251], s[98:99], s[98:99] op_sel:[0,0,1] op_sel_hi:[1,0,1]
  v_pk_fma_f32 v[252:253], v[252:253], s[98:99], s[98:99] op_sel:[0,0,1] op_sel_hi:[1,0,1]
  v_pk_fma_f32 v[254:255], v[254:255], s[98:99], s[98:99] op_sel:[0,0,1] op_sel_hi:[1,0,1]
  s_cmp_ge_u32 s44, 2
  s_cselect_b32 s50, 1.0, 0
  v_add_u32 v2, 147456, v2
  v_add_u32 v26, 147456, v26
  s_waitcnt vmcnt(2)
  v_pk_add_f32 v[32:33], v[32:33], v[36:37]
  v_pk_add_f32 v[34:35], v[34:35], v[38:39]
  s_waitcnt vmcnt(1)
  v_pk_add_f32 v[32:33], v[32:33], v[40:41]
  v_pk_add_f32 v[34:35], v[34:35], v[42:43]
  s_waitcnt vmcnt(0)
  v_pk_add_f32 v[32:33], v[32:33], v[44:45]
  v_pk_add_f32 v[34:35], v[34:35], v[46:47]
  v_cvt_pk_bf16_f32 v36, v32, v33
  v_lshlrev_b32 v32, 16, v36
  v_and_b32 v33, 0xffff0000, v36
  v_cvt_pk_bf16_f32 v37, v34, v35
  v_lshlrev_b32 v34, 16, v37
  v_and_b32 v35, 0xffff0000, v37
  v_add_f32 v32, s50, v32
  v_add_f32 v33, s50, v33
  v_add_f32 v34, s50, v34
  v_add_f32 v35, s50, v35
  v_cvt_pk_bf16_f32 v36, v32, v33
  v_lshlrev_b32 v32, 16, v36
  v_and_b32 v33, 0xffff0000, v36
  v_cvt_pk_bf16_f32 v37, v34, v35
  v_lshlrev_b32 v34, 16, v37
  v_and_b32 v35, 0xffff0000, v37
  v_mul_f32 v32, 0x3e0293ee, v32
  v_mul_f32 v33, 0x3e0293ee, v33
  v_mul_f32 v34, 0x3e0293ee, v34
  v_mul_f32 v35, 0x3e0293ee, v35
  ds_write_b128 v2, v[32:35]
  s_waitcnt lgkmcnt(0)
  s_barrier
  ds_read_b128 v[48:51], v26 offset:0
  ds_read_b128 v[52:55], v26 offset:16
  ds_read_b128 v[56:59], v26 offset:2048
  ds_read_b128 v[60:63], v26 offset:2064
  s_lshl_b32 s50, s46, 1
  s_waitcnt lgkmcnt(1)
  v_pk_fma_f32 v[128:129], v[128:129], v[56:57], v[48:49]
  v_pk_fma_f32 v[130:131], v[130:131], v[58:59], v[50:51]
  s_waitcnt lgkmcnt(0)
  v_pk_fma_f32 v[132:133], v[132:133], v[60:61], v[52:53]
  v_pk_fma_f32 v[134:135], v[134:135], v[62:63], v[54:55]
  s_mul_i32 s56, s50, 272
  v_xor_b32 v2, s56, v27
  s_add_u32 s50, s50, 1
  s_and_b32 s50, s50, 15
  v_cvt_pk_bf16_f32 v32, v128, v129
  v_cvt_pk_bf16_f32 v33, v130, v131
  v_cvt_pk_bf16_f32 v34, v132, v133
  v_cvt_pk_bf16_f32 v35, v134, v135
  ds_write_b128 v2, v[32:35]
  v_pk_fma_f32 v[136:137], v[136:137], v[56:57], v[48:49]
  v_pk_fma_f32 v[138:139], v[138:139], v[58:59], v[50:51]
  v_pk_fma_f32 v[140:141], v[140:141], v[60:61], v[52:53]
  v_pk_fma_f32 v[142:143], v[142:143], v[62:63], v[54:55]
  s_mul_i32 s56, s50, 272
  v_xor_b32 v3, s56, v27
  s_add_u32 s50, s50, 1
  s_and_b32 s50, s50, 15
  v_cvt_pk_bf16_f32 v36, v136, v137
  v_cvt_pk_bf16_f32 v37, v138, v139
  v_cvt_pk_bf16_f32 v38, v140, v141
  v_cvt_pk_bf16_f32 v39, v142, v143
  ds_write_b128 v3, v[36:39]
  v_pk_fma_f32 v[144:145], v[144:145], v[56:57], v[48:49]
  v_pk_fma_f32 v[146:147], v[146:147], v[58:59], v[50:51]
  v_pk_fma_f32 v[148:149], v[148:149], v[60:61], v[52:53]
  v_pk_fma_f32 v[150:151], v[150:151], v[62:63], v[54:55]
  s_mul_i32 s56, s50, 272
  v_xor_b32 v2, s56, v27
  s_add_u32 s50, s50, 1
  s_and_b32 s50, s50, 15
  v_cvt_pk_bf16_f32 v40, v144, v145
  v_cvt_pk_bf16_f32 v41, v146, v147
  v_cvt_pk_bf16_f32 v42, v148, v149
  v_cvt_pk_bf16_f32 v43, v150, v151
  ds_write_b128 v2, v[40:43]
  v_pk_fma_f32 v[152:153], v[152:153], v[56:57], v[48:49]
  v_pk_fma_f32 v[154:155], v[154:155], v[58:59], v[50:51]
  v_pk_fma_f32 v[156:157], v[156:157], v[60:61], v[52:53]
  v_pk_fma_f32 v[158:159], v[158:159], v[62:63], v[54:55]
  s_mul_i32 s56, s50, 272
  v_xor_b32 v3, s56, v27
  s_add_u32 s50, s50, 1
  s_and_b32 s50, s50, 15
  v_cvt_pk_bf16_f32 v44, v152, v153
  v_cvt_pk_bf16_f32 v45, v154, v155
  v_cvt_pk_bf16_f32 v46, v156, v157
  v_cvt_pk_bf16_f32 v47, v158, v159
  ds_write_b128 v3, v[44:47]
  v_pk_fma_f32 v[160:161], v[160:161], v[56:57], v[48:49]
  v_pk_fma_f32 v[162:163], v[162:163], v[58:59], v[50:51]
  v_pk_fma_f32 v[164:165], v[164:165], v[60:61], v[52:53]
  v_pk_fma_f32 v[166:167], v[166:167], v[62:63], v[54:55]
  s_mul_i32 s56, s50, 272
  v_xor_b32 v2, s56, v27
  s_add_u32 s50, s50, 1
  s_and_b32 s50, s50, 15
  v_cvt_pk_bf16_f32 v32, v160, v161
  v_cvt_pk_bf16_f32 v33, v162, v163
  v_cvt_pk_bf16_f32 v34, v164, v165
  v_cvt_pk_bf16_f32 v35, v166, v167
  ds_write_b128 v2, v[32:35]
  v_pk_fma_f32 v[168:169], v[168:169], v[56:57], v[48:49]
  v_pk_fma_f32 v[170:171], v[170:171], v[58:59], v[50:51]
  v_pk_fma_f32 v[172:173], v[172:173], v[60:61], v[52:53]
  v_pk_fma_f32 v[174:175], v[174:175], v[62:63], v[54:55]
  s_mul_i32 s56, s50, 272
  v_xor_b32 v3, s56, v27
  s_add_u32 s50, s50, 1
  s_and_b32 s50, s50, 15
  v_cvt_pk_bf16_f32 v36, v168, v169
  v_cvt_pk_bf16_f32 v37, v170, v171
  v_cvt_pk_bf16_f32 v38, v172, v173
  v_cvt_pk_bf16_f32 v39, v174, v175
  ds_write_b128 v3, v[36:39]
  v_pk_fma_f32 v[176:177], v[176:177], v[56:57], v[48:49]
  v_pk_fma_f32 v[178:179], v[178:179], v[58:59], v[50:51]
  v_pk_fma_f32 v[180:181], v[180:181], v[60:61], v[52:53]
  v_pk_fma_f32 v[182:183], v[182:183], v[62:63], v[54:55]
  s_mul_i32 s56, s50, 272
  v_xor_b32 v2, s56, v27
  s_add_u32 s50, s50, 1
  s_and_b32 s50, s50, 15
  v_cvt_pk_bf16_f32 v40, v176, v177
  v_cvt_pk_bf16_f32 v41, v178, v179
  v_cvt_pk_bf16_f32 v42, v180, v181
  v_cvt_pk_bf16_f32 v43, v182, v183
  ds_write_b128 v2, v[40:43]
  v_pk_fma_f32 v[184:185], v[184:185], v[56:57], v[48:49]
  v_pk_fma_f32 v[186:187], v[186:187], v[58:59], v[50:51]
  v_pk_fma_f32 v[188:189], v[188:189], v[60:61], v[52:53]
  v_pk_fma_f32 v[190:191], v[190:191], v[62:63], v[54:55]
  s_mul_i32 s56, s50, 272
  v_xor_b32 v3, s56, v27
  s_add_u32 s50, s50, 1
  s_and_b32 s50, s50, 15
  v_cvt_pk_bf16_f32 v44, v184, v185
  v_cvt_pk_bf16_f32 v45, v186, v187
  v_cvt_pk_bf16_f32 v46, v188, v189
  v_cvt_pk_bf16_f32 v47, v190, v191
  ds_write_b128 v3, v[44:47]
  v_pk_fma_f32 v[192:193], v[192:193], v[56:57], v[48:49]
  v_pk_fma_f32 v[194:195], v[194:195], v[58:59], v[50:51]
  v_pk_fma_f32 v[196:197], v[196:197], v[60:61], v[52:53]
  v_pk_fma_f32 v[198:199], v[198:199], v[62:63], v[54:55]
  s_mul_i32 s56, s50, 272
  v_xor_b32 v2, s56, v27
  s_add_u32 s50, s50, 1
  s_and_b32 s50, s50, 15
  v_cvt_pk_bf16_f32 v32, v192, v193
  v_cvt_pk_bf16_f32 v33, v194, v195
  v_cvt_pk_bf16_f32 v34, v196, v197
  v_cvt_pk_bf16_f32 v35, v198, v199
  ds_write_b128 v2, v[32:35]
  v_pk_fma_f32 v[200:201], v[200:201], v[56:57], v[48:49]
  v_pk_fma_f32 v[202:203], v[202:203], v[58:59], v[50:51]
  v_pk_fma_f32 v[204:205], v[204:205], v[60:61], v[52:53]
  v_pk_fma_f32 v[206:207], v[206:207], v[62:63], v[54:55]
  s_mul_i32 s56, s50, 272
  v_xor_b32 v3, s56, v27
  s_add_u32 s50, s50, 1
  s_and_b32 s50, s50, 15
  v_cvt_pk_bf16_f32 v36, v200, v201
  v_cvt_pk_bf16_f32 v37, v202, v203
  v_cvt_pk_bf16_f32 v38, v204, v205
  v_cvt_pk_bf16_f32 v39, v206, v207
  ds_write_b128 v3, v[36:39]
  v_pk_fma_f32 v[208:209], v[208:209], v[56:57], v[48:49]
  v_pk_fma_f32 v[210:211], v[210:211], v[58:59], v[50:51]
  v_pk_fma_f32 v[212:213], v[212:213], v[60:61], v[52:53]
  v_pk_fma_f32 v[214:215], v[214:215], v[62:63], v[54:55]
  s_mul_i32 s56, s50, 272
  v_xor_b32 v2, s56, v27
  s_add_u32 s50, s50, 1
  s_and_b32 s50, s50, 15
  v_cvt_pk_bf16_f32 v40, v208, v209
  v_cvt_pk_bf16_f32 v41, v210, v211
  v_cvt_pk_bf16_f32 v42, v212, v213
  v_cvt_pk_bf16_f32 v43, v214, v215
  ds_write_b128 v2, v[40:43]
  v_pk_fma_f32 v[216:217], v[216:217], v[56:57], v[48:49]
  v_pk_fma_f32 v[218:219], v[218:219], v[58:59], v[50:51]
  v_pk_fma_f32 v[220:221], v[220:221], v[60:61], v[52:53]
  v_pk_fma_f32 v[222:223], v[222:223], v[62:63], v[54:55]
  s_mul_i32 s56, s50, 272
  v_xor_b32 v3, s56, v27
  s_add_u32 s50, s50, 1
  s_and_b32 s50, s50, 15
  v_cvt_pk_bf16_f32 v44, v216, v217
  v_cvt_pk_bf16_f32 v45, v218, v219
  v_cvt_pk_bf16_f32 v46, v220, v221
  v_cvt_pk_bf16_f32 v47, v222, v223
  ds_write_b128 v3, v[44:47]
  v_pk_fma_f32 v[224:225], v[224:225], v[56:57], v[48:49]
  v_pk_fma_f32 v[226:227], v[226:227], v[58:59], v[50:51]
  v_pk_fma_f32 v[228:229], v[228:229], v[60:61], v[52:53]
  v_pk_fma_f32 v[230:231], v[230:231], v[62:63], v[54:55]
  s_mul_i32 s56, s50, 272
  v_xor_b32 v2, s56, v27
  s_add_u32 s50, s50, 1
  s_and_b32 s50, s50, 15
  v_cvt_pk_bf16_f32 v32, v224, v225
  v_cvt_pk_bf16_f32 v33, v226, v227
  v_cvt_pk_bf16_f32 v34, v228, v229
  v_cvt_pk_bf16_f32 v35, v230, v231
  ds_write_b128 v2, v[32:35]
  v_pk_fma_f32 v[232:233], v[232:233], v[56:57], v[48:49]
  v_pk_fma_f32 v[234:235], v[234:235], v[58:59], v[50:51]
  v_pk_fma_f32 v[236:237], v[236:237], v[60:61], v[52:53]
  v_pk_fma_f32 v[238:239], v[238:239], v[62:63], v[54:55]
  s_mul_i32 s56, s50, 272
  v_xor_b32 v3, s56, v27
  s_add_u32 s50, s50, 1
  s_and_b32 s50, s50, 15
  v_cvt_pk_bf16_f32 v36, v232, v233
  v_cvt_pk_bf16_f32 v37, v234, v235
  v_cvt_pk_bf16_f32 v38, v236, v237
  v_cvt_pk_bf16_f32 v39, v238, v239
  ds_write_b128 v3, v[36:39]
  v_pk_fma_f32 v[240:241], v[240:241], v[56:57], v[48:49]
  v_pk_fma_f32 v[242:243], v[242:243], v[58:59], v[50:51]
  v_pk_fma_f32 v[244:245], v[244:245], v[60:61], v[52:53]
  v_pk_fma_f32 v[246:247], v[246:247], v[62:63], v[54:55]
  s_mul_i32 s56, s50, 272
  v_xor_b32 v2, s56, v27
  s_add_u32 s50, s50, 1
  s_and_b32 s50, s50, 15
  v_cvt_pk_bf16_f32 v40, v240, v241
  v_cvt_pk_bf16_f32 v41, v242, v243
  v_cvt_pk_bf16_f32 v42, v244, v245
  v_cvt_pk_bf16_f32 v43, v246, v247
  ds_write_b128 v2, v[40:43]
  v_pk_fma_f32 v[248:249], v[248:249], v[56:57], v[48:49]
  v_pk_fma_f32 v[250:251], v[250:251], v[58:59], v[50:51]
  v_pk_fma_f32 v[252:253], v[252:253], v[60:61], v[52:53]
  v_pk_fma_f32 v[254:255], v[254:255], v[62:63], v[54:55]
  s_mul_i32 s56, s50, 272
  v_xor_b32 v3, s56, v27
  s_add_u32 s50, s50, 1
  s_and_b32 s50, s50, 15
  v_cvt_pk_bf16_f32 v44, v248, v249
  v_cvt_pk_bf16_f32 v45, v250, v251
  v_cvt_pk_bf16_f32 v46, v252, v253
  v_cvt_pk_bf16_f32 v47, v254, v255
  ds_write_b128 v3, v[44:47]
  s_mov_b32 s48, 81920
  s_mov_b32 s47, 0
  s_waitcnt lgkmcnt(0)
  s_barrier
  ds_read_b64_tr_b16 a[128:129], v5 offset:0
  ds_read_b64_tr_b16 a[130:131], v5 offset:512
  ds_read_b128 a[160:163], v6
  ds_read_b128 a[164:167], v6 offset:8192
  ds_read_b64_tr_b16 a[132:133], v5 offset:256
  ds_read_b64_tr_b16 a[134:135], v5 offset:768
  ds_read_b64_tr_b16 a[136:137], v5 offset:2048
  ds_read_b64_tr_b16 a[138:139], v5 offset:2560
  ds_read_b64_tr_b16 a[140:141], v5 offset:2304
  ds_read_b64_tr_b16 a[142:143], v5 offset:2816
  s_waitcnt lgkmcnt(4)
  v_mfma_f32_32x32x16_bf16 v[128:143], a[128:131], a[160:163], 0
  s_add_u32 m0, s48, s51
  s_mov_b32 s48, s47
  s_add_u32 s47, s47, 16384
  s_cmp_ge_u32 s47, 98304
  s_cselect_b32 s47, 0, s47
  v_add_u32 v5, s47, v4
  v_xor_b32 v7, 32, v6
  v_mfma_f32_32x32x16_bf16 v[144:159], a[128:131], a[164:167], 0
  ds_read_b64_tr_b16 a[144:145], v5 offset:0
  ds_read_b64_tr_b16 a[146:147], v5 offset:512
  v_mfma_f32_32x32x16_bf16 v[160:175], a[132:135], a[160:163], 0
  ds_read_b128 a[168:171], v7
  ds_read_b128 a[172:175], v7 offset:8192
  v_mfma_f32_32x32x16_bf16 v[176:191], a[132:135], a[164:167], 0
  ds_read_b64_tr_b16 a[148:149], v5 offset:256
  ds_read_b64_tr_b16 a[150:151], v5 offset:768
  buffer_load_dwordx4 v8, s[20:23], s52 offen lds
  s_add_u32 m0, m0, 1024
  s_waitcnt lgkmcnt(6)
  v_mfma_f32_32x32x16_bf16 v[192:207], a[136:139], a[160:163], 0
  ds_read_b64_tr_b16 a[152:153], v5 offset:2048
  ds_read_b64_tr_b16 a[154:155], v5 offset:2560
  buffer_load_dwordx4 v9, s[20:23], s52 offen lds
  s_add_u32 m0, m0, 896
  v_mfma_f32_32x32x16_bf16 v[208:223], a[136:139], a[164:167], 0
  ds_read_b64_tr_b16 a[156:157], v5 offset:2304
  ds_read_b64_tr_b16 a[158:159], v5 offset:2816
  v_mfma_f32_32x32x16_bf16 v[224:239], a[140:143], a[160:163], 0
  buffer_load_dwordx4 v8, s[20:23], s52 offen offset:128 lds
  s_add_u32 m0, m0, 1024
  v_mfma_f32_32x32x16_bf16 v[240:255], a[140:143], a[164:167], 0
  buffer_load_dwordx4 v9, s[20:23], s52 offen offset:128 lds
  s_add_u32 s52, s52, 131072
  s_mov_b32 s55, 0
  s_branch k2_p1e
k2_p1:
  s_waitcnt lgkmcnt(4)
  v_mfma_f32_32x32x16_bf16 v[128:143], a[128:131], a[160:163], v[128:143]
  s_add_u32 m0, s48, s51
  s_mov_b32 s48, s47
  s_add_u32 s47, s47, 16384
  s_cmp_ge_u32 s47, 98304
  s_cselect_b32 s47, 0, s47
  v_add_u32 v5, s47, v4
  v_xor_b32 v7, 32, v6
  v_mfma_f32_32x32x16_bf16 v[144:159], a[128:131], a[164:167], v[144:159]
  s_waitcnt vmcnt(12)
  ds_read_b64_tr_b16 a[144:145], v5 offset:0
  ds_read_b64_tr_b16 a[146:147], v5 offset:512
  v_mfma_f32_32x32x16_bf16 v[160:175], a[132:135], a[160:163], v[160:175]
  ds_read_b128 a[168:171], v7
  ds_read_b128 a[172:175], v7 offset:8192
  v_mfma_f32_32x32x16_bf16 v[176:191], a[132:135], a[164:167], v[176:191]
  ds_read_b64_tr_b16 a[148:149], v5 offset:256
  ds_read_b64_tr_b16 a[150:151], v5 offset:768
  buffer_load_dwordx4 v8, s[20:23], s52 offen lds
  s_add_u32 m0, m0, 1024
  s_waitcnt lgkmcnt(6)
  v_mfma_f32_32x32x16_bf16 v[192:207], a[136:139], a[160:163], v[192:207]
  ds_read_b64_tr_b16 a[152:153], v5 offset:2048
  ds_read_b64_tr_b16 a[154:155], v5 offset:2560
  buffer_load_dwordx4 v9, s[20:23], s52 offen lds
  s_add_u32 m0, m0, 896
  v_mfma_f32_32x32x16_bf16 v[208:223], a[136:139], a[164:167], v[208:223]
  ds_read_b64_tr_b16 a[156:157], v5 offset:2304
  ds_read_b64_tr_b16 a[158:159], v5 offset:2816
  v_mfma_f32_32x32x16_bf16 v[224:239], a[140:143], a[160:163], v[224:239]
  buffer_load_dwordx4 v8, s[20:23], s52 offen offset:128 lds
  s_add_u32 m0, m0, 1024
  v_mfma_f32_32x32x16_bf16 v[240:255], a[140:143], a[164:167], v[240:255]
  buffer_load_dwordx4 v9, s[20:23], s52 offen offset:128 lds
  s_add_u32 s52, s52, 131072
k2_p1e:
  s_waitcnt lgkmcnt(4)
  v_mfma_f32_32x32x16_bf16 v[128:143], a[144:147], a[168:171], v[128:143]
  s_add_u32 m0, s48, s51
  s_mov_b32 s48, s47
  s_add_u32 s47, s47, 16384
  s_cmp_ge_u32 s47, 98304
  s_cselect_b32 s47, 0, s47
  v_add_u32 v5, s47, v4
  v_xor_b32 v7, 64, v6
  v_mfma_f32_32x32x16_bf16 v[144:159], a[144:147], a[172:175], v[144:159]
  s_waitcnt vmcnt(12)
  ds_read_b64_tr_b16 a[128:129], v5 offset:0
  ds_read_b64_tr_b16 a[130:131], v5 offset:512
  v_mfma_f32_32x32x16_bf16 v[160:175], a[148:151], a[168:171], v[160:175]
  ds_read_b128 a[160:163], v7
  ds_read_b128 a[164:167], v7 offset:8192
  v_mfma_f32_32x32x16_bf16 v[176:191], a[148:151], a[172:175], v[176:191]
  ds_read_b64_tr_b16 a[132:133], v5 offset:256
  ds_read_b64_tr_b16 a[134:135], v5 offset:768
  buffer_load_dwordx4 v8, s[20:23], s52 offen lds
  s_add_u32 m0, m0, 1024
  s_waitcnt lgkmcnt(6)
  v_mfma_f32_32x32x16_bf16 v[192:207], a[152:155], a[168:171], v[192:207]
  ds_read_b64_tr_b16 a[136:137], v5 offset:2048
  ds_read_b64_tr_b16 a[138:139], v5 offset:2560
  buffer_load_dwordx4 v9, s[20:23], s52 offen lds
  s_add_u32 m0, m0, 896
  v_mfma_f32_32x32x16_bf16 v[208:223], a[152:155], a[172:175], v[208:223]
  ds_read_b64_tr_b16 a[140:141], v5 offset:2304
  ds_read_b64_tr_b16 a[142:143], v5 offset:2816
  v_mfma_f32_32x32x16_bf16 v[224:239], a[156:159], a[168:171], v[224:239]
  buffer_load_dwordx4 v8, s[20:23], s52 offen offset:128 lds
  s_add_u32 m0, m0, 1024
  v_mfma_f32_32x32x16_bf16 v[240:255], a[156:159], a[172:175], v[240:255]
  buffer_load_dwordx4 v9, s[20:23], s52 offen offset:128 lds
  s_add_u32 s52, s52, 131072
  s_waitcnt lgkmcnt(4)
  v_mfma_f32_32x32x16_bf16 v[128:143], a[128:131], a[160:163], v[128:143]
  s_add_u32 m0, s48, s51
  s_mov_b32 s48, s47
  s_add_u32 s47, s47, 16384
  s_cmp_ge_u32 s47, 98304
  s_cselect_b32 s47, 0, s47
  v_add_u32 v5, s47, v4
  v_xor_b32 v7, 96, v6
  v_mfma_f32_32x32x16_bf16 v[144:159], a[128:131], a[164:167], v[144:159]
  s_waitcnt vmcnt(12)
  ds_read_b64_tr_b16 a[144:145], v5 offset:0
  ds_read_b64_tr_b16 a[146:147], v5 offset:512
  v_mfma_f32_32x32x16_bf16 v[160:175], a[132:135], a[160:163], v[160:175]
  ds_read_b128 a[168:171], v7
  ds_read_b128 a[172:175], v7 offset:8192
  v_mfma_f32_32x32x16_bf16 v[176:191], a[132:135], a[164:167], v[176:191]
  ds_read_b64_tr_b16 a[148:149], v5 offset:256
  ds_read_b64_tr_b16 a[150:151], v5 offset:768
  buffer_load_dwordx4 v8, s[20:23], s52 offen lds
  s_add_u32 m0, m0, 1024
  s_waitcnt lgkmcnt(6)
  v_mfma_f32_32x32x16_bf16 v[192:207], a[136:139], a[160:163], v[192:207]
  ds_read_b64_tr_b16 a[152:153], v5 offset:2048
  ds_read_b64_tr_b16 a[154:155], v5 offset:2560
  buffer_load_dwordx4 v9, s[20:23], s52 offen lds
  s_add_u32 m0, m0, 896
  v_mfma_f32_32x32x16_bf16 v[208:223], a[136:139], a[164:167], v[208:223]
  ds_read_b64_tr_b16 a[156:157], v5 offset:2304
  ds_read_b64_tr_b16 a[158:159], v5 offset:2816
  v_mfma_f32_32x32x16_bf16 v[224:239], a[140:143], a[160:163], v[224:239]
  buffer_load_dwordx4 v8, s[20:23], s52 offen offset:128 lds
  s_add_u32 m0, m0, 1024
  v_mfma_f32_32x32x16_bf16 v[240:255], a[140:143], a[164:167], v[240:255]
  buffer_load_dwordx4 v9, s[20:23], s52 offen offset:128 lds
  s_add_u32 s52, s52, 131072
  s_waitcnt lgkmcnt(4)
  v_mfma_f32_32x32x16_bf16 v[128:143], a[144:147], a[168:171], v[128:143]
  s_add_u32 m0, s48, s51
  s_mov_b32 s48, s47
  s_add_u32 s47, s47, 16384
  s_cmp_ge_u32 s47, 98304
  s_cselect_b32 s47, 0, s47
  v_add_u32 v5, s47, v4
  v_xor_b32 v7, 128, v6
  v_mfma_f32_32x32x16_bf16 v[144:159], a[144:147], a[172:175], v[144:159]
  s_waitcnt vmcnt(12)
  ds_read_b64_tr_b16 a[128:129], v5 offset:0
  ds_read_b64_tr_b16 a[130:131], v5 offset:512
  v_mfma_f32_32x32x16_bf16 v[160:175], a[148:151], a[168:171], v[160:175]
  ds_read_b128 a[160:163], v7
  ds_read_b128 a[164:167], v7 offset:8192
  v_mfma_f32_32x32x16_bf16 v[176:191], a[148:151], a[172:175], v[176:191]
  ds_read_b64_tr_b16 a[132:133], v5 offset:256
  ds_read_b64_tr_b16 a[134:135], v5 offset:768
  buffer_load_dwordx4 v8, s[20:23], s52 offen lds
  s_add_u32 m0, m0, 1024
  s_waitcnt lgkmcnt(6)
  v_mfma_f32_32x32x16_bf16 v[192:207], a[152:155], a[168:171], v[192:207]
  ds_read_b64_tr_b16 a[136:137], v5 offset:2048
  ds_read_b64_tr_b16 a[138:139], v5 offset:2560
  buffer_load_dwordx4 v9, s[20:23], s52 offen lds
  s_add_u32 m0, m0, 896
  v_mfma_f32_32x32x16_bf16 v[208:223], a[152:155], a[172:175], v[208:223]
  ds_read_b64_tr_b16 a[140:141], v5 offset:2304
  ds_read_b64_tr_b16 a[142:143], v5 offset:2816
  v_mfma_f32_32x32x16_bf16 v[224:239], a[156:159], a[168:171], v[224:239]
  buffer_load_dwordx4 v8, s[20:23], s52 offen offset:128 lds
  s_add_u32 m0, m0, 1024
  v_mfma_f32_32x32x16_bf16 v[240:255], a[156:159], a[172:175], v[240:255]
  buffer_load_dwordx4 v9, s[20:23], s52 offen offset:128 lds
  s_add_u32 s52, s52, 131072
  s_waitcnt lgkmcnt(4)
  v_mfma_f32_32x32x16_bf16 v[128:143], a[128:131], a[160:163], v[128:143]
  s_add_u32 m0, s48, s51
  s_mov_b32 s48, s47
  s_add_u32 s47, s47, 16384
  s_cmp_ge_u32 s47, 98304
  s_cselect_b32 s47, 0, s47
  v_add_u32 v5, s47, v4
  v_xor_b32 v7, 160, v6
  v_mfma_f32_32x32x16_bf16 v[144:159], a[128:131], a[164:167], v[144:159]
  s_waitcnt vmcnt(12)
  ds_read_b64_tr_b16 a[144:145], v5 offset:0
  ds_read_b64_tr_b16 a[146:147], v5 offset:512
  v_mfma_f32_32x32x16_bf16 v[160:175], a[132:135], a[160:163], v[160:175]
  ds_read_b128 a[168:171], v7
  ds_read_b128 a[172:175], v7 offset:8192
  v_mfma_f32_32x32x16_bf16 v[176:191], a[132:135], a[164:167], v[176:191]
  ds_read_b64_tr_b16 a[148:149], v5 offset:256
  ds_read_b64_tr_b16 a[150:151], v5 offset:768
  buffer_load_dwordx4 v8, s[20:23], s52 offen lds
  s_add_u32 m0, m0, 1024
  s_waitcnt lgkmcnt(6)
  v_mfma_f32_32x32x16_bf16 v[192:207], a[136:139], a[160:163], v[192:207]
  ds_read_b64_tr_b16 a[152:153], v5 offset:2048
  ds_read_b64_tr_b16 a[154:155], v5 offset:2560
  buffer_load_dwordx4 v9, s[20:23], s52 offen lds
  s_add_u32 m0, m0, 896
  v_mfma_f32_32x32x16_bf16 v[208:223], a[136:139], a[164:167], v[208:223]
  ds_read_b64_tr_b16 a[156:157], v5 offset:2304
  ds_read_b64_tr_b16 a[158:159], v5 offset:2816
  v_mfma_f32_32x32x16_bf16 v[224:239], a[140:143], a[160:163], v[224:239]
  buffer_load_dwordx4 v8, s[20:23], s52 offen offset:128 lds
  s_add_u32 m0, m0, 1024
  v_mfma_f32_32x32x16_bf16 v[240:255], a[140:143], a[164:167], v[240:255]
  buffer_load_dwordx4 v9, s[20:23], s52 offen offset:128 lds
  s_add_u32 s52, s52, 131072
  s_waitcnt lgkmcnt(4)
  v_mfma_f32_32x32x16_bf16 v[128:143], a[144:147], a[168:171], v[128:143]
  s_add_u32 m0, s48, s51
  s_mov_b32 s48, s47
  s_add_u32 s47, s47, 16384
  s_cmp_ge_u32 s47, 98304
  s_cselect_b32 s47, 0, s47
  v_add_u32 v5, s47, v4
  v_xor_b32 v7, 192, v6
  v_mfma_f32_32x32x16_bf16 v[144:159], a[144:147], a[172:175], v[144:159]
  s_waitcnt vmcnt(12)
  ds_read_b64_tr_b16 a[128:129], v5 offset:0
  ds_read_b64_tr_b16 a[130:131], v5 offset:512
  v_mfma_f32_32x32x16_bf16 v[160:175], a[148:151], a[168:171], v[160:175]
  ds_read_b128 a[160:163], v7
  ds_read_b128 a[164:167], v7 offset:8192
  v_mfma_f32_32x32x16_bf16 v[176:191], a[148:151], a[172:175], v[176:191]
  ds_read_b64_tr_b16 a[132:133], v5 offset:256
  ds_read_b64_tr_b16 a[134:135], v5 offset:768
  buffer_load_dwordx4 v8, s[20:23], s52 offen lds
  s_add_u32 m0, m0, 1024
  s_waitcnt lgkmcnt(6)
  v_mfma_f32_32x32x16_bf16 v[192:207], a[152:155], a[168:171], v[192:207]
  ds_read_b64_tr_b16 a[136:137], v5 offset:2048
  ds_read_b64_tr_b16 a[138:139], v5 offset:2560
  buffer_load_dwordx4 v9, s[20:23], s52 offen lds
  s_add_u32 m0, m0, 896
  v_mfma_f32_32x32x16_bf16 v[208:223], a[152:155], a[172:175], v[208:223]
  ds_read_b64_tr_b16 a[140:141], v5 offset:2304
  ds_read_b64_tr_b16 a[142:143], v5 offset:2816
  v_mfma_f32_32x32x16_bf16 v[224:239], a[156:159], a[168:171], v[224:239]
  buffer_load_dwordx4 v8, s[20:23], s52 offen offset:128 lds
  s_add_u32 m0, m0, 1024
  v_mfma_f32_32x32x16_bf16 v[240:255], a[156:159], a[172:175], v[240:255]
  buffer_load_dwordx4 v9, s[20:23], s52 offen offset:128 lds
  s_add_u32 s52, s52, 131072
  s_waitcnt lgkmcnt(4)
  v_mfma_f32_32x32x16_bf16 v[128:143], a[128:131], a[160:163], v[128:143]
  s_add_u32 m0, s48, s51
  s_mov_b32 s48, s47
  s_add_u32 s47, s47, 16384
  s_cmp_ge_u32 s47, 98304
  s_cselect_b32 s47, 0, s47
  v_add_u32 v5, s47, v4
  v_xor_b32 v7, 224, v6
  v_mfma_f32_32x32x16_bf16 v[144:159], a[128:131], a[164:167], v[144:159]
  s_waitcnt vmcnt(12)
  ds_read_b64_tr_b16 a[144:145], v5 offset:0
  ds_read_b64_tr_b16 a[146:147], v5 offset:512
  v_mfma_f32_32x32x16_bf16 v[160:175], a[132:135], a[160:163], v[160:175]
  ds_read_b128 a[168:171], v7
  ds_read_b128 a[172:175], v7 offset:8192
  v_mfma_f32_32x32x16_bf16 v[176:191], a[132:135], a[164:167], v[176:191]
  ds_read_b64_tr_b16 a[148:149], v5 offset:256
  ds_read_b64_tr_b16 a[150:151], v5 offset:768
  buffer_load_dwordx4 v8, s[20:23], s52 offen lds
  s_add_u32 m0, m0, 1024
  s_waitcnt lgkmcnt(6)
  v_mfma_f32_32x32x16_bf16 v[192:207], a[136:139], a[160:163], v[192:207]
  ds_read_b64_tr_b16 a[152:153], v5 offset:2048
  ds_read_b64_tr_b16 a[154:155], v5 offset:2560
  buffer_load_dwordx4 v9, s[20:23], s52 offen lds
  s_add_u32 m0, m0, 896
  v_mfma_f32_32x32x16_bf16 v[208:223], a[136:139], a[164:167], v[208:223]
  ds_read_b64_tr_b16 a[156:157], v5 offset:2304
  ds_read_b64_tr_b16 a[158:159], v5 offset:2816
  v_mfma_f32_32x32x16_bf16 v[224:239], a[140:143], a[160:163], v[224:239]
  buffer_load_dwordx4 v8, s[20:23], s52 offen offset:128 lds
  s_add_u32 m0, m0, 1024
  v_mfma_f32_32x32x16_bf16 v[240:255], a[140:143], a[164:167], v[240:255]
  buffer_load_dwordx4 v9, s[20:23], s52 offen offset:128 lds
  s_add_u32 s52, s52, 131072
  s_waitcnt lgkmcnt(4)
  v_mfma_f32_32x32x16_bf16 v[128:143], a[144:147], a[168:171], v[128:143]
  s_add_u32 m0, s48, s51
  s_mov_b32 s48, s47
  s_add_u32 s47, s47, 16384
  s_cmp_ge_u32 s47, 98304
  s_cselect_b32 s47, 0, s47
  v_add_u32 v5, s47, v4
  v_add_u32 v6, 16384, v6
  v_mfma_f32_32x32x16_bf16 v[144:159], a[144:147], a[172:175], v[144:159]
  s_waitcnt vmcnt(12)
  ds_read_b64_tr_b16 a[128:129], v5 offset:0
  ds_read_b64_tr_b16 a[130:131], v5 offset:512
  v_mfma_f32_32x32x16_bf16 v[160:175], a[148:151], a[168:171], v[160:175]
  ds_read_b128 a[160:163], v6
  ds_read_b128 a[164:167], v6 offset:8192
  v_mfma_f32_32x32x16_bf16 v[176:191], a[148:151], a[172:175], v[176:191]
  ds_read_b64_tr_b16 a[132:133], v5 offset:256
  ds_read_b64_tr_b16 a[134:135], v5 offset:768
  buffer_load_dwordx4 v8, s[20:23], s52 offen lds
  s_add_u32 m0, m0, 1024
  s_waitcnt lgkmcnt(6)
  v_mfma_f32_32x32x16_bf16 v[192:207], a[152:155], a[168:171], v[192:207]
  ds_read_b64_tr_b16 a[136:137], v5 offset:2048
  ds_read_b64_tr_b16 a[138:139], v5 offset:2560
  buffer_load_dwordx4 v9, s[20:23], s52 offen lds
  s_add_u32 m0, m0, 896
  v_mfma_f32_32x32x16_bf16 v[208:223], a[152:155], a[172:175], v[208:223]
  ds_read_b64_tr_b16 a[140:141], v5 offset:2304
  ds_read_b64_tr_b16 a[142:143], v5 offset:2816
  v_mfma_f32_32x32x16_bf16 v[224:239], a[156:159], a[168:171], v[224:239]
  buffer_load_dwordx4 v8, s[20:23], s52 offen offset:128 lds
  s_add_u32 m0, m0, 1024
  s_add_u32 s55, s55, 1
  v_mfma_f32_32x32x16_bf16 v[240:255], a[156:159], a[172:175], v[240:255]
  buffer_load_dwordx4 v9, s[20:23], s52 offen offset:128 lds
  s_add_u32 s52, s52, 131072
  s_cmp_lt_u32 s55, 3
  s_cbranch_scc1 k2_p1
  s_waitcnt lgkmcnt(4)
  v_mfma_f32_32x32x16_bf16 v[128:143], a[128:131], a[160:163], v[128:143]
  s_add_u32 m0, s48, s51
  s_mov_b32 s48, s47
  s_add_u32 s47, s47, 16384
  s_cmp_ge_u32 s47, 98304
  s_cselect_b32 s47, 0, s47
  v_add_u32 v5, s47, v4
  v_xor_b32 v7, 32, v6
  v_mfma_f32_32x32x16_bf16 v[144:159], a[128:131], a[164:167], v[144:159]
  s_waitcnt vmcnt(12)
  ds_read_b64_tr_b16 a[144:145], v5 offset:0
  ds_read_b64_tr_b16 a[146:147], v5 offset:512
  v_mfma_f32_32x32x16_bf16 v[160:175], a[132:135], a[160:163], v[160:175]
  ds_read_b128 a[168:171], v7
  ds_read_b128 a[172:175], v7 offset:8192
  v_mfma_f32_32x32x16_bf16 v[176:191], a[132:135], a[164:167], v[176:191]
  ds_read_b64_tr_b16 a[148:149], v5 offset:256
  ds_read_b64_tr_b16 a[150:151], v5 offset:768
  buffer_load_dwordx4 v8, s[20:23], s52 offen lds
  s_add_u32 m0, m0, 1024
  s_waitcnt lgkmcnt(6)
  v_mfma_f32_32x32x16_bf16 v[192:207], a[136:139], a[160:163], v[192:207]
  ds_read_b64_tr_b16 a[152:153], v5 offset:2048
  ds_read_b64_tr_b16 a[154:155], v5 offset:2560
  buffer_load_dwordx4 v9, s[20:23], s52 offen lds
  s_add_u32 m0, m0, 896
  v_mfma_f32_32x32x16_bf16 v[208:223], a[136:139], a[164:167], v[208:223]
  ds_read_b64_tr_b16 a[156:157], v5 offset:2304
  ds_read_b64_tr_b16 a[158:159], v5 offset:2816
  v_mfma_f32_32x32x16_bf16 v[224:239], a[140:143], a[160:163], v[224:239]
  buffer_load_dwordx4 v8, s[20:23], s52 offen offset:128 lds
  s_add_u32 m0, m0, 1024
  v_mfma_f32_32x32x16_bf16 v[240:255], a[140:143], a[164:167], v[240:255]
  buffer_load_dwordx4 v9, s[20:23], s52 offen offset:128 lds
  s_add_u32 s52, s52, 131072
  s_waitcnt lgkmcnt(4)
  v_mfma_f32_32x32x16_bf16 v[128:143], a[144:147], a[168:171], v[128:143]
  s_add_u32 m0, s48, s51
  s_mov_b32 s48, s47
  s_add_u32 s47, s47, 16384
  s_cmp_ge_u32 s47, 98304
  s_cselect_b32 s47, 0, s47
  v_add_u32 v5, s47, v4
  v_xor_b32 v7, 64, v6
  v_mfma_f32_32x32x16_bf16 v[144:159], a[144:147], a[172:175], v[144:159]
  s_waitcnt vmcnt(12)
  ds_read_b64_tr_b16 a[128:129], v5 offset:0
  ds_read_b64_tr_b16 a[130:131], v5 offset:512
  v_mfma_f32_32x32x16_bf16 v[160:175], a[148:151], a[168:171], v[160:175]
  ds_read_b128 a[160:163], v7
  ds_read_b128 a[164:167], v7 offset:8192
  v_mfma_f32_32x32x16_bf16 v[176:191], a[148:151], a[172:175], v[176:191]
  ds_read_b64_tr_b16 a[132:133], v5 offset:256
  ds_read_b64_tr_b16 a[134:135], v5 offset:768
  buffer_load_dwordx4 v8, s[20:23], s52 offen lds
  s_add_u32 m0, m0, 1024
  s_waitcnt lgkmcnt(6)
  v_mfma_f32_32x32x16_bf16 v[192:207], a[152:155], a[168:171], v[192:207]
  ds_read_b64_tr_b16 a[136:137], v5 offset:2048
  ds_read_b64_tr_b16 a[138:139], v5 offset:2560
  buffer_load_dwordx4 v9, s[20:23], s52 offen lds
  s_add_u32 m0, m0, 896
  v_mfma_f32_32x32x16_bf16 v[208:223], a[152:155], a[172:175], v[208:223]
  ds_read_b64_tr_b16 a[140:141], v5 offset:2304
  ds_read_b64_tr_b16 a[142:143], v5 offset:2816
  v_mfma_f32_32x32x16_bf16 v[224:239], a[156:159], a[168:171], v[224:239]
  buffer_load_dwordx4 v8, s[20:23], s52 offen offset:128 lds
  s_add_u32 m0, m0, 1024
  v_mfma_f32_32x32x16_bf16 v[240:255], a[156:159], a[172:175], v[240:255]
  buffer_load_dwordx4 v9, s[20:23], s52 offen offset:128 lds
  s_add_u32 s52, s52, 131072
  s_waitcnt lgkmcnt(4)
  v_mfma_f32_32x32x16_bf16 v[128:143], a[128:131], a[160:163], v[128:143]
  s_add_u32 m0, s48, s51
  s_mov_b32 s48, s47
  s_add_u32 s47, s47, 16384
  s_cmp_ge_u32 s47, 98304
  s_cselect_b32 s47, 0, s47
  v_add_u32 v5, s47, v4
  v_xor_b32 v7, 96, v6
  v_mfma_f32_32x32x16_bf16 v[144:159], a[128:131], a[164:167], v[144:159]
  s_waitcnt vmcnt(12)
  ds_read_b64_tr_b16 a[144:145], v5 offset:0
  ds_read_b64_tr_b16 a[146:147], v5 offset:512
  v_mfma_f32_32x32x16_bf16 v[160:175], a[132:135], a[160:163], v[160:175]
  ds_read_b128 a[168:171], v7
  ds_read_b128 a[172:175], v7 offset:8192
  v_mfma_f32_32x32x16_bf16 v[176:191], a[132:135], a[164:167], v[176:191]
  ds_read_b64_tr_b16 a[148:149], v5 offset:256
  ds_read_b64_tr_b16 a[150:151], v5 offset:768
  buffer_load_dwordx4 v8, s[20:23], s52 offen lds
  s_add_u32 m0, m0, 1024
  s_waitcnt lgkmcnt(6)
  v_mfma_f32_32x32x16_bf16 v[192:207], a[136:139], a[160:163], v[192:207]
  ds_read_b64_tr_b16 a[152:153], v5 offset:2048
  ds_read_b64_tr_b16 a[154:155], v5 offset:2560
  buffer_load_dwordx4 v9, s[20:23], s52 offen lds
  s_add_u32 m0, m0, 896
  v_mfma_f32_32x32x16_bf16 v[208:223], a[136:139], a[164:167], v[208:223]
  ds_read_b64_tr_b16 a[156:157], v5 offset:2304
  ds_read_b64_tr_b16 a[158:159], v5 offset:2816
  v_mfma_f32_32x32x16_bf16 v[224:239], a[140:143], a[160:163], v[224:239]
  buffer_load_dwordx4 v8, s[20:23], s52 offen offset:128 lds
  s_add_u32 m0, m0, 1024
  v_mfma_f32_32x32x16_bf16 v[240:255], a[140:143], a[164:167], v[240:255]
  buffer_load_dwordx4 v9, s[20:23], s52 offen offset:128 lds
  s_add_u32 s52, s52, 131072
  s_waitcnt lgkmcnt(4)
  v_mfma_f32_32x32x16_bf16 v[128:143], a[144:147], a[168:171], v[128:143]
  s_add_u32 m0, s48, s51
  s_mov_b32 s48, s47
  s_add_u32 s47, s47, 16384
  s_cmp_ge_u32 s47, 98304
  s_cselect_b32 s47, 0, s47
  v_add_u32 v5, s47, v4
  v_xor_b32 v7, 128, v6
  v_mfma_f32_32x32x16_bf16 v[144:159], a[144:147], a[172:175], v[144:159]
  s_waitcnt vmcnt(12)
  ds_read_b64_tr_b16 a[128:129], v5 offset:0
  ds_read_b64_tr_b16 a[130:131], v5 offset:512
  v_mfma_f32_32x32x16_bf16 v[160:175], a[148:151], a[168:171], v[160:175]
  ds_read_b128 a[160:163], v7
  ds_read_b128 a[164:167], v7 offset:8192
  v_mfma_f32_32x32x16_bf16 v[176:191], a[148:151], a[172:175], v[176:191]
  ds_read_b64_tr_b16 a[132:133], v5 offset:256
  ds_read_b64_tr_b16 a[134:135], v5 offset:768
  buffer_load_dwordx4 v12, s[24:27], s54 offen lds
  s_add_u32 m0, m0, 1024
  s_waitcnt lgkmcnt(6)
  v_mfma_f32_32x32x16_bf16 v[192:207], a[152:155], a[168:171], v[192:207]
  ds_read_b64_tr_b16 a[136:137], v5 offset:2048
  ds_read_b64_tr_b16 a[138:139], v5 offset:2560
  s_add_u32 s61, s54, 4096
  buffer_load_dwordx4 v12, s[24:27], s61 offen lds
  s_add_u32 m0, m0, 1024
  v_mfma_f32_32x32x16_bf16 v[208:223], a[152:155], a[172:175], v[208:223]
  ds_read_b64_tr_b16 a[140:141], v5 offset:2304
  ds_read_b64_tr_b16 a[142:143], v5 offset:2816
  v_mfma_f32_32x32x16_bf16 v[224:239], a[156:159], a[168:171], v[224:239]
  buffer_load_dwordx4 v13, s[28:31], s54 offen lds
  s_add_u32 m0, m0, 1024
  v_mfma_f32_32x32x16_bf16 v[240:255], a[156:159], a[172:175], v[240:255]
  buffer_load_dwordx4 v14, s[28:31], s54 offen lds
  s_add_u32 s54, s54, 8192
  s_waitcnt lgkmcnt(4)
  v_mfma_f32_32x32x16_bf16 v[128:143], a[128:131], a[160:163], v[128:143]
  s_add_u32 m0, s48, s51
  s_mov_b32 s48, s47
  s_add_u32 s47, s47, 16384
  s_cmp_ge_u32 s47, 98304
  s_cselect_b32 s47, 0, s47
  v_add_u32 v5, s47, v4
  v_xor_b32 v7, 160, v6
  v_mfma_f32_32x32x16_bf16 v[144:159], a[128:131], a[164:167], v[144:159]
  s_waitcnt vmcnt(12)
  ds_read_b64_tr_b16 a[144:145], v5 offset:0
  ds_read_b64_tr_b16 a[146:147], v5 offset:512
  v_mfma_f32_32x32x16_bf16 v[160:175], a[132:135], a[160:163], v[160:175]
  ds_read_b128 a[168:171], v7
  ds_read_b128 a[172:175], v7 offset:8192
  v_mfma_f32_32x32x16_bf16 v[176:191], a[132:135], a[164:167], v[176:191]
  ds_read_b64_tr_b16 a[148:149], v5 offset:256
  ds_read_b64_tr_b16 a[150:151], v5 offset:768
  buffer_load_dwordx4 v12, s[24:27], s54 offen lds
  s_add_u32 m0, m0, 1024
  s_waitcnt lgkmcnt(6)
  v_mfma_f32_32x32x16_bf16 v[192:207], a[136:139], a[160:163], v[192:207]
  ds_read_b64_tr_b16 a[152:153], v5 offset:2048
  ds_read_b64_tr_b16 a[154:155], v5 offset:2560
  s_add_u32 s61, s54, 4096
  buffer_load_dwordx4 v12, s[24:27], s61 offen lds
  s_add_u32 m0, m0, 1024
  v_mfma_f32_32x32x16_bf16 v[208:223], a[136:139], a[164:167], v[208:223]
  ds_read_b64_tr_b16 a[156:157], v5 offset:2304
  ds_read_b64_tr_b16 a[158:159], v5 offset:2816
  v_mfma_f32_32x32x16_bf16 v[224:239], a[140:143], a[160:163], v[224:239]
  buffer_load_dwordx4 v13, s[28:31], s54 offen lds
  s_add_u32 m0, m0, 1024
  v_mfma_f32_32x32x16_bf16 v[240:255], a[140:143], a[164:167], v[240:255]
  buffer_load_dwordx4 v14, s[28:31], s54 offen lds
  s_add_u32 s54, s54, 8192
  s_waitcnt lgkmcnt(4)
  v_mfma_f32_32x32x16_bf16 v[128:143], a[144:147], a[168:171], v[128:143]
  s_add_u32 m0, s48, s51
  s_mov_b32 s48, s47
  s_add_u32 s47, s47, 16384
  s_cmp_ge_u32 s47, 98304
  s_cselect_b32 s47, 0, s47
  v_add_u32 v5, s47, v4
  v_xor_b32 v7, 192, v6
  v_mfma_f32_32x32x16_bf16 v[144:159], a[144:147], a[172:175], v[144:159]
  s_waitcnt vmcnt(12)
  ds_read_b64_tr_b16 a[128:129], v5 offset:0
  ds_read_b64_tr_b16 a[130:131], v5 offset:512
  v_mfma_f32_32x32x16_bf16 v[160:175], a[148:151], a[168:171], v[160:175]
  ds_read_b128 a[160:163], v7
  ds_read_b128 a[164:167], v7 offset:8192
  v_mfma_f32_32x32x16_bf16 v[176:191], a[148:151], a[172:175], v[176:191]
  ds_read_b64_tr_b16 a[132:133], v5 offset:256
  ds_read_b64_tr_b16 a[134:135], v5 offset:768
  buffer_load_dwordx4 v12, s[24:27], s54 offen lds
  s_add_u32 m0, m0, 1024
  s_waitcnt lgkmcnt(6)
  v_mfma_f32_32x32x16_bf16 v[192:207], a[152:155], a[168:171], v[192:207]
  ds_read_b64_tr_b16 a[136:137], v5 offset:2048
  ds_read_b64_tr_b16 a[138:139], v5 offset:2560
  s_add_u32 s61, s54, 4096
  buffer_load_dwordx4 v12, s[24:27], s61 offen lds
  s_add_u32 m0, m0, 1024
  v_mfma_f32_32x32x16_bf16 v[208:223], a[152:155], a[172:175], v[208:223]
  ds_read_b64_tr_b16 a[140:141], v5 offset:2304
  ds_read_b64_tr_b16 a[142:143], v5 offset:2816
  v_mfma_f32_32x32x16_bf16 v[224:239], a[156:159], a[168:171], v[224:239]
  buffer_load_dwordx4 v13, s[28:31], s54 offen lds
  s_add_u32 m0, m0, 1024
  v_mfma_f32_32x32x16_bf16 v[240:255], a[156:159], a[172:175], v[240:255]
  buffer_load_dwordx4 v14, s[28:31], s54 offen lds
  s_add_u32 s54, s54, 8192
  s_waitcnt lgkmcnt(4)
  v_mfma_f32_32x32x16_bf16 v[128:143], a[128:131], a[160:163], v[128:143]
  s_add_u32 m0, s48, s51
  s_mov_b32 s48, s47
  s_add_u32 s47, s47, 16384
  s_cmp_ge_u32 s47, 98304
  s_cselect_b32 s47, 0, s47
  v_add_u32 v5, s47, v4
  v_xor_b32 v7, 224, v6
  v_mfma_f32_32x32x16_bf16 v[144:159], a[128:131], a[164:167], v[144:159]
  s_waitcnt vmcnt(12)
  ds_read_b64_tr_b16 a[144:145], v5 offset:0
  ds_read_b64_tr_b16 a[146:147], v5 offset:512
  v_mfma_f32_32x32x16_bf16 v[160:175], a[132:135], a[160:163], v[160:175]
  ds_read_b128 a[168:171], v7
  ds_read_b128 a[172:175], v7 offset:8192
  v_mfma_f32_32x32x16_bf16 v[176:191], a[132:135], a[164:167], v[176:191]
  ds_read_b64_tr_b16 a[148:149], v5 offset:256
  ds_read_b64_tr_b16 a[150:151], v5 offset:768
  buffer_load_dwordx4 v12, s[24:27], s54 offen lds
  s_add_u32 m0, m0, 1024
  s_waitcnt lgkmcnt(6)
  v_mfma_f32_32x32x16_bf16 v[192:207], a[136:139], a[160:163], v[192:207]
  ds_read_b64_tr_b16 a[152:153], v5 offset:2048
  ds_read_b64_tr_b16 a[154:155], v5 offset:2560
  s_add_u32 s61, s54, 4096
  buffer_load_dwordx4 v12, s[24:27], s61 offen lds
  s_add_u32 m0, m0, 1024
  v_mfma_f32_32x32x16_bf16 v[208:223], a[136:139], a[164:167], v[208:223]
  ds_read_b64_tr_b16 a[156:157], v5 offset:2304
  ds_read_b64_tr_b16 a[158:159], v5 offset:2816
  v_mfma_f32_32x32x16_bf16 v[224:239], a[140:143], a[160:163], v[224:239]
  buffer_load_dwordx4 v13, s[28:31], s54 offen lds
  s_add_u32 m0, m0, 1024
  v_mfma_f32_32x32x16_bf16 v[240:255], a[140:143], a[164:167], v[240:255]
  buffer_load_dwordx4 v14, s[28:31], s54 offen lds
  s_add_u32 s54, s54, 8192
  s_waitcnt lgkmcnt(0)
  v_mfma_f32_32x32x16_bf16 v[128:143], a[144:147], a[168:171], v[128:143]
  s_add_u32 m0, s48, s51
  s_mov_b32 s48, s47
  v_add_u32 v16, 32768, v15
  v_xor_b32 v17, 32, v16
  v_mfma_f32_32x32x16_bf16 v[160:175], a[148:151], a[168:171], v[160:175]
  s_waitcnt vmcnt(8)
  s_barrier
  v_mfma_f32_32x32x16_bf16 v[192:207], a[152:155], a[168:171], v[192:207]
  ds_read_b128 a[64:67], v16 offset:0
  ds_read_b128 a[68:71], v17 offset:0
  ds_read_b128 a[72:75], v16 offset:4096
  v_mfma_f32_32x32x16_bf16 v[224:239], a[156:159], a[168:171], v[224:239]
  buffer_load_dwordx4 v12, s[24:27], s54 offen lds
  s_add_u32 m0, m0, 1024
  ds_read_b128 a[76:79], v17 offset:4096
  ds_read_b128 a[80:83], v16 offset:8192
  v_mfma_f32_32x32x16_bf16 v[144:159], a[144:147], a[172:175], v[144:159]
  s_add_u32 s61, s54, 4096
  buffer_load_dwordx4 v12, s[24:27], s61 offen lds
  s_add_u32 m0, m0, 1024
  ds_read_b128 a[84:87], v17 offset:8192
  ds_read_b128 a[88:91], v16 offset:12288
  ds_read_b128 a[92:95], v17 offset:12288
  v_mfma_f32_32x32x16_bf16 v[176:191], a[148:151], a[172:175], v[176:191]
  v_cvt_pk_bf16_f32 v116, v128, v129
  v_cvt_pk_bf16_f32 v117, v130, v131
  v_cvt_pk_bf16_f32 v118, v132, v133
  v_cvt_pk_bf16_f32 v119, v134, v135
  v_mfma_f32_32x32x16_bf16 v[208:223], a[152:155], a[172:175], v[208:223]
  buffer_load_dwordx4 v13, s[28:31], s54 offen lds
  s_add_u32 m0, m0, 1024
  v_accvgpr_write_b32 a0, v116
  v_accvgpr_write_b32 a1, v117
  v_accvgpr_write_b32 a2, v118
  v_accvgpr_write_b32 a3, v119
  v_mfma_f32_32x32x16_bf16 v[240:255], a[156:159], a[172:175], v[240:255]
  buffer_load_dwordx4 v14, s[28:31], s54 offen lds
  s_add_u32 s54, s54, 8192
  v_cvt_pk_bf16_f32 v120, v136, v137
  v_cvt_pk_bf16_f32 v121, v138, v139
  v_cvt_pk_bf16_f32 v122, v140, v141
  v_cvt_pk_bf16_f32 v123, v142, v143
  v_accvgpr_write_b32 a4, v120
  v_accvgpr_write_b32 a5, v121
  v_accvgpr_write_b32 a6, v122
  v_accvgpr_write_b32 a7, v123
  s_waitcnt lgkmcnt(7)
  v_mfma_f32_32x32x16_bf16 v[32:47], a[64:67], a[0:3], 0
  v_cvt_pk_bf16_f32 v116, v160, v161
  v_cvt_pk_bf16_f32 v117, v162, v163
  v_cvt_pk_bf16_f32 v118, v164, v165
  v_cvt_pk_bf16_f32 v119, v166, v167
  v_accvgpr_write_b32 a8, v116
  v_accvgpr_write_b32 a9, v117
  v_accvgpr_write_b32 a10, v118
  v_accvgpr_write_b32 a11, v119
  s_waitcnt lgkmcnt(6)
  v_mfma_f32_32x32x16_bf16 v[32:47], a[68:71], a[4:7], v[32:47]
  v_cvt_pk_bf16_f32 v120, v168, v169
  v_cvt_pk_bf16_f32 v121, v170, v171
  v_cvt_pk_bf16_f32 v122, v172, v173
  v_cvt_pk_bf16_f32 v123, v174, v175
  v_accvgpr_write_b32 a12, v120
  v_accvgpr_write_b32 a13, v121
  v_accvgpr_write_b32 a14, v122
  v_accvgpr_write_b32 a15, v123
  s_waitcnt lgkmcnt(5)
  v_mfma_f32_32x32x16_bf16 v[32:47], a[72:75], a[8:11], v[32:47]
  v_cvt_pk_bf16_f32 v116, v192, v193
  v_cvt_pk_bf16_f32 v117, v194, v195
  v_cvt_pk_bf16_f32 v118, v196, v197
  v_cvt_pk_bf16_f32 v119, v198, v199
  v_accvgpr_write_b32 a16, v116
  v_accvgpr_write_b32 a17, v117
  v_accvgpr_write_b32 a18, v118
  v_accvgpr_write_b32 a19, v119
  s_waitcnt lgkmcnt(4)
  v_mfma_f32_32x32x16_bf16 v[32:47], a[76:79], a[12:15], v[32:47]
  v_cvt_pk_bf16_f32 v120, v200, v201
  v_cvt_pk_bf16_f32 v121, v202, v203
  v_cvt_pk_bf16_f32 v122, v204, v205
  v_cvt_pk_bf16_f32 v123, v206, v207
  v_accvgpr_write_b32 a20, v120
  v_accvgpr_write_b32 a21, v121
  v_accvgpr_write_b32 a22, v122
  v_accvgpr_write_b32 a23, v123
  s_waitcnt lgkmcnt(3)
  v_mfma_f32_32x32x16_bf16 v[32:47], a[80:83], a[16:19], v[32:47]
  v_cvt_pk_bf16_f32 v116, v224, v225
  v_cvt_pk_bf16_f32 v117, v226, v227
  v_cvt_pk_bf16_f32 v118, v228, v229
  v_cvt_pk_bf16_f32 v119, v230, v231
  v_accvgpr_write_b32 a24, v116
  v_accvgpr_write_b32 a25, v117
  v_accvgpr_write_b32 a26, v118
  v_accvgpr_write_b32 a27, v119
  s_waitcnt lgkmcnt(2)
  v_mfma_f32_32x32x16_bf16 v[32:47], a[84:87], a[20:23], v[32:47]
  v_cvt_pk_bf16_f32 v120, v232, v233
  v_cvt_pk_bf16_f32 v121, v234, v235
  v_cvt_pk_bf16_f32 v122, v236, v237
  v_cvt_pk_bf16_f32 v123, v238, v239
  v_accvgpr_write_b32 a28, v120
  v_accvgpr_write_b32 a29, v121
  v_accvgpr_write_b32 a30, v122
  v_accvgpr_write_b32 a31, v123
  s_waitcnt lgkmcnt(1)
  v_mfma_f32_32x32x16_bf16 v[32:47], a[88:91], a[24:27], v[32:47]
  v_cvt_pk_bf16_f32 v116, v144, v145
  v_cvt_pk_bf16_f32 v117, v146, v147
  v_cvt_pk_bf16_f32 v118, v148, v149
  v_cvt_pk_bf16_f32 v119, v150, v151
  v_accvgpr_write_b32 a32, v116
  v_accvgpr_write_b32 a33, v117
  v_accvgpr_write_b32 a34, v118
  v_accvgpr_write_b32 a35, v119
  s_waitcnt lgkmcnt(0)
  v_mfma_f32_32x32x16_bf16 v[32:47], a[92:95], a[28:31], v[32:47]
  v_cvt_pk_bf16_f32 v120, v152, v153
  v_cvt_pk_bf16_f32 v121, v154, v155
  v_cvt_pk_bf16_f32 v122, v156, v157
  v_cvt_pk_bf16_f32 v123, v158, v159
  v_accvgpr_write_b32 a36, v120
  v_accvgpr_write_b32 a37, v121
  v_accvgpr_write_b32 a38, v122
  v_accvgpr_write_b32 a39, v123
  v_mfma_f32_32x32x16_bf16 v[48:63], a[64:67], a[32:35], 0
  v_cvt_pk_bf16_f32 v116, v176, v177
  v_cvt_pk_bf16_f32 v117, v178, v179
  v_cvt_pk_bf16_f32 v118, v180, v181
  v_cvt_pk_bf16_f32 v119, v182, v183
  v_accvgpr_write_b32 a40, v116
  v_accvgpr_write_b32 a41, v117
  v_accvgpr_write_b32 a42, v118
  v_accvgpr_write_b32 a43, v119
  v_mfma_f32_32x32x16_bf16 v[48:63], a[68:71], a[36:39], v[48:63]
  v_cvt_pk_bf16_f32 v120, v184, v185
  v_cvt_pk_bf16_f32 v121, v186, v187
  v_cvt_pk_bf16_f32 v122, v188, v189
  v_cvt_pk_bf16_f32 v123, v190, v191
  v_accvgpr_write_b32 a44, v120
  v_accvgpr_write_b32 a45, v121
  v_accvgpr_write_b32 a46, v122
  v_accvgpr_write_b32 a47, v123
  v_mfma_f32_32x32x16_bf16 v[48:63], a[72:75], a[40:43], v[48:63]
  v_cvt_pk_bf16_f32 v116, v208, v209
  v_cvt_pk_bf16_f32 v117, v210, v211
  v_cvt_pk_bf16_f32 v118, v212, v213
  v_cvt_pk_bf16_f32 v119, v214, v215
  v_accvgpr_write_b32 a48, v116
  v_accvgpr_write_b32 a49, v117
  v_accvgpr_write_b32 a50, v118
  v_accvgpr_write_b32 a51, v119
  v_mfma_f32_32x32x16_bf16 v[48:63], a[76:79], a[44:47], v[48:63]
  v_cvt_pk_bf16_f32 v120, v216, v217
  v_cvt_pk_bf16_f32 v121, v218, v219
  v_cvt_pk_bf16_f32 v122, v220, v221
  v_cvt_pk_bf16_f32 v123, v222, v223
  v_accvgpr_write_b32 a52, v120
  v_accvgpr_write_b32 a53, v121
  v_accvgpr_write_b32 a54, v122
  v_accvgpr_write_b32 a55, v123
  v_mfma_f32_32x32x16_bf16 v[48:63], a[80:83], a[48:51], v[48:63]
  v_cvt_pk_bf16_f32 v116, v240, v241
  v_cvt_pk_bf16_f32 v117, v242, v243
  v_cvt_pk_bf16_f32 v118, v244, v245
  v_cvt_pk_bf16_f32 v119, v246, v247
  v_accvgpr_write_b32 a56, v116
  v_accvgpr_write_b32 a57, v117
  v_accvgpr_write_b32 a58, v118
  v_accvgpr_write_b32 a59, v119
  v_mfma_f32_32x32x16_bf16 v[48:63], a[84:87], a[52:55], v[48:63]
  v_cvt_pk_bf16_f32 v120, v248, v249
  v_cvt_pk_bf16_f32 v121, v250, v251
  v_cvt_pk_bf16_f32 v122, v252, v253
  v_cvt_pk_bf16_f32 v123, v254, v255
  v_accvgpr_write_b32 a60, v120
  v_accvgpr_write_b32 a61, v121
  v_accvgpr_write_b32 a62, v122
  v_accvgpr_write_b32 a63, v123
  v_mfma_f32_32x32x16_bf16 v[48:63], a[88:91], a[56:59], v[48:63]
  s_add_u32 m0, s48, s51
  s_nop 0
  buffer_load_dwordx4 v12, s[24:27], s54 offen lds
  s_add_u32 m0, m0, 1024
  s_add_u32 s61, s54, 4096
  buffer_load_dwordx4 v12, s[24:27], s61 offen lds
  v_mfma_f32_32x32x16_bf16 v[48:63], a[92:95], a[60:63], v[48:63]
  s_add_u32 m0, m0, 1024
  s_nop 0
  buffer_load_dwordx4 v13, s[28:31], s54 offen lds
  s_add_u32 m0, m0, 1024
  s_nop 0
  buffer_load_dwordx4 v14, s[28:31], s54 offen lds
  s_add_u32 s54, s54, 8192
k2_p2:
  v_add_u32 v16, 49152, v15
  v_xor_b32 v17, 32, v16
  ds_read_b128 a[64:67], v16 offset:0
  ds_read_b128 a[68:71], v17 offset:0
  ds_read_b128 a[72:75], v16 offset:4096
  ds_read_b128 a[76:79], v17 offset:4096
  ds_read_b128 a[80:83], v16 offset:8192
  ds_read_b128 a[84:87], v17 offset:8192
  ds_read_b128 a[88:91], v16 offset:12288
  ds_read_b128 a[92:95], v17 offset:12288
  v_max3_f32 v112, v32, v33, v34
  v_max3_f32 v112, v112, v35, v36
  v_max3_f32 v112, v112, v37, v38
  v_max3_f32 v112, v112, v39, v40
  v_max3_f32 v112, v112, v41, v42
  v_max3_f32 v112, v112, v43, v44
  v_max3_f32 v112, v112, v45, v46
  v_max_f32 v112, v112, v47
  v_mov_b32 v113, v112
  s_cmp_eq_u32 s60, 1
  s_cselect_b64 vcc, -1, 0
  v_permlane32_swap_b32 v113, v112
  v_max_f32 v112, v112, v113
  v_add_f32 v112, 0x42d40000, v112
  v_cndmask_b32 v112, v112, v23, vcc
  v_sub_f32 v80, 0, v112
  v_sub_f32 v32, v32, v112
  v_sub_f32 v33, v33, v112
  v_sub_f32 v34, v34, v112
  v_sub_f32 v35, v35, v112
  v_sub_f32 v36, v36, v112
  v_sub_f32 v37, v37, v112
  v_sub_f32 v38, v38, v112
  v_sub_f32 v39, v39, v112
  v_sub_f32 v40, v40, v112
  v_sub_f32 v41, v41, v112
  v_sub_f32 v42, v42, v112
  v_sub_f32 v43, v43, v112
  v_sub_f32 v44, v44, v112
  v_sub_f32 v45, v45, v112
  v_sub_f32 v46, v46, v112
  v_sub_f32 v47, v47, v112
  v_mov_b32 v81, v80
  v_mov_b32 v82, v80
  v_mov_b32 v83, v80
  v_mov_b32 v84, v80
  v_mov_b32 v85, v80
  v_mov_b32 v86, v80
  v_mov_b32 v87, v80
  v_mov_b32 v88, v80
  v_mov_b32 v89, v80
  v_mov_b32 v90, v80
  v_mov_b32 v91, v80
  v_mov_b32 v92, v80
  v_mov_b32 v93, v80
  v_mov_b32 v94, v80
  v_mov_b32 v95, v80
  v_exp_f32 v32, v32
  v_exp_f32 v33, v33
  v_exp_f32 v34, v34
  v_exp_f32 v35, v35
  v_add_f32 v21, v32, v33
  v_cvt_pk_bf16_f32 v64, v32, v33
  v_exp_f32 v36, v36
  v_exp_f32 v37, v37
  v_add_f32 v21, v21, v34
  v_add_f32 v21, v21, v35
  v_cvt_pk_bf16_f32 v65, v34, v35
  v_exp_f32 v38, v38
  v_exp_f32 v39, v39
  v_add_f32 v21, v21, v36
  v_add_f32 v21, v21, v37
  v_cvt_pk_bf16_f32 v66, v36, v37
  v_exp_f32 v40, v40
  v_exp_f32 v41, v41
  v_add_f32 v21, v21, v38
  v_add_f32 v21, v21, v39
  v_cvt_pk_bf16_f32 v67, v38, v39
  v_exp_f32 v42, v42
  v_exp_f32 v43, v43
  v_add_f32 v21, v21, v40
  v_add_f32 v21, v21, v41
  v_cvt_pk_bf16_f32 v68, v40, v41
  v_exp_f32 v44, v44
  v_exp_f32 v45, v45
  v_add_f32 v21, v21, v42
  v_add_f32 v21, v21, v43
  v_cvt_pk_bf16_f32 v69, v42, v43
  v_exp_f32 v46, v46
  v_exp_f32 v47, v47
  v_add_f32 v21, v21, v44
  v_add_f32 v21, v21, v45
  v_cvt_pk_bf16_f32 v70, v44, v45
  v_add_f32 v21, v21, v46
  v_add_f32 v21, v21, v47
  v_cvt_pk_bf16_f32 v71, v46, v47
  v_max3_f32 v114, v48, v49, v50
  v_max3_f32 v114, v114, v51, v52
  v_max3_f32 v114, v114, v53, v54
  v_max3_f32 v114, v114, v55, v56
  v_max3_f32 v114, v114, v57, v58
  v_max3_f32 v114, v114, v59, v60
  v_max3_f32 v114, v114, v61, v62
  v_max_f32 v114, v114, v63
  v_mov_b32 v115, v114
  s_cmp_eq_u32 s60, 1
  s_cselect_b64 vcc, -1, 0
  v_permlane32_swap_b32 v115, v114
  v_max_f32 v114, v114, v115
  v_add_f32 v114, 0x42d40000, v114
  v_cndmask_b32 v114, v114, v24, vcc
  v_sub_f32 v96, 0, v114
  v_sub_f32 v48, v48, v114
  v_sub_f32 v49, v49, v114
  v_sub_f32 v50, v50, v114
  v_sub_f32 v51, v51, v114
  v_sub_f32 v52, v52, v114
  v_sub_f32 v53, v53, v114
  v_sub_f32 v54, v54, v114
  v_sub_f32 v55, v55, v114
  v_sub_f32 v56, v56, v114
  v_sub_f32 v57, v57, v114
  v_sub_f32 v58, v58, v114
  v_sub_f32 v59, v59, v114
  v_sub_f32 v60, v60, v114
  v_sub_f32 v61, v61, v114
  v_sub_f32 v62, v62, v114
  v_sub_f32 v63, v63, v114
  v_mov_b32 v97, v96
  v_mov_b32 v98, v96
  v_mov_b32 v99, v96
  v_mov_b32 v100, v96
  v_mov_b32 v101, v96
  v_mov_b32 v102, v96
  v_mov_b32 v103, v96
  v_mov_b32 v104, v96
  v_mov_b32 v105, v96
  v_mov_b32 v106, v96
  v_mov_b32 v107, v96
  v_mov_b32 v108, v96
  v_mov_b32 v109, v96
  v_mov_b32 v110, v96
  v_mov_b32 v111, v96
  s_mov_b32 s59, 32768
  s_mov_b32 s58, 49152
  s_mov_b32 s57, 65536
  v_add_u32 v19, s59, v18
  v_lshlrev_b32 v2, 6, v1
  s_lshl_b32 s56, s46, 19
  s_and_b32 s61, s45, 15
  s_lshl_b32 s61, s61, 14
  s_add_u32 s56, s56, s61
  s_lshl_b32 s61, s44, 12
  s_add_u32 s56, s56, s61
  buffer_load_dword a200, v2, s[32:35], s56 offen
  s_add_u32 s56, s56, 262144
  buffer_load_dword a201, v2, s[32:35], s56 offen
  s_add_u32 s56, s56, 262144
  s_mov_b32 s80, s100
  s_mov_b32 s81, s101
  s_mov_b32 s82, 0x100
  s_mov_b32 s83, 0x20000
  v_mov_b32 v28, 0
  v_mov_b32 v29, 1
  s_cmp_eq_u32 s44, 0
  s_cselect_b64 s[68:69], 1, 0
  s_and_b32 s70, s45, 7
  s_cmp_eq_u32 s60, 1
  s_cselect_b32 s70, 99, s70
  s_lshl_b32 s71, s44, 14
  v_subrev_u32 v25, s51, v4
  v_add_u32 v25, s71, v25
  s_sub_u32 s71, s71, 2048
  s_sub_u32 s53, s53, 16384
  s_waitcnt lgkmcnt(0)
  v_mfma_f32_32x32x16_bf16 v[32:47], a[64:67], a[0:3], v[80:95]
  ds_read_b64_tr_b16 a[96:97], v19 offset:0
  ds_read_b64_tr_b16 a[98:99], v19 offset:512
  ds_read_b64_tr_b16 a[100:101], v19 offset:256
  v_exp_f32 v48, v48
  v_mfma_f32_32x32x16_bf16 v[32:47], a[68:71], a[4:7], v[32:47]
  ds_read_b64_tr_b16 a[102:103], v19 offset:768
  ds_read_b64_tr_b16 a[104:105], v19 offset:4096
  ds_read_b64_tr_b16 a[106:107], v19 offset:4608
  v_exp_f32 v49, v49
  v_mfma_f32_32x32x16_bf16 v[32:47], a[72:75], a[8:11], v[32:47]
  ds_read_b64_tr_b16 a[108:109], v19 offset:4352
  ds_read_b64_tr_b16 a[110:111], v19 offset:4864
  ds_read_b64_tr_b16 a[112:113], v19 offset:8192
  v_exp_f32 v50, v50
  v_mfma_f32_32x32x16_bf16 v[32:47], a[76:79], a[12:15], v[32:47]
  ds_read_b64_tr_b16 a[114:115], v19 offset:8704
  ds_read_b64_tr_b16 a[116:117], v19 offset:8448
  ds_read_b64_tr_b16 a[118:119], v19 offset:8960
  v_exp_f32 v51, v51
  v_add_f32 v22, v48, v49
  v_mfma_f32_32x32x16_bf16 v[32:47], a[80:83], a[16:19], v[32:47]
  ds_read_b64_tr_b16 a[120:121], v19 offset:12288
  ds_read_b64_tr_b16 a[122:123], v19 offset:12800
  ds_read_b64_tr_b16 a[124:125], v19 offset:12544
  v_cvt_pk_bf16_f32 v72, v48, v49
  v_mfma_f32_32x32x16_bf16 v[32:47], a[84:87], a[20:23], v[32:47]
  ds_read_b64_tr_b16 a[126:127], v19 offset:13056
  v_exp_f32 v52, v52
  v_exp_f32 v53, v53
  v_add_f32 v22, v22, v50
  v_mfma_f32_32x32x16_bf16 v[32:47], a[88:91], a[24:27], v[32:47]
  v_add_f32 v22, v22, v51
  v_cvt_pk_bf16_f32 v73, v50, v51
  v_exp_f32 v54, v54
  v_mfma_f32_32x32x16_bf16 v[32:47], a[92:95], a[28:31], v[32:47]
  s_waitcnt vmcnt(12) lgkmcnt(0)
  s_barrier
  v_exp_f32 v55, v55
  v_add_f32 v22, v22, v52
  v_add_f32 v22, v22, v53
  v_mfma_f32_32x32x16_bf16 v[128:143], a[96:99], v[64:67], 0
  s_add_u32 m0, s59, s51
  v_cvt_pk_bf16_f32 v74, v52, v53
  v_exp_f32 v56, v56
  v_exp_f32 v57, v57
  v_mfma_f32_32x32x16_bf16 v[160:175], a[100:103], v[64:67], 0
  buffer_load_dwordx4 v12, s[24:27], s54 offen lds
  s_add_u32 m0, m0, 1024
  v_add_f32 v22, v22, v54
  v_add_f32 v22, v22, v55
  v_cvt_pk_bf16_f32 v75, v54, v55
  v_mfma_f32_32x32x16_bf16 v[192:207], a[104:107], v[64:67], 0
  s_add_u32 s61, s54, 4096
  buffer_load_dwordx4 v12, s[24:27], s61 offen lds
  s_add_u32 m0, m0, 1024
  v_exp_f32 v58, v58
  v_mfma_f32_32x32x16_bf16 v[224:239], a[108:111], v[64:67], 0
  buffer_load_dwordx4 v13, s[28:31], s54 offen lds
  s_add_u32 m0, m0, 1024
  v_exp_f32 v59, v59
  v_add_f32 v22, v22, v56
  v_add_f32 v22, v22, v57
  v_mfma_f32_32x32x16_bf16 v[128:143], a[112:115], v[68:71], v[128:143]
  buffer_load_dwordx4 v14, s[28:31], s54 offen lds
  s_add_u32 s54, s54, 8192
  v_cvt_pk_bf16_f32 v76, v56, v57
  v_exp_f32 v60, v60
  v_mfma_f32_32x32x16_bf16 v[160:175], a[116:119], v[68:71], v[160:175]
  v_exp_f32 v61, v61
  v_add_f32 v22, v22, v58
  v_add_f32 v22, v22, v59
  v_cvt_pk_bf16_f32 v77, v58, v59
  v_mfma_f32_32x32x16_bf16 v[192:207], a[120:123], v[68:71], v[192:207]
  v_exp_f32 v62, v62
  v_exp_f32 v63, v63
  v_add_f32 v22, v22, v60
  v_mfma_f32_32x32x16_bf16 v[224:239], a[124:127], v[68:71], v[224:239]
  v_add_f32 v22, v22, v61
  v_cvt_pk_bf16_f32 v78, v60, v61
  v_add_f32 v22, v22, v62
  v_add_f32 v22, v22, v63
  v_cvt_pk_bf16_f32 v79, v62, v63
  v_mfma_f32_32x32x16_bf16 v[48:63], a[64:67], a[32:35], v[96:111]
  v_add_u32 v16, s57, v15
  v_xor_b32 v17, 32, v16
  v_exp_f32 v32, v32
  v_mfma_f32_32x32x16_bf16 v[48:63], a[68:71], a[36:39], v[48:63]
  v_exp_f32 v33, v33
  v_exp_f32 v34, v34
  v_mfma_f32_32x32x16_bf16 v[48:63], a[72:75], a[40:43], v[48:63]
  s_mov_b32 s59, s58
  s_mov_b32 s58, s57
  v_exp_f32 v35, v35
  v_add_f32 v21, v21, v32
  v_add_f32 v21, v21, v33
  v_mfma_f32_32x32x16_bf16 v[48:63], a[76:79], a[44:47], v[48:63]
  s_add_u32 s57, s57, 16384
  s_cmp_ge_u32 s57, 98304
  s_cselect_b32 s57, 0, s57
  v_cvt_pk_bf16_f32 v64, v32, v33
  v_exp_f32 v36, v36
  v_mfma_f32_32x32x16_bf16 v[48:63], a[80:83], a[48:51], v[48:63]
  v_add_u32 v19, s59, v18
  v_exp_f32 v37, v37
  v_add_f32 v21, v21, v34
  v_mfma_f32_32x32x16_bf16 v[48:63], a[84:87], a[52:55], v[48:63]
  v_add_f32 v21, v21, v35
  v_cvt_pk_bf16_f32 v65, v34, v35
  v_exp_f32 v38, v38
  v_mfma_f32_32x32x16_bf16 v[48:63], a[88:91], a[56:59], v[48:63]
  v_exp_f32 v39, v39
  v_add_f32 v21, v21, v36
  v_add_f32 v21, v21, v37
  v_mfma_f32_32x32x16_bf16 v[48:63], a[92:95], a[60:63], v[48:63]
  v_cvt_pk_bf16_f32 v66, v36, v37
  v_exp_f32 v40, v40
  v_exp_f32 v41, v41
  v_mfma_f32_32x32x16_bf16 v[144:159], a[96:99], v[72:75], 0
  ds_read_b128 a[64:67], v16 offset:0
  ds_read_b128 a[68:71], v17 offset:0
  v_add_f32 v21, v21, v38
  v_add_f32 v21, v21, v39
  v_mfma_f32_32x32x16_bf16 v[176:191], a[100:103], v[72:75], 0
  ds_read_b128 a[72:75], v16 offset:4096
  ds_read_b128 a[76:79], v17 offset:4096
  v_cvt_pk_bf16_f32 v67, v38, v39
  v_exp_f32 v42, v42
  v_mfma_f32_32x32x16_bf16 v[208:223], a[104:107], v[72:75], 0
  ds_read_b128 a[80:83], v16 offset:8192
  ds_read_b128 a[84:87], v17 offset:8192
  v_exp_f32 v43, v43
  v_mfma_f32_32x32x16_bf16 v[240:255], a[108:111], v[72:75], 0
  ds_read_b128 a[88:91], v16 offset:12288
  ds_read_b128 a[92:95], v17 offset:12288
  v_add_f32 v21, v21, v40
  v_add_f32 v21, v21, v41
  v_cvt_pk_bf16_f32 v68, v40, v41
  v_mfma_f32_32x32x16_bf16 v[144:159], a[112:115], v[76:79], v[144:159]
  v_exp_f32 v44, v44
  v_exp_f32 v45, v45
  v_mfma_f32_32x32x16_bf16 v[176:191], a[116:119], v[76:79], v[176:191]
  v_add_f32 v21, v21, v42
  v_add_f32 v21, v21, v43
  v_cvt_pk_bf16_f32 v69, v42, v43
  v_exp_f32 v46, v46
  v_mfma_f32_32x32x16_bf16 v[208:223], a[120:123], v[76:79], v[208:223]
  v_exp_f32 v47, v47
  v_add_f32 v21, v21, v44
  v_add_f32 v21, v21, v45
  v_mfma_f32_32x32x16_bf16 v[240:255], a[124:127], v[76:79], v[240:255]
  v_cvt_pk_bf16_f32 v70, v44, v45
  v_add_f32 v21, v21, v46
  v_add_f32 v21, v21, v47
  v_cvt_pk_bf16_f32 v71, v46, v47
  s_mov_b32 s55, 0
k2_p2a:
  s_waitcnt lgkmcnt(0)
  v_mfma_f32_32x32x16_bf16 v[32:47], a[64:67], a[0:3], v[80:95]
  ds_read_b64_tr_b16 a[96:97], v19 offset:0
  ds_read_b64_tr_b16 a[98:99], v19 offset:512
  ds_read_b64_tr_b16 a[100:101], v19 offset:256
  v_exp_f32 v48, v48
  v_mfma_f32_32x32x16_bf16 v[32:47], a[68:71], a[4:7], v[32:47]
  ds_read_b64_tr_b16 a[102:103], v19 offset:768
  ds_read_b64_tr_b16 a[104:105], v19 offset:4096
  ds_read_b64_tr_b16 a[106:107], v19 offset:4608
  v_exp_f32 v49, v49
  v_mfma_f32_32x32x16_bf16 v[32:47], a[72:75], a[8:11], v[32:47]
  ds_read_b64_tr_b16 a[108:109], v19 offset:4352
  ds_read_b64_tr_b16 a[110:111], v19 offset:4864
  ds_read_b64_tr_b16 a[112:113], v19 offset:8192
  v_exp_f32 v50, v50
  v_mfma_f32_32x32x16_bf16 v[32:47], a[76:79], a[12:15], v[32:47]
  ds_read_b64_tr_b16 a[114:115], v19 offset:8704
  ds_read_b64_tr_b16 a[116:117], v19 offset:8448
  ds_read_b64_tr_b16 a[118:119], v19 offset:8960
  v_exp_f32 v51, v51
  v_add_f32 v22, v22, v48
  v_mfma_f32_32x32x16_bf16 v[32:47], a[80:83], a[16:19], v[32:47]
  ds_read_b64_tr_b16 a[120:121], v19 offset:12288
  ds_read_b64_tr_b16 a[122:123], v19 offset:12800
  ds_read_b64_tr_b16 a[124:125], v19 offset:12544
  v_add_f32 v22, v22, v49
  v_cvt_pk_bf16_f32 v72, v48, v49
  v_mfma_f32_32x32x16_bf16 v[32:47], a[84:87], a[20:23], v[32:47]
  ds_read_b64_tr_b16 a[126:127], v19 offset:13056
  v_exp_f32 v52, v52
  v_exp_f32 v53, v53
  v_mfma_f32_32x32x16_bf16 v[32:47], a[88:91], a[24:27], v[32:47]
  v_add_f32 v22, v22, v50
  v_add_f32 v22, v22, v51
  v_cvt_pk_bf16_f32 v73, v50, v51
  v_exp_f32 v54, v54
  v_mfma_f32_32x32x16_bf16 v[32:47], a[92:95], a[28:31], v[32:47]
  s_waitcnt vmcnt(12) lgkmcnt(0)
  s_barrier
  v_exp_f32 v55, v55
  v_add_f32 v22, v22, v52
  v_add_f32 v22, v22, v53
  v_mfma_f32_32x32x16_bf16 v[128:143], a[96:99], v[64:67], v[128:143]
  s_add_u32 m0, s59, s51
  v_cvt_pk_bf16_f32 v74, v52, v53
  v_exp_f32 v56, v56
  v_exp_f32 v57, v57
  v_mfma_f32_32x32x16_bf16 v[160:175], a[100:103], v[64:67], v[160:175]
  buffer_load_dwordx4 v12, s[24:27], s54 offen lds
  s_add_u32 m0, m0, 1024
  v_add_f32 v22, v22, v54
  v_add_f32 v22, v22, v55
  v_cvt_pk_bf16_f32 v75, v54, v55
  v_mfma_f32_32x32x16_bf16 v[192:207], a[104:107], v[64:67], v[192:207]
  s_add_u32 s61, s54, 4096
  buffer_load_dwordx4 v12, s[24:27], s61 offen lds
  s_add_u32 m0, m0, 1024
  v_exp_f32 v58, v58
  v_mfma_f32_32x32x16_bf16 v[224:239], a[108:111], v[64:67], v[224:239]
  buffer_load_dwordx4 v13, s[28:31], s54 offen lds
  s_add_u32 m0, m0, 1024
  v_exp_f32 v59, v59
  v_add_f32 v22, v22, v56
  v_add_f32 v22, v22, v57
  v_mfma_f32_32x32x16_bf16 v[128:143], a[112:115], v[68:71], v[128:143]
  buffer_load_dwordx4 v14, s[28:31], s54 offen lds
  s_add_u32 s54, s54, 8192
  v_cvt_pk_bf16_f32 v76, v56, v57
  v_exp_f32 v60, v60
  v_mfma_f32_32x32x16_bf16 v[160:175], a[116:119], v[68:71], v[160:175]
  v_exp_f32 v61, v61
  v_add_f32 v22, v22, v58
  v_add_f32 v22, v22, v59
  v_cvt_pk_bf16_f32 v77, v58, v59
  v_mfma_f32_32x32x16_bf16 v[192:207], a[120:123], v[68:71], v[192:207]
  v_exp_f32 v62, v62
  v_exp_f32 v63, v63
  v_add_f32 v22, v22, v60
  v_mfma_f32_32x32x16_bf16 v[224:239], a[124:127], v[68:71], v[224:239]
  v_add_f32 v22, v22, v61
  v_cvt_pk_bf16_f32 v78, v60, v61
  v_add_f32 v22, v22, v62
  v_add_f32 v22, v22, v63
  v_cvt_pk_bf16_f32 v79, v62, v63
  v_mfma_f32_32x32x16_bf16 v[48:63], a[64:67], a[32:35], v[96:111]
  v_add_u32 v16, s57, v15
  v_xor_b32 v17, 32, v16
  v_exp_f32 v32, v32
  v_exp_f32 v33, v33
  v_mfma_f32_32x32x16_bf16 v[48:63], a[68:71], a[36:39], v[48:63]
  v_exp_f32 v34, v34
  v_exp_f32 v35, v35
  v_mfma_f32_32x32x16_bf16 v[48:63], a[72:75], a[40:43], v[48:63]
  s_mov_b32 s59, s58
  s_mov_b32 s58, s57
  v_add_f32 v21, v21, v32
  v_add_f32 v21, v21, v33
  v_cvt_pk_bf16_f32 v64, v32, v33
  v_mfma_f32_32x32x16_bf16 v[48:63], a[76:79], a[44:47], v[48:63]
  s_add_u32 s57, s57, 16384
  s_cmp_ge_u32 s57, 98304
  s_cselect_b32 s57, 0, s57
  v_exp_f32 v36, v36
  v_exp_f32 v37, v37
  v_mfma_f32_32x32x16_bf16 v[48:63], a[80:83], a[48:51], v[48:63]
  v_add_u32 v19, s59, v18
  v_add_f32 v21, v21, v34
  v_add_f32 v21, v21, v35
  v_cvt_pk_bf16_f32 v65, v34, v35
  v_mfma_f32_32x32x16_bf16 v[48:63], a[84:87], a[52:55], v[48:63]
  s_cmp_ge_u32 s55, 1
  s_cselect_b64 exec, -1, 0
  s_mov_b32 m0, s71
  s_add_u32 s71, s71, 1024
  buffer_load_dwordx4 v10, s[32:35], s53 offen lds
  s_mov_b32 m0, s71
  s_add_u32 s71, s71, 1024
  buffer_load_dwordx4 v11, s[32:35], s53 offen lds
  s_mov_b64 exec, -1
  s_add_u32 s53, s53, 16384
  v_mfma_f32_32x32x16_bf16 v[48:63], a[88:91], a[56:59], v[48:63]
  s_cmp_eq_u32 s55, s70
  s_cselect_b64 exec, s[68:69], 0
  buffer_atomic_add v29, v28, s[80:83], 0 offen offset:128 sc1
  s_mov_b64 exec, -1
  v_exp_f32 v38, v38
  v_mfma_f32_32x32x16_bf16 v[48:63], a[92:95], a[60:63], v[48:63]
  v_exp_f32 v39, v39
  v_add_f32 v21, v21, v36
  v_add_f32 v21, v21, v37
  v_cvt_pk_bf16_f32 v66, v36, v37
  v_mfma_f32_32x32x16_bf16 v[144:159], a[96:99], v[72:75], v[144:159]
  ds_read_b128 a[64:67], v16 offset:0
  ds_read_b128 a[68:71], v17 offset:0
  v_exp_f32 v40, v40
  v_exp_f32 v41, v41
  v_mfma_f32_32x32x16_bf16 v[176:191], a[100:103], v[72:75], v[176:191]
  ds_read_b128 a[72:75], v16 offset:4096
  ds_read_b128 a[76:79], v17 offset:4096
  v_add_f32 v21, v21, v38
  v_add_f32 v21, v21, v39
  v_cvt_pk_bf16_f32 v67, v38, v39
  v_mfma_f32_32x32x16_bf16 v[208:223], a[104:107], v[72:75], v[208:223]
  ds_read_b128 a[80:83], v16 offset:8192
  ds_read_b128 a[84:87], v17 offset:8192
  v_exp_f32 v42, v42
  v_mfma_f32_32x32x16_bf16 v[240:255], a[108:111], v[72:75], v[240:255]
  ds_read_b128 a[88:91], v16 offset:12288
  ds_read_b128 a[92:95], v17 offset:12288
  v_exp_f32 v43, v43
  v_add_f32 v21, v21, v40
  v_add_f32 v21, v21, v41
  v_mfma_f32_32x32x16_bf16 v[144:159], a[112:115], v[76:79], v[144:159]
  v_cvt_pk_bf16_f32 v68, v40, v41
  v_exp_f32 v44, v44
  v_exp_f32 v45, v45
  v_mfma_f32_32x32x16_bf16 v[176:191], a[116:119], v[76:79], v[176:191]
  v_add_f32 v21, v21, v42
  v_add_f32 v21, v21, v43
  v_cvt_pk_bf16_f32 v69, v42, v43
  v_exp_f32 v46, v46
  v_mfma_f32_32x32x16_bf16 v[208:223], a[120:123], v[76:79], v[208:223]
  s_add_u32 s55, s55, 1
  s_cmp_lt_u32 s55, 9
  v_exp_f32 v47, v47
  v_add_f32 v21, v21, v44
  v_mfma_f32_32x32x16_bf16 v[240:255], a[124:127], v[76:79], v[240:255]
  v_add_f32 v21, v21, v45
  v_cvt_pk_bf16_f32 v70, v44, v45
  v_add_f32 v21, v21, v46
  v_add_f32 v21, v21, v47
  v_cvt_pk_bf16_f32 v71, v46, v47
  s_cbranch_scc1 k2_p2a
  s_mov_b32 s55, 0
  s_mov_b32 s20, s4
  s_mov_b32 s21, s5
  s_mov_b32 s22, 0x1c0000
  s_mov_b32 s23, 0x20000
  s_mov_b32 s84, s8
  s_mov_b32 s85, s9
  s_mov_b32 s86, 0x1c0000
  s_mov_b32 s87, 0x20000
  v_and_b32 v2, 127, v0
  v_lshrrev_b32 v23, 3, v2
  s_movk_i32 s50, 3584
  v_mul_lo_u32 v23, v23, s50
  v_and_b32 v3, 7, v2
  v_lshl_add_u32 v23, v3, 6, v23
  v_lshlrev_b32 v2, 6, v2
  s_and_b32 s50, s45, 15
  s_mul_i32 s50, s50, 57344
  s_lshl_b32 s56, s46, 9
  s_add_u32 s50, s50, s56
  s_lshl_b32 s56, s46, 18
  s_and_b32 s61, s45, 15
  s_lshl_b32 s61, s61, 13
  s_add_u32 s56, s56, s61
  s_cmp_lt_u32 s44, 2
  s_cselect_b64 exec, -1, 0
  buffer_load_dword a210, v23, s[20:23], s50 offen
  buffer_load_dword a211, v2, s[84:87], s56 offen
  s_add_u32 s50, s50, 917504
  s_add_u32 s56, s56, 131072
  buffer_load_dword a212, v23, s[20:23], s50 offen
  buffer_load_dword a213, v2, s[84:87], s56 offen
  s_add_u32 s50, s50, 917504
  s_add_u32 s56, s56, 131072
  s_mov_b64 exec, -1
  s_waitcnt vmcnt(4)
  ds_read_b64_tr_b16 a[128:129], v25 offset:0
  ds_read_b64_tr_b16 a[130:131], v25 offset:512
  ds_read_b64_tr_b16 a[132:133], v25 offset:256
  ds_read_b64_tr_b16 a[134:135], v25 offset:768
  ds_read_b64_tr_b16 a[136:137], v25 offset:2048
  ds_read_b64_tr_b16 a[138:139], v25 offset:2560
  ds_read_b64_tr_b16 a[140:141], v25 offset:2304
  ds_read_b64_tr_b16 a[142:143], v25 offset:2816
  ds_read_b64_tr_b16 a[144:145], v25 offset:4096
  ds_read_b64_tr_b16 a[146:147], v25 offset:4608
  ds_read_b64_tr_b16 a[148:149], v25 offset:4352
  ds_read_b64_tr_b16 a[150:151], v25 offset:4864
  ds_read_b64_tr_b16 a[152:153], v25 offset:6144
  ds_read_b64_tr_b16 a[154:155], v25 offset:6656
  ds_read_b64_tr_b16 a[156:157], v25 offset:6400
  ds_read_b64_tr_b16 a[158:159], v25 offset:6912
  ds_read_b64_tr_b16 a[160:161], v25 offset:8192
  ds_read_b64_tr_b16 a[162:163], v25 offset:8704
  ds_read_b64_tr_b16 a[164:165], v25 offset:8448
  ds_read_b64_tr_b16 a[166:167], v25 offset:8960
  ds_read_b64_tr_b16 a[168:169], v25 offset:10240
  ds_read_b64_tr_b16 a[170:171], v25 offset:10752
  ds_read_b64_tr_b16 a[172:173], v25 offset:10496
  ds_read_b64_tr_b16 a[174:175], v25 offset:11008
  ds_read_b64_tr_b16 a[176:177], v25 offset:12288
  ds_read_b64_tr_b16 a[178:179], v25 offset:12800
  ds_read_b64_tr_b16 a[180:181], v25 offset:12544
  ds_read_b64_tr_b16 a[182:183], v25 offset:13056
  ds_read_b64_tr_b16 a[184:185], v25 offset:14336
  ds_read_b64_tr_b16 a[186:187], v25 offset:14848
  ds_read_b64_tr_b16 a[188:189], v25 offset:14592
  ds_read_b64_tr_b16 a[190:191], v25 offset:15104
  s_mov_b32 s76, s53
  s_add_u32 s53, s53, 131072
  s_sub_u32 s71, s71, 16384
k2_p2b:
  s_waitcnt lgkmcnt(0)
  v_mfma_f32_32x32x16_bf16 v[32:47], a[64:67], a[0:3], v[80:95]
  ds_read_b64_tr_b16 a[96:97], v19 offset:0
  ds_read_b64_tr_b16 a[98:99], v19 offset:512
  ds_read_b64_tr_b16 a[100:101], v19 offset:256
  v_exp_f32 v48, v48
  v_mfma_f32_32x32x16_bf16 v[32:47], a[68:71], a[4:7], v[32:47]
  ds_read_b64_tr_b16 a[102:103], v19 offset:768
  ds_read_b64_tr_b16 a[104:105], v19 offset:4096
  ds_read_b64_tr_b16 a[106:107], v19 offset:4608
  v_exp_f32 v49, v49
  v_mfma_f32_32x32x16_bf16 v[32:47], a[72:75], a[8:11], v[32:47]
  ds_read_b64_tr_b16 a[108:109], v19 offset:4352
  ds_read_b64_tr_b16 a[110:111], v19 offset:4864
  ds_read_b64_tr_b16 a[112:113], v19 offset:8192
  v_exp_f32 v50, v50
  v_mfma_f32_32x32x16_bf16 v[32:47], a[76:79], a[12:15], v[32:47]
  ds_read_b64_tr_b16 a[114:115], v19 offset:8704
  ds_read_b64_tr_b16 a[116:117], v19 offset:8448
  ds_read_b64_tr_b16 a[118:119], v19 offset:8960
  v_exp_f32 v51, v51
  v_add_f32 v22, v22, v48
  v_mfma_f32_32x32x16_bf16 v[32:47], a[80:83], a[16:19], v[32:47]
  ds_read_b64_tr_b16 a[120:121], v19 offset:12288
  ds_read_b64_tr_b16 a[122:123], v19 offset:12800
  ds_read_b64_tr_b16 a[124:125], v19 offset:12544
  v_add_f32 v22, v22, v49
  v_cvt_pk_bf16_f32 v72, v48, v49
  v_mfma_f32_32x32x16_bf16 v[32:47], a[84:87], a[20:23], v[32:47]
  ds_read_b64_tr_b16 a[126:127], v19 offset:13056
  v_exp_f32 v52, v52
  v_exp_f32 v53, v53
  v_mfma_f32_32x32x16_bf16 v[32:47], a[88:91], a[24:27], v[32:47]
  v_add_f32 v22, v22, v50
  v_add_f32 v22, v22, v51
  v_cvt_pk_bf16_f32 v73, v50, v51
  v_exp_f32 v54, v54
  v_mfma_f32_32x32x16_bf16 v[32:47], a[92:95], a[28:31], v[32:47]
  s_waitcnt vmcnt(12) lgkmcnt(0)
  s_barrier
  v_exp_f32 v55, v55
  v_add_f32 v22, v22, v52
  v_add_f32 v22, v22, v53
  v_mfma_f32_32x32x16_bf16 v[128:143], a[96:99], v[64:67], v[128:143]
  s_add_u32 m0, s59, s51
  v_cvt_pk_bf16_f32 v74, v52, v53
  v_exp_f32 v56, v56
  v_exp_f32 v57, v57
  v_mfma_f32_32x32x16_bf16 v[160:175], a[100:103], v[64:67], v[160:175]
  buffer_load_dwordx4 v10, s[32:35], s53 offen lds
  s_add_u32 m0, m0, 1024
  v_add_f32 v22, v22, v54
  v_add_f32 v22, v22, v55
  v_cvt_pk_bf16_f32 v75, v54, v55
  v_mfma_f32_32x32x16_bf16 v[192:207], a[104:107], v[64:67], v[192:207]
  buffer_load_dwordx4 v11, s[32:35], s53 offen lds
  s_add_u32 s53, s53, 16384
  s_add_u32 m0, m0, 1024
  v_exp_f32 v58, v58
  v_mfma_f32_32x32x16_bf16 v[224:239], a[108:111], v[64:67], v[224:239]
  buffer_load_dwordx4 v10, s[32:35], s53 offen lds
  s_add_u32 m0, m0, 1024
  v_exp_f32 v59, v59
  v_add_f32 v22, v22, v56
  v_add_f32 v22, v22, v57
  v_mfma_f32_32x32x16_bf16 v[128:143], a[112:115], v[68:71], v[128:143]
  buffer_load_dwordx4 v11, s[32:35], s53 offen lds
  s_add_u32 s53, s53, 16384
  v_cvt_pk_bf16_f32 v76, v56, v57
  v_exp_f32 v60, v60
  v_mfma_f32_32x32x16_bf16 v[160:175], a[116:119], v[68:71], v[160:175]
  v_exp_f32 v61, v61
  v_add_f32 v22, v22, v58
  v_add_f32 v22, v22, v59
  v_cvt_pk_bf16_f32 v77, v58, v59
  v_mfma_f32_32x32x16_bf16 v[192:207], a[120:123], v[68:71], v[192:207]
  v_exp_f32 v62, v62
  v_exp_f32 v63, v63
  v_add_f32 v22, v22, v60
  v_mfma_f32_32x32x16_bf16 v[224:239], a[124:127], v[68:71], v[224:239]
  v_add_f32 v22, v22, v61
  v_cvt_pk_bf16_f32 v78, v60, v61
  v_add_f32 v22, v22, v62
  v_add_f32 v22, v22, v63
  v_cvt_pk_bf16_f32 v79, v62, v63
  v_mfma_f32_32x32x16_bf16 v[48:63], a[64:67], a[32:35], v[96:111]
  v_add_u32 v16, s57, v15
  v_xor_b32 v17, 32, v16
  v_exp_f32 v32, v32
  v_exp_f32 v33, v33
  v_mfma_f32_32x32x16_bf16 v[48:63], a[68:71], a[36:39], v[48:63]
  v_exp_f32 v34, v34
  v_exp_f32 v35, v35
  v_mfma_f32_32x32x16_bf16 v[48:63], a[72:75], a[40:43], v[48:63]
  s_mov_b32 s59, s58
  s_mov_b32 s58, s57
  v_add_f32 v21, v21, v32
  v_add_f32 v21, v21, v33
  v_cvt_pk_bf16_f32 v64, v32, v33
  v_exp_f32 v36, v36
  v_mfma_f32_32x32x16_bf16 v[48:63], a[76:79], a[44:47], v[48:63]
  s_add_u32 s57, s57, 16384
  s_cmp_ge_u32 s57, 98304
  s_cselect_b32 s57, 0, s57
  v_exp_f32 v37, v37
  v_mfma_f32_32x32x16_bf16 v[48:63], a[80:83], a[48:51], v[48:63]
  v_add_u32 v19, s59, v18
  v_add_f32 v21, v21, v34
  v_add_f32 v21, v21, v35
  v_cvt_pk_bf16_f32 v65, v34, v35
  v_exp_f32 v38, v38
  v_mfma_f32_32x32x16_bf16 v[48:63], a[84:87], a[52:55], v[48:63]
  s_mov_b32 m0, s71
  s_add_u32 s71, s71, 1024
  buffer_load_dwordx4 v10, s[32:35], s76 offen lds
  s_mov_b32 m0, s71
  s_add_u32 s71, s71, 1024
  buffer_load_dwordx4 v11, s[32:35], s76 offen lds
  s_add_u32 s76, s76, 16384
  v_mfma_f32_32x32x16_bf16 v[48:63], a[88:91], a[56:59], v[48:63]
  v_exp_f32 v39, v39
  v_add_f32 v21, v21, v36
  v_add_f32 v21, v21, v37
  v_mfma_f32_32x32x16_bf16 v[48:63], a[92:95], a[60:63], v[48:63]
  s_mov_b32 m0, s71
  s_add_u32 s71, s71, 1024
  buffer_load_dwordx4 v10, s[32:35], s76 offen lds
  s_mov_b32 m0, s71
  s_add_u32 s71, s71, 1024
  buffer_load_dwordx4 v11, s[32:35], s76 offen lds
  s_add_u32 s76, s76, 16384
  v_mfma_f32_32x32x16_bf16 v[144:159], a[96:99], v[72:75], v[144:159]
  ds_read_b128 a[64:67], v16 offset:0
  ds_read_b128 a[68:71], v17 offset:0
  v_cvt_pk_bf16_f32 v66, v36, v37
  v_exp_f32 v40, v40
  v_mfma_f32_32x32x16_bf16 v[176:191], a[100:103], v[72:75], v[176:191]
  ds_read_b128 a[72:75], v16 offset:4096
  ds_read_b128 a[76:79], v17 offset:4096
  v_exp_f32 v41, v41
  v_add_f32 v21, v21, v38
  v_add_f32 v21, v21, v39
  v_mfma_f32_32x32x16_bf16 v[208:223], a[104:107], v[72:75], v[208:223]
  ds_read_b128 a[80:83], v16 offset:8192
  ds_read_b128 a[84:87], v17 offset:8192
  v_cvt_pk_bf16_f32 v67, v38, v39
  v_exp_f32 v42, v42
  v_mfma_f32_32x32x16_bf16 v[240:255], a[108:111], v[72:75], v[240:255]
  ds_read_b128 a[88:91], v16 offset:12288
  ds_read_b128 a[92:95], v17 offset:12288
  v_exp_f32 v43, v43
  v_add_f32 v21, v21, v40
  v_mfma_f32_32x32x16_bf16 v[144:159], a[112:115], v[76:79], v[144:159]
  v_add_f32 v21, v21, v41
  v_cvt_pk_bf16_f32 v68, v40, v41
  v_exp_f32 v44, v44
  v_exp_f32 v45, v45
  v_mfma_f32_32x32x16_bf16 v[176:191], a[116:119], v[76:79], v[176:191]
  v_add_f32 v21, v21, v42
  v_add_f32 v21, v21, v43
  v_cvt_pk_bf16_f32 v69, v42, v43
  v_exp_f32 v46, v46
  v_mfma_f32_32x32x16_bf16 v[208:223], a[120:123], v[76:79], v[208:223]
  s_add_u32 s55, s55, 1
  s_cmp_lt_u32 s55, 4
  v_exp_f32 v47, v47
  v_add_f32 v21, v21, v44
  v_mfma_f32_32x32x16_bf16 v[240:255], a[124:127], v[76:79], v[240:255]
  v_add_f32 v21, v21, v45
  v_cvt_pk_bf16_f32 v70, v44, v45
  v_add_f32 v21, v21, v46
  v_add_f32 v21, v21, v47
  v_cvt_pk_bf16_f32 v71, v46, v47
  s_cbranch_scc1 k2_p2b
  buffer_load_dword v30, v28, s[80:83], 0 offen offset:128 sc1
  s_waitcnt lgkmcnt(0)
  v_mfma_f32_32x32x16_bf16 v[32:47], a[64:67], a[0:3], v[80:95]
  ds_read_b64_tr_b16 a[96:97], v19 offset:0
  ds_read_b64_tr_b16 a[98:99], v19 offset:512
  ds_read_b64_tr_b16 a[100:101], v19 offset:256
  v_exp_f32 v48, v48
  v_mfma_f32_32x32x16_bf16 v[32:47], a[68:71], a[4:7], v[32:47]
  ds_read_b64_tr_b16 a[102:103], v19 offset:768
  ds_read_b64_tr_b16 a[104:105], v19 offset:4096
  ds_read_b64_tr_b16 a[106:107], v19 offset:4608
  v_exp_f32 v49, v49
  v_mfma_f32_32x32x16_bf16 v[32:47], a[72:75], a[8:11], v[32:47]
  ds_read_b64_tr_b16 a[108:109], v19 offset:4352
  ds_read_b64_tr_b16 a[110:111], v19 offset:4864
  ds_read_b64_tr_b16 a[112:113], v19 offset:8192
  v_exp_f32 v50, v50
  v_mfma_f32_32x32x16_bf16 v[32:47], a[76:79], a[12:15], v[32:47]
  ds_read_b64_tr_b16 a[114:115], v19 offset:8704
  ds_read_b64_tr_b16 a[116:117], v19 offset:8448
  ds_read_b64_tr_b16 a[118:119], v19 offset:8960
  v_exp_f32 v51, v51
  v_add_f32 v22, v22, v48
  v_mfma_f32_32x32x16_bf16 v[32:47], a[80:83], a[16:19], v[32:47]
  ds_read_b64_tr_b16 a[120:121], v19 offset:12288
  ds_read_b64_tr_b16 a[122:123], v19 offset:12800
  ds_read_b64_tr_b16 a[124:125], v19 offset:12544
  v_add_f32 v22, v22, v49
  v_cvt_pk_bf16_f32 v72, v48, v49
  v_mfma_f32_32x32x16_bf16 v[32:47], a[84:87], a[20:23], v[32:47]
  ds_read_b64_tr_b16 a[126:127], v19 offset:13056
  v_exp_f32 v52, v52
  v_exp_f32 v53, v53
  v_mfma_f32_32x32x16_bf16 v[32:47], a[88:91], a[24:27], v[32:47]
  v_add_f32 v22, v22, v50
  v_add_f32 v22, v22, v51
  v_cvt_pk_bf16_f32 v73, v50, v51
  v_exp_f32 v54, v54
  v_mfma_f32_32x32x16_bf16 v[32:47], a[92:95], a[28:31], v[32:47]
  s_waitcnt vmcnt(12) lgkmcnt(0)
  s_barrier
  v_exp_f32 v55, v55
  v_add_f32 v22, v22, v52
  v_add_f32 v22, v22, v53
  v_mfma_f32_32x32x16_bf16 v[128:143], a[96:99], v[64:67], v[128:143]
  s_add_u32 m0, s59, s51
  v_cvt_pk_bf16_f32 v74, v52, v53
  v_exp_f32 v56, v56
  v_exp_f32 v57, v57
  v_mfma_f32_32x32x16_bf16 v[160:175], a[100:103], v[64:67], v[160:175]
  buffer_load_dwordx4 v10, s[32:35], s53 offen lds
  s_add_u32 m0, m0, 1024
  v_add_f32 v22, v22, v54
  v_add_f32 v22, v22, v55
  v_cvt_pk_bf16_f32 v75, v54, v55
  v_mfma_f32_32x32x16_bf16 v[192:207], a[104:107], v[64:67], v[192:207]
  buffer_load_dwordx4 v11, s[32:35], s53 offen lds
  s_add_u32 s53, s53, 16384
  s_add_u32 m0, m0, 1024
  v_exp_f32 v58, v58
  v_mfma_f32_32x32x16_bf16 v[224:239], a[108:111], v[64:67], v[224:239]
  buffer_load_dwordx4 v10, s[32:35], s53 offen lds
  s_add_u32 m0, m0, 1024
  v_exp_f32 v59, v59
  v_add_f32 v22, v22, v56
  v_add_f32 v22, v22, v57
  v_mfma_f32_32x32x16_bf16 v[128:143], a[112:115], v[68:71], v[128:143]
  buffer_load_dwordx4 v11, s[32:35], s53 offen lds
  s_add_u32 s53, s53, 16384
  v_cvt_pk_bf16_f32 v76, v56, v57
  v_exp_f32 v60, v60
  v_mfma_f32_32x32x16_bf16 v[160:175], a[116:119], v[68:71], v[160:175]
  v_exp_f32 v61, v61
  v_add_f32 v22, v22, v58
  v_add_f32 v22, v22, v59
  v_cvt_pk_bf16_f32 v77, v58, v59
  v_mfma_f32_32x32x16_bf16 v[192:207], a[120:123], v[68:71], v[192:207]
  v_exp_f32 v62, v62
  v_exp_f32 v63, v63
  v_add_f32 v22, v22, v60
  v_mfma_f32_32x32x16_bf16 v[224:239], a[124:127], v[68:71], v[224:239]
  v_add_f32 v22, v22, v61
  v_cvt_pk_bf16_f32 v78, v60, v61
  v_add_f32 v22, v22, v62
  v_add_f32 v22, v22, v63
  v_cvt_pk_bf16_f32 v79, v62, v63
  v_mfma_f32_32x32x16_bf16 v[48:63], a[64:67], a[32:35], v[96:111]
  ds_read_b64_tr_b16 a[192:193], v25 offset:0
  ds_read_b64_tr_b16 a[194:195], v25 offset:512
  v_add_u32 v16, s57, v15
  v_xor_b32 v17, 32, v16
  v_exp_f32 v32, v32
  v_mfma_f32_32x32x16_bf16 v[48:63], a[68:71], a[36:39], v[48:63]
  ds_read_b64_tr_b16 a[196:197], v25 offset:256
  ds_read_b64_tr_b16 a[198:199], v25 offset:768
  v_exp_f32 v33, v33
  v_exp_f32 v34, v34
  v_mfma_f32_32x32x16_bf16 v[48:63], a[72:75], a[40:43], v[48:63]
  s_mov_b32 s59, s58
  s_mov_b32 s58, s57
  ds_read_b64_tr_b16 a[200:201], v25 offset:2048
  ds_read_b64_tr_b16 a[202:203], v25 offset:2560
  v_exp_f32 v35, v35
  v_mfma_f32_32x32x16_bf16 v[48:63], a[76:79], a[44:47], v[48:63]
  s_add_u32 s57, s57, 16384
  s_cmp_ge_u32 s57, 98304
  s_cselect_b32 s57, 0, s57
  ds_read_b64_tr_b16 a[204:205], v25 offset:2304
  ds_read_b64_tr_b16 a[206:207], v25 offset:2816
  v_add_f32 v21, v21, v32
  v_add_f32 v21, v21, v33
  v_mfma_f32_32x32x16_bf16 v[48:63], a[80:83], a[48:51], v[48:63]
  ds_read_b64_tr_b16 a[208:209], v25 offset:4096
  ds_read_b64_tr_b16 a[210:211], v25 offset:4608
  v_add_u32 v19, s59, v18
  v_cvt_pk_bf16_f32 v64, v32, v33
  v_exp_f32 v36, v36
  v_mfma_f32_32x32x16_bf16 v[48:63], a[84:87], a[52:55], v[48:63]
  ds_read_b64_tr_b16 a[212:213], v25 offset:4352
  ds_read_b64_tr_b16 a[214:215], v25 offset:4864
  v_exp_f32 v37, v37
  v_add_f32 v21, v21, v34
  v_add_f32 v21, v21, v35
  v_mfma_f32_32x32x16_bf16 v[48:63], a[88:91], a[56:59], v[48:63]
  ds_read_b64_tr_b16 a[216:217], v25 offset:6144
  ds_read_b64_tr_b16 a[218:219], v25 offset:6656
  v_cvt_pk_bf16_f32 v65, v34, v35
  v_exp_f32 v38, v38
  v_mfma_f32_32x32x16_bf16 v[48:63], a[92:95], a[60:63], v[48:63]
  ds_read_b64_tr_b16 a[220:221], v25 offset:6400
  ds_read_b64_tr_b16 a[222:223], v25 offset:6912
  v_exp_f32 v39, v39
  v_add_f32 v21, v21, v36
  v_add_f32 v21, v21, v37
  v_cvt_pk_bf16_f32 v66, v36, v37
  v_mfma_f32_32x32x16_bf16 v[144:159], a[96:99], v[72:75], v[144:159]
  ds_read_b64_tr_b16 a[96:97], v19 offset:0
  ds_read_b64_tr_b16 a[98:99], v19 offset:512
  v_exp_f32 v40, v40
  v_exp_f32 v41, v41
  v_mfma_f32_32x32x16_bf16 v[176:191], a[100:103], v[72:75], v[176:191]
  ds_read_b64_tr_b16 a[100:101], v19 offset:256
  ds_read_b64_tr_b16 a[102:103], v19 offset:768
  v_add_f32 v21, v21, v38
  v_add_f32 v21, v21, v39
  v_cvt_pk_bf16_f32 v67, v38, v39
  v_mfma_f32_32x32x16_bf16 v[208:223], a[104:107], v[72:75], v[208:223]
  ds_read_b64_tr_b16 a[104:105], v19 offset:4096
  ds_read_b64_tr_b16 a[106:107], v19 offset:4608
  v_exp_f32 v42, v42
  v_exp_f32 v43, v43
  v_add_f32 v21, v21, v40
  v_mfma_f32_32x32x16_bf16 v[240:255], a[108:111], v[72:75], v[240:255]
  ds_read_b64_tr_b16 a[108:109], v19 offset:4352
  ds_read_b64_tr_b16 a[110:111], v19 offset:4864
  v_add_f32 v21, v21, v41
  v_cvt_pk_bf16_f32 v68, v40, v41
  v_exp_f32 v44, v44
  v_mfma_f32_32x32x16_bf16 v[144:159], a[112:115], v[76:79], v[144:159]
  ds_read_b64_tr_b16 a[112:113], v19 offset:8192
  ds_read_b64_tr_b16 a[114:115], v19 offset:8704
  v_exp_f32 v45, v45
  v_add_f32 v21, v21, v42
  v_mfma_f32_32x32x16_bf16 v[176:191], a[116:119], v[76:79], v[176:191]
  ds_read_b64_tr_b16 a[116:117], v19 offset:8448
  ds_read_b64_tr_b16 a[118:119], v19 offset:8960
  v_add_f32 v21, v21, v43
  v_cvt_pk_bf16_f32 v69, v42, v43
  v_exp_f32 v46, v46
  v_mfma_f32_32x32x16_bf16 v[208:223], a[120:123], v[76:79], v[208:223]
  ds_read_b64_tr_b16 a[120:121], v19 offset:12288
  ds_read_b64_tr_b16 a[122:123], v19 offset:12800
  v_exp_f32 v47, v47
  v_add_f32 v21, v21, v44
  v_add_f32 v21, v21, v45
  v_mfma_f32_32x32x16_bf16 v[240:255], a[124:127], v[76:79], v[240:255]
  ds_read_b64_tr_b16 a[124:125], v19 offset:12544
  ds_read_b64_tr_b16 a[126:127], v19 offset:13056
  v_cvt_pk_bf16_f32 v70, v44, v45
  v_add_f32 v21, v21, v46
  v_add_f32 v21, v21, v47
  v_cvt_pk_bf16_f32 v71, v46, v47
  s_waitcnt vmcnt(4)
  s_waitcnt lgkmcnt(14)
  v_mfma_f32_32x32x16_bf16 v[128:143], a[96:99], v[64:67], v[128:143]
  ds_read_b64_tr_b16 a[224:225], v25 offset:8192
  ds_read_b64_tr_b16 a[226:227], v25 offset:8704
  v_exp_f32 v48, v48
  v_exp_f32 v49, v49
  v_exp_f32 v50, v50
  v_exp_f32 v51, v51
  s_waitcnt lgkmcnt(14)
  v_mfma_f32_32x32x16_bf16 v[160:175], a[100:103], v[64:67], v[160:175]
  ds_read_b64_tr_b16 a[228:229], v25 offset:8448
  ds_read_b64_tr_b16 a[230:231], v25 offset:8960
  v_add_f32 v22, v22, v48
  v_add_f32 v22, v22, v49
  v_cvt_pk_bf16_f32 v72, v48, v49
  v_exp_f32 v52, v52
  v_exp_f32 v53, v53
  s_waitcnt lgkmcnt(14)
  v_mfma_f32_32x32x16_bf16 v[192:207], a[104:107], v[64:67], v[192:207]
  ds_read_b64_tr_b16 a[232:233], v25 offset:10240
  ds_read_b64_tr_b16 a[234:235], v25 offset:10752
  v_add_f32 v22, v22, v50
  v_add_f32 v22, v22, v51
  v_cvt_pk_bf16_f32 v73, v50, v51
  v_exp_f32 v54, v54
  v_exp_f32 v55, v55
  s_waitcnt lgkmcnt(14)
  v_mfma_f32_32x32x16_bf16 v[224:239], a[108:111], v[64:67], v[224:239]
  ds_read_b64_tr_b16 a[236:237], v25 offset:10496
  ds_read_b64_tr_b16 a[238:239], v25 offset:11008
  v_add_f32 v22, v22, v52
  v_add_f32 v22, v22, v53
  v_cvt_pk_bf16_f32 v74, v52, v53
  v_exp_f32 v56, v56
  v_exp_f32 v57, v57
  s_waitcnt lgkmcnt(14)
  v_mfma_f32_32x32x16_bf16 v[128:143], a[112:115], v[68:71], v[128:143]
  ds_read_b64_tr_b16 a[240:241], v25 offset:12288
  ds_read_b64_tr_b16 a[242:243], v25 offset:12800
  v_add_f32 v22, v22, v54
  v_add_f32 v22, v22, v55
  v_cvt_pk_bf16_f32 v75, v54, v55
  v_exp_f32 v58, v58
  v_exp_f32 v59, v59
  s_waitcnt lgkmcnt(14)
  v_mfma_f32_32x32x16_bf16 v[160:175], a[116:119], v[68:71], v[160:175]
  ds_read_b64_tr_b16 a[244:245], v25 offset:12544
  ds_read_b64_tr_b16 a[246:247], v25 offset:13056
  v_add_f32 v22, v22, v56
  v_add_f32 v22, v22, v57
  v_cvt_pk_bf16_f32 v76, v56, v57
  v_exp_f32 v60, v60
  v_exp_f32 v61, v61
  s_waitcnt lgkmcnt(14)
  v_mfma_f32_32x32x16_bf16 v[192:207], a[120:123], v[68:71], v[192:207]
  ds_read_b64_tr_b16 a[248:249], v25 offset:14336
  ds_read_b64_tr_b16 a[250:251], v25 offset:14848
  v_add_f32 v22, v22, v58
  v_add_f32 v22, v22, v59
  v_cvt_pk_bf16_f32 v77, v58, v59
  v_exp_f32 v62, v62
  v_exp_f32 v63, v63
  s_waitcnt lgkmcnt(14)
  v_mfma_f32_32x32x16_bf16 v[224:239], a[124:127], v[68:71], v[224:239]
  ds_read_b64_tr_b16 a[252:253], v25 offset:14592
  ds_read_b64_tr_b16 a[254:255], v25 offset:15104
  v_add_f32 v22, v22, v60
  v_add_f32 v22, v22, v61
  v_cvt_pk_bf16_f32 v78, v60, v61
  v_add_f32 v22, v22, v62
  v_add_f32 v22, v22, v63
  v_cvt_pk_bf16_f32 v79, v62, v63
  s_mov_b32 s50, 0
k2_cp:
  v_readfirstlane_b32 s56, v30
  s_nop 0
  s_cmp_ge_u32 s56, 256
  s_cbranch_scc1 k2_cd
  s_sleep 4
  buffer_load_dword v30, v28, s[80:83], 0 offen offset:128 sc1
  s_add_u32 s50, s50, 1
  s_waitcnt vmcnt(0)
  s_cmp_lt_u32 s50, 0x80000
  s_cbranch_scc1 k2_cp
k2_cd:
  v_mfma_f32_32x32x16_bf16 v[144:159], a[96:99], v[72:75], v[144:159]
  s_lshl_b32 s50, s45, 16
  s_lshl_b32 s56, s46, 12
  s_add_u32 s50, s50, s56
  s_mov_b32 s56, 32768
  v_lshrrev_b32 v2, 2, v0
  v_lshlrev_b32 v26, 4, v2
  v_and_b32 v2, 3, v0
  v_lshl_add_u32 v16, v2, 10, v26
  v_add_u32 v16, s50, v16
  v_mov_b32 v112, 0
  v_mfma_f32_32x32x16_bf16 v[176:191], a[100:103], v[72:75], v[176:191]
  s_lshl_b32 s50, s44, 14
  s_mov_b32 s84, s10
  s_mov_b32 s85, s11
  s_mov_b32 s86, 0x400
  s_mov_b32 s87, 0x20000
  v_mov_b32 v113, 0
  v_mov_b32 v114, 0
  v_mov_b32 v115, 0
  v_subrev_u32 v6, 49152, v6
  v_add_u32 v27, s50, v6
  v_mfma_f32_32x32x16_bf16 v[208:223], a[104:107], v[72:75], v[208:223]
  s_mov_b32 s50, 196608
  s_nop 1
  v_mov_b32 v124, v21
  s_nop 1
  v_permlane32_swap_b32 v124, v21
  v_add_f32 v21, v21, v124
  v_rcp_f32 v124, v21
  v_cmp_gt_f32 vcc, 0x5d800000, v21
  v_mov_b32 v125, 0x7fc00000
  v_mfma_f32_32x32x16_bf16 v[240:255], a[108:111], v[72:75], v[240:255]
  v_mov_b32 v122, 0
  v_cndmask_b32 v124, v125, v124, vcc
  v_mul_f32 v128, v124, v128
  v_mul_f32 v129, v124, v129
  v_mul_f32 v130, v124, v130
  v_mul_f32 v131, v124, v131
  v_mul_f32 v132, v124, v132
  v_mul_f32 v133, v124, v133
  v_mfma_f32_32x32x16_bf16 v[144:159], a[112:115], v[76:79], v[144:159]
  buffer_load_dwordx4 a[64:67], v26, s[36:39], s50 offen offset:0 sc1
  buffer_load_dwordx4 a[68:71], v26, s[36:39], s50 offen offset:1024 sc1
  v_mul_f32 v134, v124, v134
  v_mul_f32 v135, v124, v135
  v_xor_b32 v3, 0, v27
  v_cvt_pk_bf16_f32 v128, v128, v129
  v_cvt_pk_bf16_f32 v129, v130, v131
  v_cvt_pk_bf16_f32 v130, v132, v133
  v_mfma_f32_32x32x16_bf16 v[176:191], a[116:119], v[76:79], v[176:191]
  buffer_load_dwordx4 a[72:75], v26, s[36:39], s50 offen offset:2048 sc1
  buffer_load_dwordx4 a[76:79], v26, s[36:39], s50 offen offset:3072 sc1
  v_cvt_pk_bf16_f32 v131, v134, v135
  v_max3_f32 v122, abs(v128), abs(v129), v122
  v_max3_f32 v122, abs(v130), abs(v131), v122
  v_mul_f32 v136, v124, v136
  v_mul_f32 v137, v124, v137
  v_mul_f32 v138, v124, v138
  v_mfma_f32_32x32x16_bf16 v[208:223], a[120:123], v[76:79], v[208:223]
  ds_write_b128 v3, v[128:131] offset:0
  buffer_load_dwordx4 v[96:99], v16, s[16:19], 0 offen
  buffer_load_dwordx4 v[100:103], v16, s[16:19], s56 offen
  v_mul_f32 v139, v124, v139
  v_mul_f32 v140, v124, v140
  v_mul_f32 v141, v124, v141
  v_mul_f32 v142, v124, v142
  v_mul_f32 v143, v124, v143
  v_xor_b32 v2, 32, v27
  v_mfma_f32_32x32x16_bf16 v[240:255], a[124:127], v[76:79], v[240:255]
  buffer_load_dwordx4 v[104:107], v26, s[84:87], 0 offen
  v_cvt_pk_bf16_f32 v136, v136, v137
  v_cvt_pk_bf16_f32 v137, v138, v139
  v_cvt_pk_bf16_f32 v138, v140, v141
  v_cvt_pk_bf16_f32 v139, v142, v143
  ds_write_b128 v2, v[136:139] offset:0
  v_max3_f32 v122, abs(v136), abs(v137), v122
  v_max3_f32 v122, abs(v138), abs(v139), v122
  v_mov_b32 v126, v22
  s_nop 1
  v_permlane32_swap_b32 v126, v22
  v_add_f32 v22, v22, v126
  v_rcp_f32 v126, v22
  v_cmp_gt_f32 vcc, 0x5d800000, v22
  v_mov_b32 v127, 0x7fc00000
  v_mov_b32 v123, 0
  v_cndmask_b32 v126, v127, v126, vcc
  v_pk_mul_f32 v[160:161], v[160:161], v[124:125] op_sel_hi:[1,0]
  v_pk_mul_f32 v[162:163], v[162:163], v[124:125] op_sel_hi:[1,0]
  v_pk_mul_f32 v[164:165], v[164:165], v[124:125] op_sel_hi:[1,0]
  v_pk_mul_f32 v[166:167], v[166:167], v[124:125] op_sel_hi:[1,0]
  v_xor_b32 v3, 64, v27
  v_cvt_pk_bf16_f32 v160, v160, v161
  v_cvt_pk_bf16_f32 v161, v162, v163
  v_cvt_pk_bf16_f32 v162, v164, v165
  v_cvt_pk_bf16_f32 v163, v166, v167
  ds_write_b128 v3, v[160:163] offset:0
  v_max3_f32 v122, abs(v160), abs(v161), v122
  v_max3_f32 v122, abs(v162), abs(v163), v122
  v_pk_mul_f32 v[168:169], v[168:169], v[124:125] op_sel_hi:[1,0]
  v_pk_mul_f32 v[170:171], v[170:171], v[124:125] op_sel_hi:[1,0]
  v_pk_mul_f32 v[172:173], v[172:173], v[124:125] op_sel_hi:[1,0]
  v_pk_mul_f32 v[174:175], v[174:175], v[124:125] op_sel_hi:[1,0]
  v_xor_b32 v2, 96, v27
  v_cvt_pk_bf16_f32 v168, v168, v169
  v_cvt_pk_bf16_f32 v169, v170, v171
  v_cvt_pk_bf16_f32 v170, v172, v173
  v_cvt_pk_bf16_f32 v171, v174, v175
  ds_write_b128 v2, v[168:171] offset:0
  v_max3_f32 v122, abs(v168), abs(v169), v122
  v_max3_f32 v122, abs(v170), abs(v171), v122
  v_pk_mul_f32 v[192:193], v[192:193], v[124:125] op_sel_hi:[1,0]
  v_pk_mul_f32 v[194:195], v[194:195], v[124:125] op_sel_hi:[1,0]
  v_pk_mul_f32 v[196:197], v[196:197], v[124:125] op_sel_hi:[1,0]
  v_pk_mul_f32 v[198:199], v[198:199], v[124:125] op_sel_hi:[1,0]
  v_xor_b32 v3, 128, v27
  v_cvt_pk_bf16_f32 v192, v192, v193
  v_cvt_pk_bf16_f32 v193, v194, v195
  v_cvt_pk_bf16_f32 v194, v196, v197
  v_cvt_pk_bf16_f32 v195, v198, v199
  ds_write_b128 v3, v[192:195] offset:0
  v_max3_f32 v122, abs(v192), abs(v193), v122
  v_max3_f32 v122, abs(v194), abs(v195), v122
  v_pk_mul_f32 v[200:201], v[200:201], v[124:125] op_sel_hi:[1,0]
  v_pk_mul_f32 v[202:203], v[202:203], v[124:125] op_sel_hi:[1,0]
  v_pk_mul_f32 v[204:205], v[204:205], v[124:125] op_sel_hi:[1,0]
  v_pk_mul_f32 v[206:207], v[206:207], v[124:125] op_sel_hi:[1,0]
  v_xor_b32 v2, 160, v27
  v_cvt_pk_bf16_f32 v200, v200, v201
  v_cvt_pk_bf16_f32 v201, v202, v203
  v_cvt_pk_bf16_f32 v202, v204, v205
  v_cvt_pk_bf16_f32 v203, v206, v207
  ds_write_b128 v2, v[200:203] offset:0
  v_max3_f32 v122, abs(v200), abs(v201), v122
  v_max3_f32 v122, abs(v202), abs(v203), v122
  v_pk_mul_f32 v[224:225], v[224:225], v[124:125] op_sel_hi:[1,0]
  v_pk_mul_f32 v[226:227], v[226:227], v[124:125] op_sel_hi:[1,0]
  v_pk_mul_f32 v[228:229], v[228:229], v[124:125] op_sel_hi:[1,0]
  v_pk_mul_f32 v[230:231], v[230:231], v[124:125] op_sel_hi:[1,0]
  v_xor_b32 v3, 192, v27
  v_cvt_pk_bf16_f32 v224, v224, v225
  v_cvt_pk_bf16_f32 v225, v226, v227
  v_cvt_pk_bf16_f32 v226, v228, v229
  v_cvt_pk_bf16_f32 v227, v230, v231
  ds_write_b128 v3, v[224:227] offset:0
  v_max3_f32 v122, abs(v224), abs(v225), v122
  v_max3_f32 v122, abs(v226), abs(v227), v122
  v_pk_mul_f32 v[232:233], v[232:233], v[124:125] op_sel_hi:[1,0]
  v_pk_mul_f32 v[234:235], v[234:235], v[124:125] op_sel_hi:[1,0]
  v_pk_mul_f32 v[236:237], v[236:237], v[124:125] op_sel_hi:[1,0]
  v_pk_mul_f32 v[238:239], v[238:239], v[124:125] op_sel_hi:[1,0]
  v_xor_b32 v2, 224, v27
  v_cvt_pk_bf16_f32 v232, v232, v233
  v_cvt_pk_bf16_f32 v233, v234, v235
  v_cvt_pk_bf16_f32 v234, v236, v237
  v_cvt_pk_bf16_f32 v235, v238, v239
  ds_write_b128 v2, v[232:235] offset:0
  v_max3_f32 v122, abs(v232), abs(v233), v122
  v_max3_f32 v122, abs(v234), abs(v235), v122
  v_pk_mul_f32 v[144:145], v[144:145], v[126:127] op_sel_hi:[1,0]
  v_pk_mul_f32 v[146:147], v[146:147], v[126:127] op_sel_hi:[1,0]
  v_pk_mul_f32 v[148:149], v[148:149], v[126:127] op_sel_hi:[1,0]
  v_pk_mul_f32 v[150:151], v[150:151], v[126:127] op_sel_hi:[1,0]
  v_xor_b32 v3, 0, v27
  v_cvt_pk_bf16_f32 v144, v144, v145
  v_cvt_pk_bf16_f32 v145, v146, v147
  v_cvt_pk_bf16_f32 v146, v148, v149
  v_cvt_pk_bf16_f32 v147, v150, v151
  ds_write_b128 v3, v[144:147] offset:8192
  v_max3_f32 v123, abs(v144), abs(v145), v123
  v_max3_f32 v123, abs(v146), abs(v147), v123
  v_pk_mul_f32 v[152:153], v[152:153], v[126:127] op_sel_hi:[1,0]
  v_pk_mul_f32 v[154:155], v[154:155], v[126:127] op_sel_hi:[1,0]
  v_pk_mul_f32 v[156:157], v[156:157], v[126:127] op_sel_hi:[1,0]
  v_pk_mul_f32 v[158:159], v[158:159], v[126:127] op_sel_hi:[1,0]
  v_xor_b32 v2, 32, v27
  v_cvt_pk_bf16_f32 v152, v152, v153
  v_cvt_pk_bf16_f32 v153, v154, v155
  v_cvt_pk_bf16_f32 v154, v156, v157
  v_cvt_pk_bf16_f32 v155, v158, v159
  ds_write_b128 v2, v[152:155] offset:8192
  v_max3_f32 v123, abs(v152), abs(v153), v123
  v_max3_f32 v123, abs(v154), abs(v155), v123
  v_pk_mul_f32 v[176:177], v[176:177], v[126:127] op_sel_hi:[1,0]
  v_pk_mul_f32 v[178:179], v[178:179], v[126:127] op_sel_hi:[1,0]
  v_pk_mul_f32 v[180:181], v[180:181], v[126:127] op_sel_hi:[1,0]
  v_pk_mul_f32 v[182:183], v[182:183], v[126:127] op_sel_hi:[1,0]
  v_xor_b32 v3, 64, v27
  v_cvt_pk_bf16_f32 v176, v176, v177
  v_cvt_pk_bf16_f32 v177, v178, v179
  v_cvt_pk_bf16_f32 v178, v180, v181
  v_cvt_pk_bf16_f32 v179, v182, v183
  ds_write_b128 v3, v[176:179] offset:8192
  v_max3_f32 v123, abs(v176), abs(v177), v123
  v_max3_f32 v123, abs(v178), abs(v179), v123
  v_pk_mul_f32 v[184:185], v[184:185], v[126:127] op_sel_hi:[1,0]
  v_pk_mul_f32 v[186:187], v[186:187], v[126:127] op_sel_hi:[1,0]
  v_pk_mul_f32 v[188:189], v[188:189], v[126:127] op_sel_hi:[1,0]
  v_pk_mul_f32 v[190:191], v[190:191], v[126:127] op_sel_hi:[1,0]
  v_xor_b32 v2, 96, v27
  v_cvt_pk_bf16_f32 v184, v184, v185
  v_cvt_pk_bf16_f32 v185, v186, v187
  v_cvt_pk_bf16_f32 v186, v188, v189
  v_cvt_pk_bf16_f32 v187, v190, v191
  ds_write_b128 v2, v[184:187] offset:8192
  v_max3_f32 v123, abs(v184), abs(v185), v123
  v_max3_f32 v123, abs(v186), abs(v187), v123
  v_pk_mul_f32 v[208:209], v[208:209], v[126:127] op_sel_hi:[1,0]
  v_pk_mul_f32 v[210:211], v[210:211], v[126:127] op_sel_hi:[1,0]
  v_pk_mul_f32 v[212:213], v[212:213], v[126:127] op_sel_hi:[1,0]
  v_pk_mul_f32 v[214:215], v[214:215], v[126:127] op_sel_hi:[1,0]
  v_xor_b32 v3, 128, v27
  v_cvt_pk_bf16_f32 v208, v208, v209
  v_cvt_pk_bf16_f32 v209, v210, v211
  v_cvt_pk_bf16_f32 v210, v212, v213
  v_cvt_pk_bf16_f32 v211, v214, v215
  ds_write_b128 v3, v[208:211] offset:8192
  v_max3_f32 v123, abs(v208), abs(v209), v123
  v_max3_f32 v123, abs(v210), abs(v211), v123
  v_pk_mul_f32 v[216:217], v[216:217], v[126:127] op_sel_hi:[1,0]
  v_pk_mul_f32 v[218:219], v[218:219], v[126:127] op_sel_hi:[1,0]
  v_pk_mul_f32 v[220:221], v[220:221], v[126:127] op_sel_hi:[1,0]
  v_pk_mul_f32 v[222:223], v[222:223], v[126:127] op_sel_hi:[1,0]
  v_xor_b32 v2, 160, v27
  v_cvt_pk_bf16_f32 v216, v216, v217
  v_cvt_pk_bf16_f32 v217, v218, v219
  v_cvt_pk_bf16_f32 v218, v220, v221
  v_cvt_pk_bf16_f32 v219, v222, v223
  ds_write_b128 v2, v[216:219] offset:8192
  v_max3_f32 v123, abs(v216), abs(v217), v123
  v_max3_f32 v123, abs(v218), abs(v219), v123
  v_pk_mul_f32 v[240:241], v[240:241], v[126:127] op_sel_hi:[1,0]
  v_pk_mul_f32 v[242:243], v[242:243], v[126:127] op_sel_hi:[1,0]
  v_pk_mul_f32 v[244:245], v[244:245], v[126:127] op_sel_hi:[1,0]
  v_pk_mul_f32 v[246:247], v[246:247], v[126:127] op_sel_hi:[1,0]
  v_xor_b32 v3, 192, v27
  v_cvt_pk_bf16_f32 v240, v240, v241
  v_cvt_pk_bf16_f32 v241, v242, v243
  v_cvt_pk_bf16_f32 v242, v244, v245
  v_cvt_pk_bf16_f32 v243, v246, v247
  ds_write_b128 v3, v[240:243] offset:8192
  v_max3_f32 v123, abs(v240), abs(v241), v123
  v_max3_f32 v123, abs(v242), abs(v243), v123
  v_pk_mul_f32 v[248:249], v[248:249], v[126:127] op_sel_hi:[1,0]
  v_pk_mul_f32 v[250:251], v[250:251], v[126:127] op_sel_hi:[1,0]
  v_pk_mul_f32 v[252:253], v[252:253], v[126:127] op_sel_hi:[1,0]
  v_pk_mul_f32 v[254:255], v[254:255], v[126:127] op_sel_hi:[1,0]
  v_xor_b32 v2, 224, v27
  v_cvt_pk_bf16_f32 v248, v248, v249
  v_cvt_pk_bf16_f32 v249, v250, v251
  v_cvt_pk_bf16_f32 v250, v252, v253
  v_cvt_pk_bf16_f32 v251, v254, v255
  ds_write_b128 v2, v[248:251] offset:8192
  v_max3_f32 v123, abs(v248), abs(v249), v123
  v_max3_f32 v123, abs(v250), abs(v251), v123
  v_mfma_f32_16x16x32_bf16 v[32:35], v[112:115], v[128:131], 0
  v_mfma_f32_16x16x32_bf16 v[32:35], v[112:115], v[136:139], v[32:35]
  v_mfma_f32_16x16x32_bf16 v[32:35], v[112:115], v[144:147], v[32:35]
  v_mfma_f32_16x16x32_bf16 v[32:35], v[112:115], v[152:155], v[32:35]
  v_mfma_f32_16x16x32_bf16 v[32:35], v[112:115], v[160:163], v[32:35]
  v_mfma_f32_16x16x32_bf16 v[32:35], v[112:115], v[168:171], v[32:35]
  v_mfma_f32_16x16x32_bf16 v[32:35], v[112:115], v[176:179], v[32:35]
  v_mfma_f32_16x16x32_bf16 v[32:35], v[112:115], v[184:187], v[32:35]
  v_mfma_f32_16x16x32_bf16 v[32:35], v[112:115], v[192:195], v[32:35]
  v_mfma_f32_16x16x32_bf16 v[32:35], v[112:115], v[200:203], v[32:35]
  v_mfma_f32_16x16x32_bf16 v[32:35], v[112:115], v[208:211], v[32:35]
  v_mfma_f32_16x16x32_bf16 v[32:35], v[112:115], v[216:219], v[32:35]
  v_mfma_f32_16x16x32_bf16 v[32:35], v[112:115], v[224:227], v[32:35]
  v_mfma_f32_16x16x32_bf16 v[32:35], v[112:115], v[232:235], v[32:35]
  v_mfma_f32_16x16x32_bf16 v[32:35], v[112:115], v[240:243], v[32:35]
  v_mfma_f32_16x16x32_bf16 v[32:35], v[112:115], v[248:251], v[32:35]
  v_add_u32 v5, 65536, v4
  s_lshl_b32 s50, s44, 2
  s_add_u32 s50, s50, 147456
  v_mov_b32 v2, s50
  v_mul_f32 v122, v122, v21
  v_mul_f32 v123, v123, v22
  v_min_f32 v122, v122, v123
  v_cmp_nle_f32 vcc, 0x04800000, v122
  s_nop 0
  s_mov_b64 s[72:73], vcc
  v_cmp_u_f32 vcc, v32, v32
  s_nop 0
  s_or_b64 vcc, vcc, s[72:73]
  s_cmp_lg_u64 vcc, 0
  s_cselect_b32 s50, 1, 0
  v_mov_b32 v3, s50
  ds_write_b32 v2, v3
  v_mov_b32 v2, 147456
  s_waitcnt vmcnt(7) lgkmcnt(0)
  s_barrier
  ds_read_b128 v[36:39], v2
  ds_read_b128 v[80:83], v6 offset:0
  v_xor_b32 v7, 32, v6
  ds_read_b128 v[84:87], v7 offset:0
  v_xor_b32 v7, 64, v6
  ds_read_b128 v[88:91], v7 offset:0
  s_waitcnt lgkmcnt(3)
  v_or3_b32 v36, v36, v37, v38
  v_or_b32 v36, v36, v39
  s_nop 0
  v_readfirstlane_b32 s50, v36
  s_nop 0
  s_cmp_gt_u32 s50, s60
  s_cbranch_scc1 k2_fb
  s_waitcnt lgkmcnt(2)
  v_mfma_f32_32x32x16_bf16 v[128:143], a[128:131], v[80:83], 0
  ds_read_b64_tr_b16 a[0:1], v4 offset:0
  ds_read_b64_tr_b16 a[2:3], v4 offset:512
  v_xor_b32 v7, 96, v6
  v_mfma_f32_32x32x16_bf16 v[160:175], a[132:135], v[80:83], 0
  ds_read_b128 v[92:95], v7 offset:0
  ds_read_b64_tr_b16 a[4:5], v4 offset:256
  ds_read_b64_tr_b16 a[6:7], v4 offset:768
  s_waitcnt lgkmcnt(6)
  v_mfma_f32_32x32x16_bf16 v[128:143], a[136:139], v[84:87], v[128:143]
  ds_read_b64_tr_b16 a[8:9], v4 offset:2048
  ds_read_b64_tr_b16 a[10:11], v4 offset:2560
  v_xor_b32 v7, 128, v6
  v_mfma_f32_32x32x16_bf16 v[160:175], a[140:143], v[84:87], v[160:175]
  ds_read_b128 v[80:83], v7 offset:0
  ds_read_b64_tr_b16 a[12:13], v4 offset:2304
  ds_read_b64_tr_b16 a[14:15], v4 offset:2816
  s_waitcnt lgkmcnt(10)
  v_mfma_f32_32x32x16_bf16 v[128:143], a[144:147], v[88:91], v[128:143]
  ds_read_b64_tr_b16 a[16:17], v4 offset:16384
  ds_read_b64_tr_b16 a[18:19], v4 offset:16896
  v_xor_b32 v7, 160, v6
  v_mfma_f32_32x32x16_bf16 v[160:175], a[148:151], v[88:91], v[160:175]
  s_barrier
  ds_read_b128 v[84:87], v7 offset:0
  ds_read_b64_tr_b16 a[20:21], v4 offset:16640
  ds_read_b64_tr_b16 a[22:23], v4 offset:17152
  s_waitcnt lgkmcnt(12)
  v_mfma_f32_32x32x16_bf16 v[128:143], a[152:155], v[92:95], v[128:143]
  ds_read_b64_tr_b16 a[24:25], v4 offset:18432
  ds_read_b64_tr_b16 a[26:27], v4 offset:18944
  s_add_u32 m0, s51, 81920
  s_nop 0
  buffer_load_dwordx4 v10, s[32:35], s53 offen lds
  v_xor_b32 v7, 192, v6
  v_mfma_f32_32x32x16_bf16 v[160:175], a[156:159], v[92:95], v[160:175]
  ds_read_b128 v[88:91], v7 offset:0
  ds_read_b64_tr_b16 a[28:29], v4 offset:18688
  ds_read_b64_tr_b16 a[30:31], v4 offset:19200
  s_add_u32 m0, s51, 82944
  s_nop 0
  buffer_load_dwordx4 v11, s[32:35], s53 offen lds
  s_waitcnt lgkmcnt(12)
  v_mfma_f32_32x32x16_bf16 v[128:143], a[160:163], v[80:83], v[128:143]
  ds_read_b64_tr_b16 a[32:33], v4 offset:32768
  ds_read_b64_tr_b16 a[34:35], v4 offset:33280
  s_add_u32 m0, s51, 83968
  s_add_u32 s53, s53, 16384
  buffer_load_dwordx4 v10, s[32:35], s53 offen lds
  v_xor_b32 v7, 224, v6
  v_mfma_f32_32x32x16_bf16 v[160:175], a[164:167], v[80:83], v[160:175]
  ds_read_b128 v[92:95], v7 offset:0
  ds_read_b64_tr_b16 a[36:37], v4 offset:33024
  ds_read_b64_tr_b16 a[38:39], v4 offset:33536
  s_add_u32 m0, s51, 84992
  s_nop 0
  buffer_load_dwordx4 v11, s[32:35], s53 offen lds
  s_add_u32 s53, s53, 16384
  s_waitcnt lgkmcnt(12)
  v_mfma_f32_32x32x16_bf16 v[128:143], a[168:171], v[84:87], v[128:143]
  ds_read_b64_tr_b16 a[40:41], v4 offset:34816
  ds_read_b64_tr_b16 a[42:43], v4 offset:35328
  s_waitcnt vmcnt(10)
  v_accvgpr_read_b32 v112, a64
  v_accvgpr_read_b32 v113, a65
  v_mfma_f32_32x32x16_bf16 v[160:175], a[172:175], v[84:87], v[160:175]
  ds_read_b128 v[80:83], v6 offset:16384
  ds_read_b64_tr_b16 a[44:45], v4 offset:35072
  ds_read_b64_tr_b16 a[46:47], v4 offset:35584
  v_accvgpr_read_b32 v114, a66
  s_waitcnt lgkmcnt(12)
  v_mfma_f32_32x32x16_bf16 v[128:143], a[176:179], v[88:91], v[128:143]
  ds_read_b64_tr_b16 a[48:49], v4 offset:49152
  ds_read_b64_tr_b16 a[50:51], v4 offset:49664
  v_xor_b32 v7, 32, v6
  v_accvgpr_read_b32 v115, a67
  v_mfma_f32_32x32x16_bf16 v[160:175], a[180:183], v[88:91], v[160:175]
  ds_read_b128 v[84:87], v7 offset:16384
  ds_read_b64_tr_b16 a[52:53], v4 offset:49408
  ds_read_b64_tr_b16 a[54:55], v4 offset:49920
  s_waitcnt vmcnt(9)
  v_accvgpr_read_b32 v116, a68
  s_waitcnt lgkmcnt(12)
  v_mfma_f32_32x32x16_bf16 v[128:143], a[184:187], v[92:95], v[128:143]
  ds_read_b64_tr_b16 a[56:57], v4 offset:51200
  ds_read_b64_tr_b16 a[58:59], v4 offset:51712
  s_add_u32 m0, s51, 0
  s_nop 0
  buffer_load_dwordx4 v10, s[32:35], s53 offen lds
  v_xor_b32 v7, 64, v6
  v_mfma_f32_32x32x16_bf16 v[160:175], a[188:191], v[92:95], v[160:175]
  ds_read_b128 v[88:91], v7 offset:16384
  ds_read_b64_tr_b16 a[60:61], v4 offset:51456
  ds_read_b64_tr_b16 a[62:63], v4 offset:51968
  s_add_u32 m0, s51, 1024
  s_nop 0
  buffer_load_dwordx4 v11, s[32:35], s53 offen lds
  s_waitcnt lgkmcnt(12)
  v_mfma_f32_32x32x16_bf16 v[128:143], a[192:195], v[80:83], v[128:143]
  s_add_u32 m0, s51, 2048
  s_add_u32 s53, s53, 16384
  buffer_load_dwordx4 v10, s[32:35], s53 offen lds
  v_xor_b32 v7, 96, v6
  v_mfma_f32_32x32x16_bf16 v[160:175], a[196:199], v[80:83], v[160:175]
  ds_read_b128 v[92:95], v7 offset:16384
  s_add_u32 m0, s51, 3072
  s_nop 0
  buffer_load_dwordx4 v11, s[32:35], s53 offen lds
  s_add_u32 s53, s53, 16384
  s_waitcnt lgkmcnt(8)
  v_mfma_f32_32x32x16_bf16 v[128:143], a[200:203], v[84:87], v[128:143]
  v_xor_b32 v7, 128, v6
  v_accvgpr_read_b32 v117, a69
  v_accvgpr_read_b32 v118, a70
  v_accvgpr_read_b32 v119, a71
  v_mfma_f32_32x32x16_bf16 v[160:175], a[204:207], v[84:87], v[160:175]
  ds_read_b128 v[80:83], v7 offset:16384
  s_waitcnt vmcnt(12)
  v_accvgpr_read_b32 v120, a72
  v_accvgpr_read_b32 v121, a73
  v_accvgpr_read_b32 v122, a74
  s_waitcnt lgkmcnt(4)
  v_mfma_f32_32x32x16_bf16 v[128:143], a[208:211], v[88:91], v[128:143]
  v_xor_b32 v7, 160, v6
  v_accvgpr_read_b32 v123, a75
  s_waitcnt vmcnt(11)
  v_accvgpr_read_b32 v124, a76
  v_mfma_f32_32x32x16_bf16 v[160:175], a[212:215], v[88:91], v[160:175]
  ds_read_b128 v[84:87], v7 offset:16384
  v_accvgpr_read_b32 v125, a77
  v_accvgpr_read_b32 v126, a78
  v_accvgpr_read_b32 v127, a79
  s_waitcnt lgkmcnt(2)
  v_mfma_f32_32x32x16_bf16 v[128:143], a[216:219], v[92:95], v[128:143]
  s_add_u32 m0, s51, 16384
  s_nop 0
  buffer_load_dwordx4 v10, s[32:35], s53 offen lds
  v_xor_b32 v7, 192, v6
  v_mfma_f32_32x32x16_bf16 v[160:175], a[220:223], v[92:95], v[160:175]
  ds_read_b128 v[88:91], v7 offset:16384
  s_add_u32 m0, s51, 17408
  s_nop 0
  buffer_load_dwordx4 v11, s[32:35], s53 offen lds
  s_waitcnt lgkmcnt(2)
  v_mfma_f32_32x32x16_bf16 v[128:143], a[224:227], v[80:83], v[128:143]
  s_add_u32 m0, s51, 18432
  s_add_u32 s53, s53, 16384
  buffer_load_dwordx4 v10, s[32:35], s53 offen lds
  v_xor_b32 v7, 224, v6
  v_mfma_f32_32x32x16_bf16 v[160:175], a[228:231], v[80:83], v[160:175]
  ds_read_b128 v[92:95], v7 offset:16384
  s_add_u32 m0, s51, 19456
  s_nop 0
  buffer_load_dwordx4 v11, s[32:35], s53 offen lds
  s_add_u32 s53, s53, 16384
  s_waitcnt lgkmcnt(2)
  v_mfma_f32_32x32x16_bf16 v[128:143], a[232:235], v[84:87], v[128:143]
  ds_read_b64_tr_b16 a[64:65], v5 offset:0
  ds_read_b64_tr_b16 a[66:67], v5 offset:512
  v_mfma_f32_32x32x16_bf16 v[160:175], a[236:239], v[84:87], v[160:175]
  ds_read_b128 v[80:83], v6 offset:32768
  ds_read_b64_tr_b16 a[68:69], v5 offset:256
  ds_read_b64_tr_b16 a[70:71], v5 offset:768
  s_waitcnt lgkmcnt(6)
  v_mfma_f32_32x32x16_bf16 v[128:143], a[240:243], v[88:91], v[128:143]
  ds_read_b64_tr_b16 a[72:73], v5 offset:2048
  ds_read_b64_tr_b16 a[74:75], v5 offset:2560
  v_xor_b32 v7, 32, v6
  v_mfma_f32_32x32x16_bf16 v[160:175], a[244:247], v[88:91], v[160:175]
  ds_read_b128 v[84:87], v7 offset:32768
  ds_read_b64_tr_b16 a[76:77], v5 offset:2304
  ds_read_b64_tr_b16 a[78:79], v5 offset:2816
  s_waitcnt lgkmcnt(10)
  v_mfma_f32_32x32x16_bf16 v[128:143], a[248:251], v[92:95], v[128:143]
  s_add_u32 m0, s51, 32768
  s_sub_u32 s53, s53, 524160
  buffer_load_dwordx4 v10, s[32:35], s53 offen lds
  v_xor_b32 v7, 64, v6
  v_mfma_f32_32x32x16_bf16 v[160:175], a[252:255], v[92:95], v[160:175]
  ds_read_b128 v[88:91], v7 offset:32768
  s_add_u32 m0, s51, 33792
  s_nop 0
  buffer_load_dwordx4 v11, s[32:35], s53 offen lds
  s_waitcnt lgkmcnt(8)
  v_mfma_f32_32x32x16_bf16 v[128:143], a[0:3], v[80:83], v[128:143]
  s_add_u32 m0, s51, 34816
  s_add_u32 s53, s53, 16384
  buffer_load_dwordx4 v10, s[32:35], s53 offen lds
  s_mov_b32 s24, s8
  v_xor_b32 v7, 96, v6
  v_mfma_f32_32x32x16_bf16 v[160:175], a[4:7], v[80:83], v[160:175]
  ds_read_b128 v[92:95], v7 offset:32768
  s_add_u32 m0, s51, 35840
  s_nop 0
  buffer_load_dwordx4 v11, s[32:35], s53 offen lds
  s_add_u32 s53, s53, 16384
  s_waitcnt lgkmcnt(4)
  v_mfma_f32_32x32x16_bf16 v[128:143], a[8:11], v[84:87], v[128:143]
  s_mov_b32 s25, s9
  s_mov_b32 s26, 0x1c0000
  s_mov_b32 s27, 0x20000
  s_mov_b32 s28, s6
  v_xor_b32 v7, 128, v6
  v_mfma_f32_32x32x16_bf16 v[160:175], a[12:15], v[84:87], v[160:175]
  ds_read_b128 v[80:83], v7 offset:32768
  s_mov_b32 s29, s7
  s_mov_b32 s30, 0xe00
  s_mov_b32 s31, 0x20000
  s_mov_b32 s88, s12
  s_waitcnt lgkmcnt(2)
  v_mfma_f32_32x32x16_bf16 v[128:143], a[16:19], v[88:91], v[128:143]
  s_mov_b32 s89, s13
  s_mov_b32 s90, 0x200000
  s_mov_b32 s91, 0x20000
  v_xor_b32 v7, 160, v6
  v_lshrrev_b32 v8, 5, v1
  v_mfma_f32_32x32x16_bf16 v[160:175], a[20:23], v[88:91], v[160:175]
  ds_read_b128 v[84:87], v7 offset:32768
  v_bfe_u32 v2, v1, 2, 2
  v_lshl_add_u32 v8, v8, 2, v2
  v_bfe_u32 v2, v1, 4, 1
  s_waitcnt lgkmcnt(2)
  v_mfma_f32_32x32x16_bf16 v[128:143], a[24:27], v[92:95], v[128:143]
  s_add_u32 m0, s51, 49152
  s_nop 0
  buffer_load_dwordx4 v10, s[32:35], s53 offen lds
  v_xor_b32 v7, 192, v6
  v_mfma_f32_32x32x16_bf16 v[160:175], a[28:31], v[92:95], v[160:175]
  ds_read_b128 v[88:91], v7 offset:32768
  s_add_u32 m0, s51, 50176
  s_nop 0
  buffer_load_dwordx4 v11, s[32:35], s53 offen lds
  v_and_b32 v9, 3, v1
  s_waitcnt lgkmcnt(2)
  v_mfma_f32_32x32x16_bf16 v[128:143], a[32:35], v[80:83], v[128:143]
  s_add_u32 m0, s51, 51200
  s_add_u32 s53, s53, 16384
  buffer_load_dwordx4 v10, s[32:35], s53 offen lds
  v_xor_b32 v7, 224, v6
  v_lshlrev_b32 v9, 4, v9
  v_mfma_f32_32x32x16_bf16 v[160:175], a[36:39], v[80:83], v[160:175]
  ds_read_b128 v[92:95], v7 offset:32768
  s_add_u32 m0, s51, 52224
  s_nop 0
  buffer_load_dwordx4 v11, s[32:35], s53 offen lds
  s_add_u32 s53, s53, 16384
  s_waitcnt lgkmcnt(2)
  v_mfma_f32_32x32x16_bf16 v[128:143], a[40:43], v[84:87], v[128:143]
  s_waitcnt vmcnt(16)
  ds_read_b64_tr_b16 a[80:81], v5 offset:16384
  ds_read_b64_tr_b16 a[82:83], v5 offset:16896
  s_movk_i32 s50, 3584
  v_lshl_add_u32 v9, v2, 6, v9
  v_mfma_f32_32x32x16_bf16 v[160:175], a[44:47], v[84:87], v[160:175]
  ds_read_b128 v[80:83], v6 offset:49152
  ds_read_b64_tr_b16 a[84:85], v5 offset:16640
  ds_read_b64_tr_b16 a[86:87], v5 offset:17152
  v_mul_lo_u32 v8, v8, s50
  s_waitcnt lgkmcnt(6)
  v_mfma_f32_32x32x16_bf16 v[128:143], a[48:51], v[88:91], v[128:143]
  ds_read_b64_tr_b16 a[88:89], v5 offset:18432
  ds_read_b64_tr_b16 a[90:91], v5 offset:18944
  v_xor_b32 v7, 32, v6
  v_add_u32 v8, v8, v9
  v_mfma_f32_32x32x16_bf16 v[160:175], a[52:55], v[88:91], v[160:175]
  ds_read_b128 v[84:87], v7 offset:49152
  ds_read_b64_tr_b16 a[92:93], v5 offset:18688
  ds_read_b64_tr_b16 a[94:95], v5 offset:19200
  v_add_u32 v9, 28672, v8
  s_waitcnt lgkmcnt(10)
  v_mfma_f32_32x32x16_bf16 v[128:143], a[56:59], v[92:95], v[128:143]
  s_add_u32 m0, s51, 65536
  s_nop 0
  buffer_load_dwordx4 v10, s[32:35], s53 offen lds
  v_xor_b32 v7, 64, v6
  v_mfma_f32_32x32x16_bf16 v[160:175], a[60:63], v[92:95], v[160:175]
  ds_read_b128 v[88:91], v7 offset:49152
  s_add_u32 m0, s51, 66560
  s_nop 0
  buffer_load_dwordx4 v11, s[32:35], s53 offen lds
  s_lshl_b32 s50, s46, 9
  s_waitcnt lgkmcnt(8)
  v_mfma_f32_32x32x16_bf16 v[128:143], a[64:67], v[80:83], v[128:143]
  s_add_u32 m0, s51, 67584
  s_add_u32 s53, s53, 16384
  buffer_load_dwordx4 v10, s[32:35], s53 offen lds
  s_lshl_b32 s52, s44, 7
  v_xor_b32 v7, 96, v6
  v_mfma_f32_32x32x16_bf16 v[160:175], a[68:71], v[80:83], v[160:175]
  ds_read_b128 v[92:95], v7 offset:49152
  s_add_u32 m0, s51, 68608
  s_nop 0
  buffer_load_dwordx4 v11, s[32:35], s53 offen lds
  s_add_u32 s53, s53, 16384
  s_waitcnt lgkmcnt(4)
  v_mfma_f32_32x32x16_bf16 v[128:143], a[72:75], v[84:87], v[128:143]
  s_waitcnt vmcnt(16)
  ds_read_b64_tr_b16 a[96:97], v4 offset:0
  ds_read_b64_tr_b16 a[98:99], v4 offset:512
  s_add_u32 s52, s52, s50
  v_xor_b32 v7, 128, v6
  v_mfma_f32_32x32x16_bf16 v[160:175], a[76:79], v[84:87], v[160:175]
  ds_read_b128 v[80:83], v7 offset:49152
  ds_read_b64_tr_b16 a[100:101], v4 offset:256
  ds_read_b64_tr_b16 a[102:103], v4 offset:768
  s_mov_b32 s57, s52
  s_lshl_b32 s54, s46, 18
  s_waitcnt lgkmcnt(6)
  v_mfma_f32_32x32x16_bf16 v[128:143], a[80:83], v[88:91], v[128:143]
  ds_read_b64_tr_b16 a[104:105], v4 offset:2048
  ds_read_b64_tr_b16 a[106:107], v4 offset:2560
  s_lshl_b32 s50, s44, 8
  v_xor_b32 v7, 160, v6
  v_mfma_f32_32x32x16_bf16 v[160:175], a[84:87], v[88:91], v[160:175]
  ds_read_b128 v[84:87], v7 offset:49152
  ds_read_b64_tr_b16 a[108:109], v4 offset:2304
  ds_read_b64_tr_b16 a[110:111], v4 offset:2816
  s_add_u32 s54, s54, s50
  s_add_u32 s47, s64, 4096
  s_waitcnt lgkmcnt(10)
  v_mfma_f32_32x32x16_bf16 v[128:143], a[88:91], v[92:95], v[128:143]
  s_waitcnt vmcnt(12)
  ds_read_b64_tr_b16 a[112:113], v4 offset:16384
  ds_read_b64_tr_b16 a[114:115], v4 offset:16896
  s_add_u32 m0, s51, 81920
  s_nop 0
  buffer_load_dwordx4 v10, s[32:35], s53 offen lds
  v_xor_b32 v7, 192, v6
  v_mfma_f32_32x32x16_bf16 v[160:175], a[92:95], v[92:95], v[160:175]
  ds_read_b128 v[88:91], v7 offset:49152
  ds_read_b64_tr_b16 a[116:117], v4 offset:16640
  ds_read_b64_tr_b16 a[118:119], v4 offset:17152
  s_add_u32 m0, s51, 82944
  s_nop 0
  buffer_load_dwordx4 v11, s[32:35], s53 offen lds
  s_waitcnt lgkmcnt(5)
  v_mfma_f32_32x32x16_bf16 v[128:143], a[96:99], v[80:83], v[128:143]
  ds_read_b64_tr_b16 a[120:121], v4 offset:18432
  ds_read_b64_tr_b16 a[122:123], v4 offset:18944
  s_add_u32 m0, s51, 83968
  s_add_u32 s53, s53, 16384
  buffer_load_dwordx4 v10, s[32:35], s53 offen lds
  v_xor_b32 v7, 224, v6
  v_mfma_f32_32x32x16_bf16 v[160:175], a[100:103], v[80:83], v[160:175]
  ds_read_b128 v[92:95], v7 offset:49152
  ds_read_b64_tr_b16 a[124:125], v4 offset:18688
  ds_read_b64_tr_b16 a[126:127], v4 offset:19200
  s_add_u32 m0, s51, 84992
  s_nop 0
  buffer_load_dwordx4 v11, s[32:35], s53 offen lds
  s_add_u32 s53, s53, 16384
  v_mfma_f32_32x32x16_bf16 v[128:143], a[104:107], v[84:87], v[128:143]
  v_lshrrev_b32 v2, 5, v1
  v_lshlrev_b32 v13, 4, v2
  v_lshlrev_b32 v14, 6, v2
  v_bfe_u32 v2, v1, 2, 3
  v_mfma_f32_32x32x16_bf16 v[160:175], a[108:111], v[84:87], v[160:175]
  ds_read_b128 v[80:83], v6 offset:8192
  v_lshl_add_u32 v14, v2, 7, v14
  v_and_b32 v12, 3, v0
  v_lshl_add_u32 v14, v12, 4, v14
  s_waitcnt lgkmcnt(1)
  v_mfma_f32_32x32x16_bf16 v[128:143], a[112:115], v[88:91], v[128:143]
  v_xor_b32 v7, 32, v6
  v_lshrrev_b32 v2, 3, v0
  v_lshlrev_b32 v15, 11, v2
  v_and_b32 v2, 7, v0
  v_mfma_f32_32x32x16_bf16 v[160:175], a[116:119], v[88:91], v[160:175]
  ds_read_b128 v[84:87], v7 offset:8192
  s_lshl_b32 s50, s45, 16
  s_lshl_b32 s56, s46, 7
  s_add_u32 s50, s50, s56
  v_lshl_add_u32 v15, v2, 4, v15
  v_mfma_f32_32x32x16_bf16 v[128:143], a[120:123], v[92:95], v[128:143]
  s_add_u32 m0, s51, 0
  s_nop 0
  buffer_load_dwordx4 v10, s[32:35], s53 offen lds
  v_xor_b32 v7, 64, v6
  v_mfma_f32_32x32x16_bf16 v[160:175], a[124:127], v[92:95], v[160:175]
  ds_read_b128 v[88:91], v7 offset:8192
  s_add_u32 m0, s51, 1024
  s_nop 0
  buffer_load_dwordx4 v11, s[32:35], s53 offen lds
  v_add_u32 v15, s50, v15
  s_waitcnt lgkmcnt(2)
  v_mfma_f32_32x32x16_bf16 v[144:159], a[128:131], v[80:83], 0
  s_add_u32 m0, s51, 2048
  s_add_u32 s53, s53, 16384
  buffer_load_dwordx4 v10, s[32:35], s53 offen lds
  v_xor_b32 v7, 96, v6
  v_lshrrev_b32 v2, 2, v0
  v_mfma_f32_32x32x16_bf16 v[176:191], a[132:135], v[80:83], 0
  ds_read_b128 v[92:95], v7 offset:8192
  s_add_u32 m0, s51, 3072
  s_nop 0
  buffer_load_dwordx4 v11, s[32:35], s53 offen lds
  s_add_u32 s53, s53, 16384
  s_waitcnt lgkmcnt(2)
  v_mfma_f32_32x32x16_bf16 v[144:159], a[136:139], v[84:87], v[144:159]
  s_lshl_b32 s50, s46, 2
  v_xor_b32 v7, 128, v6
  v_add_u32 v3, s50, v12
  v_xor_b32 v18, v3, v2
  v_mfma_f32_32x32x16_bf16 v[176:191], a[140:143], v[84:87], v[176:191]
  ds_read_b128 v[80:83], v7 offset:8192
  v_and_b32 v18, 15, v18
  v_lshlrev_b32 v18, 4, v18
  v_lshl_add_u32 v18, v3, 8, v18
  s_waitcnt lgkmcnt(2)
  v_mfma_f32_32x32x16_bf16 v[144:159], a[144:147], v[88:91], v[144:159]
  s_waitcnt vmcnt(16)
  ds_read_b64_tr_b16 a[128:129], v4 offset:32768
  ds_read_b64_tr_b16 a[130:131], v4 offset:33280
  v_xor_b32 v7, 160, v6
  v_lshrrev_b32 v2, 4, v2
  v_mfma_f32_32x32x16_bf16 v[176:191], a[148:151], v[88:91], v[176:191]
  ds_read_b128 v[84:87], v7 offset:8192
  ds_read_b64_tr_b16 a[132:133], v4 offset:33024
  ds_read_b64_tr_b16 a[134:135], v4 offset:33536
  v_lshl_add_u32 v18, v2, 14, v18
  s_waitcnt lgkmcnt(6)
  v_mfma_f32_32x32x16_bf16 v[144:159], a[152:155], v[92:95], v[144:159]
  ds_read_b64_tr_b16 a[136:137], v4 offset:34816
  ds_read_b64_tr_b16 a[138:139], v4 offset:35328
  s_add_u32 m0, s51, 16384
  s_nop 0
  buffer_load_dwordx4 v10, s[32:35], s53 offen lds
  v_xor_b32 v7, 192, v6
  v_mfma_f32_32x32x16_bf16 v[176:191], a[156:159], v[92:95], v[176:191]
  ds_read_b128 v[88:91], v7 offset:8192
  ds_read_b64_tr_b16 a[140:141], v4 offset:35072
  ds_read_b64_tr_b16 a[142:143], v4 offset:35584
  s_add_u32 m0, s51, 17408
  s_nop 0
  buffer_load_dwordx4 v11, s[32:35], s53 offen lds
  s_waitcnt lgkmcnt(10)
  v_mfma_f32_32x32x16_bf16 v[144:159], a[160:163], v[80:83], v[144:159]
  s_add_u32 m0, s51, 18432
  s_add_u32 s53, s53, 16384
  buffer_load_dwordx4 v10, s[32:35], s53 offen lds
  s_lshl_b32 s58, s45, 16
  v_xor_b32 v7, 224, v6
  v_mfma_f32_32x32x16_bf16 v[176:191], a[164:167], v[80:83], v[176:191]
  ds_read_b128 v[92:95], v7 offset:8192
  s_add_u32 m0, s51, 19456
  s_nop 0
  buffer_load_dwordx4 v11, s[32:35], s53 offen lds
  s_add_u32 s53, s53, 16384
  s_waitcnt lgkmcnt(8)
  v_mfma_f32_32x32x16_bf16 v[144:159], a[168:171], v[84:87], v[144:159]
  s_waitcnt vmcnt(16)
  ds_read_b64_tr_b16 a[144:145], v4 offset:49152
  ds_read_b64_tr_b16 a[146:147], v4 offset:49664
  s_add_u32 s58, s58, 3145728
  s_lshl_b32 s50, s44, 3
  v_mfma_f32_32x32x16_bf16 v[176:191], a[172:175], v[84:87], v[176:191]
  ds_read_b128 v[80:83], v6 offset:24576
  ds_read_b64_tr_b16 a[148:149], v4 offset:49408
  ds_read_b64_tr_b16 a[150:151], v4 offset:49920
  v_lshlrev_b32 v19, 5, v12
  s_waitcnt lgkmcnt(8)
  v_mfma_f32_32x32x16_bf16 v[144:159], a[176:179], v[88:91], v[144:159]
  ds_read_b64_tr_b16 a[152:153], v4 offset:51200
  ds_read_b64_tr_b16 a[154:155], v4 offset:51712
  v_xor_b32 v7, 32, v6
  v_add_u32 v21, s50, v19
  v_lshlrev_b32 v24, 2, v1
  v_mfma_f32_32x32x16_bf16 v[176:191], a[180:183], v[88:91], v[176:191]
  ds_read_b128 v[84:87], v7 offset:24576
  ds_read_b64_tr_b16 a[156:157], v4 offset:51456
  ds_read_b64_tr_b16 a[158:159], v4 offset:51968
  s_lshl_b32 s59, s46, 2
  s_waitcnt lgkmcnt(10)
  v_mfma_f32_32x32x16_bf16 v[144:159], a[184:187], v[92:95], v[144:159]
  s_add_u32 m0, s51, 32768
  s_nop 0
  buffer_load_dwordx4 v10, s[32:35], s53 offen lds
  v_xor_b32 v7, 64, v6
  v_mfma_f32_32x32x16_bf16 v[176:191], a[188:191], v[92:95], v[176:191]
  ds_read_b128 v[88:91], v7 offset:24576
  s_add_u32 m0, s51, 33792
  s_nop 0
  buffer_load_dwordx4 v11, s[32:35], s53 offen lds
  s_add_u32 s59, s59, s63
  s_waitcnt lgkmcnt(8)
  v_mfma_f32_32x32x16_bf16 v[144:159], a[192:195], v[80:83], v[144:159]
  s_add_u32 m0, s51, 34816
  s_add_u32 s53, s53, 16384
  buffer_load_dwordx4 v10, s[32:35], s53 offen lds
  v_xor_b32 v7, 96, v6
  v_mfma_f32_32x32x16_bf16 v[176:191], a[196:199], v[80:83], v[176:191]
  ds_read_b128 v[92:95], v7 offset:24576
  s_add_u32 m0, s51, 35840
  s_nop 0
  buffer_load_dwordx4 v11, s[32:35], s53 offen lds
  s_add_u32 s53, s53, 16384
  s_waitcnt lgkmcnt(4)
  v_mfma_f32_32x32x16_bf16 v[144:159], a[200:203], v[84:87], v[144:159]
  s_waitcnt vmcnt(16)
  ds_read_b64_tr_b16 a[160:161], v5 offset:0
  ds_read_b64_tr_b16 a[162:163], v5 offset:512
  v_xor_b32 v7, 128, v6
  v_cvt_pk_bf16_f32 v32, v128, v129
  v_cvt_pk_bf16_f32 v33, v130, v131
  v_mfma_f32_32x32x16_bf16 v[176:191], a[204:207], v[84:87], v[176:191]
  ds_read_b128 v[80:83], v7 offset:24576
  ds_read_b64_tr_b16 a[164:165], v5 offset:256
  ds_read_b64_tr_b16 a[166:167], v5 offset:768
  v_cvt_pk_bf16_f32 v34, v132, v133
  v_cvt_pk_bf16_f32 v35, v134, v135
  s_waitcnt lgkmcnt(6)
  v_mfma_f32_32x32x16_bf16 v[144:159], a[208:211], v[88:91], v[144:159]
  buffer_store_dwordx4 v[32:35], v14, s[40:43], s64 offen offset:0 sc1
  ds_read_b64_tr_b16 a[168:169], v5 offset:2048
  ds_read_b64_tr_b16 a[170:171], v5 offset:2560
  v_xor_b32 v7, 160, v6
  v_cvt_pk_bf16_f32 v36, v136, v137
  v_cvt_pk_bf16_f32 v37, v138, v139
  v_cvt_pk_bf16_f32 v38, v140, v141
  v_mfma_f32_32x32x16_bf16 v[176:191], a[212:215], v[88:91], v[176:191]
  ds_read_b128 v[84:87], v7 offset:24576
  ds_read_b64_tr_b16 a[172:173], v5 offset:2304
  ds_read_b64_tr_b16 a[174:175], v5 offset:2816
  v_cvt_pk_bf16_f32 v39, v142, v143
  v_cvt_pk_bf16_f32 v40, v160, v161
  s_waitcnt lgkmcnt(10)
  v_mfma_f32_32x32x16_bf16 v[144:159], a[216:219], v[92:95], v[144:159]
  buffer_store_dwordx4 v[36:39], v14, s[40:43], s64 offen offset:2048 sc1
  s_add_u32 m0, s51, 49152
  s_nop 0
  buffer_load_dwordx4 v10, s[32:35], s53 offen lds
  v_xor_b32 v7, 192, v6
  v_cvt_pk_bf16_f32 v41, v162, v163
  v_cvt_pk_bf16_f32 v42, v164, v165
  v_mfma_f32_32x32x16_bf16 v[176:191], a[220:223], v[92:95], v[176:191]
  ds_read_b128 v[88:91], v7 offset:24576
  s_add_u32 m0, s51, 50176
  s_nop 0
  buffer_load_dwordx4 v11, s[32:35], s53 offen lds
  v_cvt_pk_bf16_f32 v43, v166, v167
  v_cvt_pk_bf16_f32 v44, v168, v169
  s_waitcnt lgkmcnt(8)
  v_mfma_f32_32x32x16_bf16 v[144:159], a[224:227], v[80:83], v[144:159]
  buffer_store_dwordx4 v[40:43], v14, s[40:43], s47 offen offset:0 sc1
  s_add_u32 m0, s51, 51200
  s_add_u32 s53, s53, 16384
  buffer_load_dwordx4 v10, s[32:35], s53 offen lds
  v_xor_b32 v7, 224, v6
  v_cvt_pk_bf16_f32 v45, v170, v171
  v_cvt_pk_bf16_f32 v46, v172, v173
  v_mfma_f32_32x32x16_bf16 v[176:191], a[228:231], v[80:83], v[176:191]
  ds_read_b128 v[92:95], v7 offset:24576
  s_add_u32 m0, s51, 52224
  s_nop 0
  buffer_load_dwordx4 v11, s[32:35], s53 offen lds
  s_add_u32 s53, s53, 16384
  v_cvt_pk_bf16_f32 v47, v174, v175
  s_waitcnt lgkmcnt(4)
  v_mfma_f32_32x32x16_bf16 v[144:159], a[232:235], v[84:87], v[144:159]
  buffer_store_dwordx4 v[44:47], v14, s[40:43], s47 offen offset:2048 sc1
  s_waitcnt vmcnt(20)
  ds_read_b64_tr_b16 a[176:177], v5 offset:16384
  ds_read_b64_tr_b16 a[178:179], v5 offset:16896
  v_mfma_f32_32x32x16_bf16 v[176:191], a[236:239], v[84:87], v[176:191]
  ds_read_b128 v[80:83], v6 offset:40960
  ds_read_b64_tr_b16 a[180:181], v5 offset:16640
  ds_read_b64_tr_b16 a[182:183], v5 offset:17152
  s_waitcnt lgkmcnt(6)
  v_mfma_f32_32x32x16_bf16 v[144:159], a[240:243], v[88:91], v[144:159]
  ds_read_b64_tr_b16 a[184:185], v5 offset:18432
  ds_read_b64_tr_b16 a[186:187], v5 offset:18944
  v_xor_b32 v7, 32, v6
  v_mfma_f32_32x32x16_bf16 v[176:191], a[244:247], v[88:91], v[176:191]
  ds_read_b128 v[84:87], v7 offset:40960
  ds_read_b64_tr_b16 a[188:189], v5 offset:18688
  ds_read_b64_tr_b16 a[190:191], v5 offset:19200
  s_waitcnt lgkmcnt(10)
  v_mfma_f32_32x32x16_bf16 v[144:159], a[248:251], v[92:95], v[144:159]
  s_add_u32 m0, s51, 65536
  s_nop 0
  buffer_load_dwordx4 v10, s[32:35], s53 offen lds
  v_xor_b32 v7, 64, v6
  v_mfma_f32_32x32x16_bf16 v[176:191], a[252:255], v[92:95], v[176:191]
  ds_read_b128 v[88:91], v7 offset:40960
  s_add_u32 m0, s51, 66560
  s_nop 0
  buffer_load_dwordx4 v11, s[32:35], s53 offen lds
  s_waitcnt lgkmcnt(8)
  v_mfma_f32_32x32x16_bf16 v[144:159], a[0:3], v[80:83], v[144:159]
  s_add_u32 m0, s51, 67584
  s_add_u32 s53, s53, 16384
  buffer_load_dwordx4 v10, s[32:35], s53 offen lds
  v_xor_b32 v7, 96, v6
  v_mfma_f32_32x32x16_bf16 v[176:191], a[4:7], v[80:83], v[176:191]
  ds_read_b128 v[92:95], v7 offset:40960
  s_add_u32 m0, s51, 68608
  s_nop 0
  buffer_load_dwordx4 v11, s[32:35], s53 offen lds
  s_add_u32 s53, s53, 16384
  s_waitcnt lgkmcnt(4)
  v_mfma_f32_32x32x16_bf16 v[144:159], a[8:11], v[84:87], v[144:159]
  s_waitcnt vmcnt(20)
  ds_read_b64_tr_b16 a[192:193], v4 offset:0
  ds_read_b64_tr_b16 a[194:195], v4 offset:512
  v_xor_b32 v7, 128, v6
  v_mfma_f32_32x32x16_bf16 v[176:191], a[12:15], v[84:87], v[176:191]
  ds_read_b128 v[80:83], v7 offset:40960
  ds_read_b64_tr_b16 a[196:197], v4 offset:256
  ds_read_b64_tr_b16 a[198:199], v4 offset:768
  s_waitcnt lgkmcnt(6)
  v_mfma_f32_32x32x16_bf16 v[144:159], a[16:19], v[88:91], v[144:159]
  ds_read_b64_tr_b16 a[200:201], v4 offset:2048
  ds_read_b64_tr_b16 a[202:203], v4 offset:2560
  v_xor_b32 v7, 160, v6
  v_mfma_f32_32x32x16_bf16 v[176:191], a[20:23], v[88:91], v[176:191]
  ds_read_b128 v[84:87], v7 offset:40960
  ds_read_b64_tr_b16 a[204:205], v4 offset:2304
  ds_read_b64_tr_b16 a[206:207], v4 offset:2816
  s_waitcnt lgkmcnt(10)
  v_mfma_f32_32x32x16_bf16 v[144:159], a[24:27], v[92:95], v[144:159]
  s_add_u32 m0, s51, 81920
  s_nop 0
  buffer_load_dwordx4 v10, s[32:35], s53 offen lds
  v_xor_b32 v7, 192, v6
  v_mfma_f32_32x32x16_bf16 v[176:191], a[28:31], v[92:95], v[176:191]
  ds_read_b128 v[88:91], v7 offset:40960
  s_add_u32 m0, s51, 82944
  s_nop 0
  buffer_load_dwordx4 v11, s[32:35], s53 offen lds
  s_waitcnt lgkmcnt(8)
  v_mfma_f32_32x32x16_bf16 v[144:159], a[32:35], v[80:83], v[144:159]
  s_add_u32 m0, s51, 83968
  s_add_u32 s53, s53, 16384
  buffer_load_dwordx4 v10, s[32:35], s53 offen lds
  v_xor_b32 v7, 224, v6
  v_mfma_f32_32x32x16_bf16 v[176:191], a[36:39], v[80:83], v[176:191]
  ds_read_b128 v[92:95], v7 offset:40960
  s_add_u32 m0, s51, 84992
  s_nop 0
  buffer_load_dwordx4 v11, s[32:35], s53 offen lds
  s_add_u32 s53, s53, 16384
  s_waitcnt lgkmcnt(4)
  v_mfma_f32_32x32x16_bf16 v[144:159], a[40:43], v[84:87], v[144:159]
  s_waitcnt vmcnt(20)
  ds_read_b64_tr_b16 a[208:209], v4 offset:16384
  ds_read_b64_tr_b16 a[210:211], v4 offset:16896
  v_mfma_f32_32x32x16_bf16 v[176:191], a[44:47], v[84:87], v[176:191]
  ds_read_b128 v[80:83], v6 offset:57344
  ds_read_b64_tr_b16 a[212:213], v4 offset:16640
  ds_read_b64_tr_b16 a[214:215], v4 offset:17152
  s_waitcnt lgkmcnt(6)
  v_mfma_f32_32x32x16_bf16 v[144:159], a[48:51], v[88:91], v[144:159]
  ds_read_b64_tr_b16 a[216:217], v4 offset:18432
  ds_read_b64_tr_b16 a[218:219], v4 offset:18944
  v_xor_b32 v7, 32, v6
  v_mfma_f32_32x32x16_bf16 v[176:191], a[52:55], v[88:91], v[176:191]
  ds_read_b128 v[84:87], v7 offset:57344
  ds_read_b64_tr_b16 a[220:221], v4 offset:18688
  ds_read_b64_tr_b16 a[222:223], v4 offset:19200
  s_waitcnt lgkmcnt(10)
  v_mfma_f32_32x32x16_bf16 v[144:159], a[56:59], v[92:95], v[144:159]
  s_add_u32 m0, s51, 0
  s_nop 0
  buffer_load_dwordx4 v10, s[32:35], s53 offen lds
  v_xor_b32 v7, 64, v6
  v_mfma_f32_32x32x16_bf16 v[176:191], a[60:63], v[92:95], v[176:191]
  ds_read_b128 v[88:91], v7 offset:57344
  s_add_u32 m0, s51, 1024
  s_nop 0
  buffer_load_dwordx4 v11, s[32:35], s53 offen lds
  s_waitcnt lgkmcnt(8)
  v_mfma_f32_32x32x16_bf16 v[144:159], a[64:67], v[80:83], v[144:159]
  s_add_u32 m0, s51, 2048
  s_add_u32 s53, s53, 16384
  buffer_load_dwordx4 v10, s[32:35], s53 offen lds
  v_xor_b32 v7, 96, v6
  v_mfma_f32_32x32x16_bf16 v[176:191], a[68:71], v[80:83], v[176:191]
  ds_read_b128 v[92:95], v7 offset:57344
  s_add_u32 m0, s51, 3072
  s_nop 0
  buffer_load_dwordx4 v11, s[32:35], s53 offen lds
  s_add_u32 s53, s53, 16384
  s_waitcnt lgkmcnt(4)
  v_mfma_f32_32x32x16_bf16 v[144:159], a[72:75], v[84:87], v[144:159]
  s_waitcnt vmcnt(20)
  ds_read_b64_tr_b16 a[224:225], v4 offset:32768
  ds_read_b64_tr_b16 a[226:227], v4 offset:33280
  v_xor_b32 v7, 128, v6
  v_mfma_f32_32x32x16_bf16 v[176:191], a[76:79], v[84:87], v[176:191]
  ds_read_b128 v[80:83], v7 offset:57344
  ds_read_b64_tr_b16 a[228:229], v4 offset:33024
  ds_read_b64_tr_b16 a[230:231], v4 offset:33536
  s_waitcnt lgkmcnt(6)
  v_mfma_f32_32x32x16_bf16 v[144:159], a[80:83], v[88:91], v[144:159]
  ds_read_b64_tr_b16 a[232:233], v4 offset:34816
  ds_read_b64_tr_b16 a[234:235], v4 offset:35328
  v_xor_b32 v7, 160, v6
  v_mfma_f32_32x32x16_bf16 v[176:191], a[84:87], v[88:91], v[176:191]
  ds_read_b128 v[84:87], v7 offset:57344
  ds_read_b64_tr_b16 a[236:237], v4 offset:35072
  ds_read_b64_tr_b16 a[238:239], v4 offset:35584
  s_waitcnt lgkmcnt(10)
  v_mfma_f32_32x32x16_bf16 v[144:159], a[88:91], v[92:95], v[144:159]
  s_add_u32 m0, s51, 16384
  s_nop 0
  buffer_load_dwordx4 v10, s[32:35], s53 offen lds
  v_xor_b32 v7, 192, v6
  v_mfma_f32_32x32x16_bf16 v[176:191], a[92:95], v[92:95], v[176:191]
  ds_read_b128 v[88:91], v7 offset:57344
  s_add_u32 m0, s51, 17408
  s_nop 0
  buffer_load_dwordx4 v11, s[32:35], s53 offen lds
  s_waitcnt lgkmcnt(8)
  v_mfma_f32_32x32x16_bf16 v[144:159], a[96:99], v[80:83], v[144:159]
  s_add_u32 m0, s51, 18432
  s_add_u32 s53, s53, 16384
  buffer_load_dwordx4 v10, s[32:35], s53 offen lds
  v_xor_b32 v7, 224, v6
  v_mfma_f32_32x32x16_bf16 v[176:191], a[100:103], v[80:83], v[176:191]
  ds_read_b128 v[92:95], v7 offset:57344
  s_add_u32 m0, s51, 19456
  s_nop 0
  buffer_load_dwordx4 v11, s[32:35], s53 offen lds
  s_add_u32 s53, s53, 16384
  s_waitcnt lgkmcnt(4)
  v_mfma_f32_32x32x16_bf16 v[144:159], a[104:107], v[84:87], v[144:159]
  s_waitcnt vmcnt(17)
  ds_read_b64_tr_b16 a[240:241], v4 offset:49152
  ds_read_b64_tr_b16 a[242:243], v4 offset:49664
  v_mfma_f32_32x32x16_bf16 v[176:191], a[108:111], v[84:87], v[176:191]
  ds_read_b128 v[80:83], v6 offset:0
  ds_read_b64_tr_b16 a[244:245], v4 offset:49408
  ds_read_b64_tr_b16 a[246:247], v4 offset:49920
  s_waitcnt lgkmcnt(6)
  v_mfma_f32_32x32x16_bf16 v[144:159], a[112:115], v[88:91], v[144:159]
  ds_read_b64_tr_b16 a[248:249], v4 offset:51200
  ds_read_b64_tr_b16 a[250:251], v4 offset:51712
  v_xor_b32 v7, 32, v6
  v_mfma_f32_32x32x16_bf16 v[176:191], a[116:119], v[88:91], v[176:191]
  ds_read_b128 v[84:87], v7 offset:0
  ds_read_b64_tr_b16 a[252:253], v4 offset:51456
  ds_read_b64_tr_b16 a[254:255], v4 offset:51968
  s_waitcnt lgkmcnt(10)
  v_mfma_f32_32x32x16_bf16 v[144:159], a[120:123], v[92:95], v[144:159]
  s_add_u32 m0, s51, 32768
  s_nop 0
  buffer_load_dwordx4 v10, s[32:35], s53 offen lds
  v_xor_b32 v7, 64, v6
  v_mfma_f32_32x32x16_bf16 v[176:191], a[124:127], v[92:95], v[176:191]
  ds_read_b128 v[88:91], v7 offset:0
  s_add_u32 m0, s51, 33792
  s_nop 0
  buffer_load_dwordx4 v11, s[32:35], s53 offen lds
  s_waitcnt lgkmcnt(8)
  v_mfma_f32_32x32x16_bf16 v[192:207], a[128:131], v[80:83], 0
  s_add_u32 m0, s51, 34816
  s_add_u32 s53, s53, 16384
  buffer_load_dwordx4 v10, s[32:35], s53 offen lds
  v_xor_b32 v7, 96, v6
  v_mfma_f32_32x32x16_bf16 v[224:239], a[132:135], v[80:83], 0
  ds_read_b128 v[92:95], v7 offset:0
  s_add_u32 m0, s51, 35840
  s_nop 0
  buffer_load_dwordx4 v11, s[32:35], s53 offen lds
  s_add_u32 s53, s53, 16384
  s_waitcnt lgkmcnt(4)
  v_mfma_f32_32x32x16_bf16 v[192:207], a[136:139], v[84:87], v[192:207]
  s_waitcnt vmcnt(16)
  ds_read_b64_tr_b16 a[0:1], v5 offset:0
  ds_read_b64_tr_b16 a[2:3], v5 offset:512
  v_xor_b32 v7, 128, v6
  v_mfma_f32_32x32x16_bf16 v[224:239], a[140:143], v[84:87], v[224:239]
  ds_read_b128 v[80:83], v7 offset:0
  ds_read_b64_tr_b16 a[4:5], v5 offset:256
  ds_read_b64_tr_b16 a[6:7], v5 offset:768
  s_waitcnt lgkmcnt(6)
  v_mfma_f32_32x32x16_bf16 v[192:207], a[144:147], v[88:91], v[192:207]
  ds_read_b64_tr_b16 a[8:9], v5 offset:2048
  ds_read_b64_tr_b16 a[10:11], v5 offset:2560
  v_xor_b32 v7, 160, v6
  v_cvt_pk_bf16_f32 v32, v144, v145
  v_cvt_pk_bf16_f32 v33, v146, v147
  v_cvt_pk_bf16_f32 v34, v148, v149
  v_mfma_f32_32x32x16_bf16 v[224:239], a[148:151], v[88:91], v[224:239]
  ds_read_b128 v[84:87], v7 offset:0
  ds_read_b64_tr_b16 a[12:13], v5 offset:2304
  ds_read_b64_tr_b16 a[14:15], v5 offset:2816
  v_cvt_pk_bf16_f32 v35, v150, v151
  v_cvt_pk_bf16_f32 v36, v152, v153
  s_waitcnt lgkmcnt(10)
  v_mfma_f32_32x32x16_bf16 v[192:207], a[152:155], v[92:95], v[192:207]
  buffer_store_dwordx4 v[32:35], v14, s[40:43], s64 offen offset:1024 sc1
  s_add_u32 m0, s51, 49152
  s_nop 0
  buffer_load_dwordx4 v10, s[32:35], s53 offen lds
  v_xor_b32 v7, 192, v6
  v_cvt_pk_bf16_f32 v37, v154, v155
  v_cvt_pk_bf16_f32 v38, v156, v157
  v_mfma_f32_32x32x16_bf16 v[224:239], a[156:159], v[92:95], v[224:239]
  ds_read_b128 v[88:91], v7 offset:0
  s_add_u32 m0, s51, 50176
  s_nop 0
  buffer_load_dwordx4 v11, s[32:35], s53 offen lds
  v_cvt_pk_bf16_f32 v39, v158, v159
  v_cvt_pk_bf16_f32 v40, v176, v177
  s_waitcnt lgkmcnt(8)
  v_mfma_f32_32x32x16_bf16 v[192:207], a[160:163], v[80:83], v[192:207]
  buffer_store_dwordx4 v[36:39], v14, s[40:43], s64 offen offset:3072 sc1
  s_add_u32 m0, s51, 51200
  s_add_u32 s53, s53, 16384
  buffer_load_dwordx4 v10, s[32:35], s53 offen lds
  v_xor_b32 v7, 224, v6
  v_cvt_pk_bf16_f32 v41, v178, v179
  v_cvt_pk_bf16_f32 v42, v180, v181
  v_mfma_f32_32x32x16_bf16 v[224:239], a[164:167], v[80:83], v[224:239]
  ds_read_b128 v[92:95], v7 offset:0
  s_add_u32 m0, s51, 52224
  s_nop 0
  buffer_load_dwordx4 v11, s[32:35], s53 offen lds
  s_add_u32 s53, s53, 16384
  v_cvt_pk_bf16_f32 v43, v182, v183
  s_waitcnt lgkmcnt(4)
  v_mfma_f32_32x32x16_bf16 v[192:207], a[168:171], v[84:87], v[192:207]
  buffer_store_dwordx4 v[40:43], v14, s[40:43], s47 offen offset:1024 sc1
  s_waitcnt vmcnt(19)
  ds_read_b64_tr_b16 a[16:17], v5 offset:16384
  ds_read_b64_tr_b16 a[18:19], v5 offset:16896
  v_cvt_pk_bf16_f32 v44, v184, v185
  v_cvt_pk_bf16_f32 v45, v186, v187
  v_cvt_pk_bf16_f32 v46, v188, v189
  v_mfma_f32_32x32x16_bf16 v[224:239], a[172:175], v[84:87], v[224:239]
  ds_read_b128 v[80:83], v6 offset:16384
  ds_read_b64_tr_b16 a[20:21], v5 offset:16640
  ds_read_b64_tr_b16 a[22:23], v5 offset:17152
  v_cvt_pk_bf16_f32 v47, v190, v191
  s_waitcnt lgkmcnt(6)
  v_mfma_f32_32x32x16_bf16 v[192:207], a[176:179], v[88:91], v[192:207]
  buffer_store_dwordx4 v[44:47], v14, s[40:43], s47 offen offset:3072 sc1
  s_add_u32 s64, s64, 8192
  s_add_u32 s47, s47, 8192
  ds_read_b64_tr_b16 a[24:25], v5 offset:18432
  ds_read_b64_tr_b16 a[26:27], v5 offset:18944
  v_xor_b32 v7, 32, v6
  v_mfma_f32_32x32x16_bf16 v[224:239], a[180:183], v[88:91], v[224:239]
  ds_read_b128 v[84:87], v7 offset:16384
  ds_read_b64_tr_b16 a[28:29], v5 offset:18688
  ds_read_b64_tr_b16 a[30:31], v5 offset:19200
  s_waitcnt lgkmcnt(10)
  v_mfma_f32_32x32x16_bf16 v[192:207], a[184:187], v[92:95], v[192:207]
  s_add_u32 m0, s51, 65536
  s_nop 0
  buffer_load_dwordx4 v10, s[32:35], s53 offen lds
  v_xor_b32 v7, 64, v6
  v_mfma_f32_32x32x16_bf16 v[224:239], a[188:191], v[92:95], v[224:239]
  ds_read_b128 v[88:91], v7 offset:16384
  s_add_u32 m0, s51, 66560
  s_nop 0
  buffer_load_dwordx4 v11, s[32:35], s53 offen lds
  s_waitcnt lgkmcnt(8)
  v_mfma_f32_32x32x16_bf16 v[192:207], a[192:195], v[80:83], v[192:207]
  s_add_u32 m0, s51, 67584
  s_add_u32 s53, s53, 16384
  buffer_load_dwordx4 v10, s[32:35], s53 offen lds
  v_xor_b32 v7, 96, v6
  v_mfma_f32_32x32x16_bf16 v[224:239], a[196:199], v[80:83], v[224:239]
  ds_read_b128 v[92:95], v7 offset:16384
  s_add_u32 m0, s51, 68608
  s_nop 0
  buffer_load_dwordx4 v11, s[32:35], s53 offen lds
  s_add_u32 s53, s53, 16384
  s_waitcnt lgkmcnt(4)
  v_mfma_f32_32x32x16_bf16 v[192:207], a[200:203], v[84:87], v[192:207]
  s_waitcnt vmcnt(20)
  ds_read_b64_tr_b16 a[32:33], v4 offset:0
  ds_read_b64_tr_b16 a[34:35], v4 offset:512
  v_xor_b32 v7, 128, v6
  v_mfma_f32_32x32x16_bf16 v[224:239], a[204:207], v[84:87], v[224:239]
  ds_read_b128 v[80:83], v7 offset:16384
  ds_read_b64_tr_b16 a[36:37], v4 offset:256
  ds_read_b64_tr_b16 a[38:39], v4 offset:768
  s_waitcnt lgkmcnt(6)
  v_mfma_f32_32x32x16_bf16 v[192:207], a[208:211], v[88:91], v[192:207]
  ds_read_b64_tr_b16 a[40:41], v4 offset:2048
  ds_read_b64_tr_b16 a[42:43], v4 offset:2560
  v_xor_b32 v7, 160, v6
  v_mfma_f32_32x32x16_bf16 v[224:239], a[212:215], v[88:91], v[224:239]
  ds_read_b128 v[84:87], v7 offset:16384
  ds_read_b64_tr_b16 a[44:45], v4 offset:2304
  ds_read_b64_tr_b16 a[46:47], v4 offset:2816
  s_waitcnt lgkmcnt(10)
  v_mfma_f32_32x32x16_bf16 v[192:207], a[216:219], v[92:95], v[192:207]
  s_add_u32 m0, s51, 81920
  s_nop 0
  buffer_load_dwordx4 v10, s[32:35], s53 offen lds
  v_xor_b32 v7, 192, v6
  v_mfma_f32_32x32x16_bf16 v[224:239], a[220:223], v[92:95], v[224:239]
  ds_read_b128 v[88:91], v7 offset:16384
  s_add_u32 m0, s51, 82944
  s_nop 0
  buffer_load_dwordx4 v11, s[32:35], s53 offen lds
  s_waitcnt lgkmcnt(8)
  v_mfma_f32_32x32x16_bf16 v[192:207], a[224:227], v[80:83], v[192:207]
  s_add_u32 m0, s51, 83968
  s_add_u32 s53, s53, 16384
  buffer_load_dwordx4 v10, s[32:35], s53 offen lds
  v_xor_b32 v7, 224, v6
  v_mfma_f32_32x32x16_bf16 v[224:239], a[228:231], v[80:83], v[224:239]
  ds_read_b128 v[92:95], v7 offset:16384
  s_add_u32 m0, s51, 84992
  s_nop 0
  buffer_load_dwordx4 v11, s[32:35], s53 offen lds
  s_add_u32 s53, s53, 16384
  s_waitcnt lgkmcnt(4)
  v_mfma_f32_32x32x16_bf16 v[192:207], a[232:235], v[84:87], v[192:207]
  s_waitcnt vmcnt(20)
  ds_read_b64_tr_b16 a[48:49], v4 offset:16384
  ds_read_b64_tr_b16 a[50:51], v4 offset:16896
  v_mfma_f32_32x32x16_bf16 v[224:239], a[236:239], v[84:87], v[224:239]
  ds_read_b128 v[80:83], v6 offset:32768
  ds_read_b64_tr_b16 a[52:53], v4 offset:16640
  ds_read_b64_tr_b16 a[54:55], v4 offset:17152
  s_waitcnt lgkmcnt(6)
  v_mfma_f32_32x32x16_bf16 v[192:207], a[240:243], v[88:91], v[192:207]
  ds_read_b64_tr_b16 a[56:57], v4 offset:18432
  ds_read_b64_tr_b16 a[58:59], v4 offset:18944
  v_xor_b32 v7, 32, v6
  v_mfma_f32_32x32x16_bf16 v[224:239], a[244:247], v[88:91], v[224:239]
  ds_read_b128 v[84:87], v7 offset:32768
  ds_read_b64_tr_b16 a[60:61], v4 offset:18688
  ds_read_b64_tr_b16 a[62:63], v4 offset:19200
  s_waitcnt lgkmcnt(10)
  v_mfma_f32_32x32x16_bf16 v[192:207], a[248:251], v[92:95], v[192:207]
  s_add_u32 m0, s51, 0
  s_nop 0
  buffer_load_dwordx4 v8, s[20:23], s52 offen lds
  v_xor_b32 v7, 64, v6
  v_mfma_f32_32x32x16_bf16 v[224:239], a[252:255], v[92:95], v[224:239]
  ds_read_b128 v[88:91], v7 offset:32768
  s_add_u32 m0, s51, 1024
  s_nop 0
  buffer_load_dwordx4 v9, s[20:23], s52 offen lds
  s_waitcnt lgkmcnt(8)
  v_mfma_f32_32x32x16_bf16 v[192:207], a[0:3], v[80:83], v[192:207]
  s_add_u32 m0, s51, 2048
  s_add_u32 s52, s52, 57344
  buffer_load_dwordx4 v8, s[20:23], s52 offen lds
  v_xor_b32 v7, 96, v6
  v_mfma_f32_32x32x16_bf16 v[224:239], a[4:7], v[80:83], v[224:239]
  ds_read_b128 v[92:95], v7 offset:32768
  s_add_u32 m0, s51, 3072
  s_nop 0
  buffer_load_dwordx4 v9, s[20:23], s52 offen lds
  s_add_u32 s52, s52, 57344
  s_waitcnt lgkmcnt(4)
  v_mfma_f32_32x32x16_bf16 v[192:207], a[8:11], v[84:87], v[192:207]
  s_waitcnt vmcnt(20)
  ds_read_b64_tr_b16 a[64:65], v4 offset:32768
  ds_read_b64_tr_b16 a[66:67], v4 offset:33280
  v_xor_b32 v7, 128, v6
  v_mfma_f32_32x32x16_bf16 v[224:239], a[12:15], v[84:87], v[224:239]
  ds_read_b128 v[80:83], v7 offset:32768
  ds_read_b64_tr_b16 a[68:69], v4 offset:33024
  ds_read_b64_tr_b16 a[70:71], v4 offset:33536
  s_waitcnt lgkmcnt(6)
  v_mfma_f32_32x32x16_bf16 v[192:207], a[16:19], v[88:91], v[192:207]
  ds_read_b64_tr_b16 a[72:73], v4 offset:34816
  ds_read_b64_tr_b16 a[74:75], v4 offset:35328
  v_xor_b32 v7, 160, v6
  v_mfma_f32_32x32x16_bf16 v[224:239], a[20:23], v[88:91], v[224:239]
  ds_read_b128 v[84:87], v7 offset:32768
  ds_read_b64_tr_b16 a[76:77], v4 offset:35072
  ds_read_b64_tr_b16 a[78:79], v4 offset:35584
  s_waitcnt lgkmcnt(10)
  v_mfma_f32_32x32x16_bf16 v[192:207], a[24:27], v[92:95], v[192:207]
  s_add_u32 m0, s51, 16384
  s_nop 0
  buffer_load_dwordx4 v8, s[20:23], s52 offen lds
  v_xor_b32 v7, 192, v6
  v_mfma_f32_32x32x16_bf16 v[224:239], a[28:31], v[92:95], v[224:239]
  ds_read_b128 v[88:91], v7 offset:32768
  s_add_u32 m0, s51, 17408
  s_nop 0
  buffer_load_dwordx4 v9, s[20:23], s52 offen lds
  s_waitcnt lgkmcnt(8)
  v_mfma_f32_32x32x16_bf16 v[192:207], a[32:35], v[80:83], v[192:207]
  s_add_u32 m0, s51, 18432
  s_add_u32 s52, s52, 57344
  buffer_load_dwordx4 v8, s[20:23], s52 offen lds
  v_xor_b32 v7, 224, v6
  v_mfma_f32_32x32x16_bf16 v[224:239], a[36:39], v[80:83], v[224:239]
  ds_read_b128 v[92:95], v7 offset:32768
  s_add_u32 m0, s51, 19456
  s_nop 0
  buffer_load_dwordx4 v9, s[20:23], s52 offen lds
  s_add_u32 s52, s52, 57344
  s_waitcnt lgkmcnt(4)
  v_mfma_f32_32x32x16_bf16 v[192:207], a[40:43], v[84:87], v[192:207]
  s_waitcnt vmcnt(18)
  ds_read_b64_tr_b16 a[80:81], v4 offset:49152
  ds_read_b64_tr_b16 a[82:83], v4 offset:49664
  v_mfma_f32_32x32x16_bf16 v[224:239], a[44:47], v[84:87], v[224:239]
  ds_read_b128 v[80:83], v6 offset:49152
  ds_read_b64_tr_b16 a[84:85], v4 offset:49408
  ds_read_b64_tr_b16 a[86:87], v4 offset:49920
  s_waitcnt lgkmcnt(6)
  v_mfma_f32_32x32x16_bf16 v[192:207], a[48:51], v[88:91], v[192:207]
  ds_read_b64_tr_b16 a[88:89], v4 offset:51200
  ds_read_b64_tr_b16 a[90:91], v4 offset:51712
  v_xor_b32 v7, 32, v6
  v_mfma_f32_32x32x16_bf16 v[224:239], a[52:55], v[88:91], v[224:239]
  ds_read_b128 v[84:87], v7 offset:49152
  ds_read_b64_tr_b16 a[92:93], v4 offset:51456
  ds_read_b64_tr_b16 a[94:95], v4 offset:51968
  s_waitcnt lgkmcnt(10)
  v_mfma_f32_32x32x16_bf16 v[192:207], a[56:59], v[92:95], v[192:207]
  s_add_u32 m0, s51, 32768
  s_nop 0
  buffer_load_dwordx4 v8, s[20:23], s52 offen lds
  v_xor_b32 v7, 64, v6
  v_mfma_f32_32x32x16_bf16 v[224:239], a[60:63], v[92:95], v[224:239]
  ds_read_b128 v[88:91], v7 offset:49152
  s_add_u32 m0, s51, 33792
  s_nop 0
  buffer_load_dwordx4 v9, s[20:23], s52 offen lds
  s_waitcnt lgkmcnt(8)
  v_mfma_f32_32x32x16_bf16 v[192:207], a[64:67], v[80:83], v[192:207]
  s_add_u32 m0, s51, 34816
  s_add_u32 s52, s52, 57344
  buffer_load_dwordx4 v8, s[20:23], s52 offen lds
  v_xor_b32 v7, 96, v6
  v_mfma_f32_32x32x16_bf16 v[224:239], a[68:71], v[80:83], v[224:239]
  ds_read_b128 v[92:95], v7 offset:49152
  s_add_u32 m0, s51, 35840
  s_nop 0
  buffer_load_dwordx4 v9, s[20:23], s52 offen lds
  s_add_u32 s52, s52, 57344
  s_waitcnt lgkmcnt(4)
  v_mfma_f32_32x32x16_bf16 v[192:207], a[72:75], v[84:87], v[192:207]
  s_waitcnt vmcnt(16)
  ds_read_b64_tr_b16 a[96:97], v5 offset:0
  ds_read_b64_tr_b16 a[98:99], v5 offset:512
  v_xor_b32 v7, 128, v6
  v_mfma_f32_32x32x16_bf16 v[224:239], a[76:79], v[84:87], v[224:239]
  ds_read_b128 v[80:83], v7 offset:49152
  ds_read_b64_tr_b16 a[100:101], v5 offset:256
  ds_read_b64_tr_b16 a[102:103], v5 offset:768
  s_waitcnt lgkmcnt(6)
  v_mfma_f32_32x32x16_bf16 v[192:207], a[80:83], v[88:91], v[192:207]
  ds_read_b64_tr_b16 a[104:105], v5 offset:2048
  ds_read_b64_tr_b16 a[106:107], v5 offset:2560
  v_xor_b32 v7, 160, v6
  v_mfma_f32_32x32x16_bf16 v[224:239], a[84:87], v[88:91], v[224:239]
  ds_read_b128 v[84:87], v7 offset:49152
  ds_read_b64_tr_b16 a[108:109], v5 offset:2304
  ds_read_b64_tr_b16 a[110:111], v5 offset:2816
  s_waitcnt lgkmcnt(10)
  v_mfma_f32_32x32x16_bf16 v[192:207], a[88:91], v[92:95], v[192:207]
  s_waitcnt vmcnt(12)
  ds_read_b64_tr_b16 a[112:113], v5 offset:16384
  ds_read_b64_tr_b16 a[114:115], v5 offset:16896
  s_add_u32 m0, s51, 49152
  s_nop 0
  buffer_load_dwordx4 v8, s[20:23], s52 offen lds
  v_xor_b32 v7, 192, v6
  v_mfma_f32_32x32x16_bf16 v[224:239], a[92:95], v[92:95], v[224:239]
  ds_read_b128 v[88:91], v7 offset:49152
  ds_read_b64_tr_b16 a[116:117], v5 offset:16640
  ds_read_b64_tr_b16 a[118:119], v5 offset:17152
  s_add_u32 m0, s51, 50176
  s_nop 0
  buffer_load_dwordx4 v9, s[20:23], s52 offen lds
  s_waitcnt lgkmcnt(5)
  v_mfma_f32_32x32x16_bf16 v[192:207], a[96:99], v[80:83], v[192:207]
  ds_read_b64_tr_b16 a[120:121], v5 offset:18432
  ds_read_b64_tr_b16 a[122:123], v5 offset:18944
  s_add_u32 m0, s51, 51200
  s_add_u32 s52, s52, 57344
  buffer_load_dwordx4 v8, s[20:23], s52 offen lds
  v_xor_b32 v7, 224, v6
  v_mfma_f32_32x32x16_bf16 v[224:239], a[100:103], v[80:83], v[224:239]
  ds_read_b128 v[92:95], v7 offset:49152
  ds_read_b64_tr_b16 a[124:125], v5 offset:18688
  ds_read_b64_tr_b16 a[126:127], v5 offset:19200
  s_add_u32 m0, s51, 52224
  s_nop 0
  buffer_load_dwordx4 v9, s[20:23], s52 offen lds
  s_add_u32 s52, s52, 57344
  v_mfma_f32_32x32x16_bf16 v[192:207], a[104:107], v[84:87], v[192:207]
  v_mfma_f32_32x32x16_bf16 v[224:239], a[108:111], v[84:87], v[224:239]
  ds_read_b128 v[80:83], v6 offset:8192
  s_waitcnt lgkmcnt(1)
  v_mfma_f32_32x32x16_bf16 v[192:207], a[112:115], v[88:91], v[192:207]
  v_xor_b32 v7, 32, v6
  v_mfma_f32_32x32x16_bf16 v[224:239], a[116:119], v[88:91], v[224:239]
  ds_read_b128 v[84:87], v7 offset:8192
  v_mfma_f32_32x32x16_bf16 v[192:207], a[120:123], v[92:95], v[192:207]
  s_add_u32 m0, s51, 65536
  s_nop 0
  buffer_load_dwordx4 v8, s[20:23], s52 offen lds
  v_xor_b32 v7, 64, v6
  v_mfma_f32_32x32x16_bf16 v[224:239], a[124:127], v[92:95], v[224:239]
  ds_read_b128 v[88:91], v7 offset:8192
  s_add_u32 m0, s51, 66560
  s_nop 0
  buffer_load_dwordx4 v9, s[20:23], s52 offen lds
  s_waitcnt lgkmcnt(2)
  v_mfma_f32_32x32x16_bf16 v[208:223], a[128:131], v[80:83], 0
  s_add_u32 m0, s51, 67584
  s_add_u32 s52, s52, 57344
  buffer_load_dwordx4 v8, s[20:23], s52 offen lds
  v_xor_b32 v7, 96, v6
  v_mfma_f32_32x32x16_bf16 v[240:255], a[132:135], v[80:83], 0
  ds_read_b128 v[92:95], v7 offset:8192
  s_add_u32 m0, s51, 68608
  s_nop 0
  buffer_load_dwordx4 v9, s[20:23], s52 offen lds
  s_add_u32 s52, s52, 57344
  s_waitcnt lgkmcnt(2)
  v_mfma_f32_32x32x16_bf16 v[208:223], a[136:139], v[84:87], v[208:223]
  v_xor_b32 v7, 128, v6
  v_cvt_pk_bf16_f32 v32, v192, v193
  v_cvt_pk_bf16_f32 v33, v194, v195
  v_cvt_pk_bf16_f32 v34, v196, v197
  v_mfma_f32_32x32x16_bf16 v[240:255], a[140:143], v[84:87], v[240:255]
  ds_read_b128 v[80:83], v7 offset:8192
  v_cvt_pk_bf16_f32 v35, v198, v199
  v_cvt_pk_bf16_f32 v36, v200, v201
  v_cvt_pk_bf16_f32 v37, v202, v203
  s_waitcnt lgkmcnt(2)
  v_mfma_f32_32x32x16_bf16 v[208:223], a[144:147], v[88:91], v[208:223]
  buffer_store_dwordx4 v[32:35], v14, s[40:43], s64 offen offset:0 sc1
  s_waitcnt vmcnt(17)
  ds_read_b64_tr_b16 a[128:129], v4 offset:0
  ds_read_b64_tr_b16 a[130:131], v4 offset:512
  v_xor_b32 v7, 160, v6
  v_cvt_pk_bf16_f32 v38, v204, v205
  v_mfma_f32_32x32x16_bf16 v[240:255], a[148:151], v[88:91], v[240:255]
  ds_read_b128 v[84:87], v7 offset:8192
  ds_read_b64_tr_b16 a[132:133], v4 offset:256
  ds_read_b64_tr_b16 a[134:135], v4 offset:768
  v_cvt_pk_bf16_f32 v39, v206, v207
  s_waitcnt lgkmcnt(6)
  v_mfma_f32_32x32x16_bf16 v[208:223], a[152:155], v[92:95], v[208:223]
  buffer_store_dwordx4 v[36:39], v14, s[40:43], s64 offen offset:2048 sc1
  ds_read_b64_tr_b16 a[136:137], v4 offset:2048
  ds_read_b64_tr_b16 a[138:139], v4 offset:2560
  v_xor_b32 v7, 192, v6
  v_cvt_pk_bf16_f32 v40, v224, v225
  v_mfma_f32_32x32x16_bf16 v[240:255], a[156:159], v[92:95], v[240:255]
  ds_read_b128 v[88:91], v7 offset:8192
  ds_read_b64_tr_b16 a[140:141], v4 offset:2304
  ds_read_b64_tr_b16 a[142:143], v4 offset:2816
  v_cvt_pk_bf16_f32 v41, v226, v227
  v_cvt_pk_bf16_f32 v42, v228, v229
  s_waitcnt lgkmcnt(10)
  v_mfma_f32_32x32x16_bf16 v[208:223], a[160:163], v[80:83], v[208:223]
  v_xor_b32 v7, 224, v6
  v_cvt_pk_bf16_f32 v43, v230, v231
  v_cvt_pk_bf16_f32 v44, v232, v233
  v_cvt_pk_bf16_f32 v45, v234, v235
  v_mfma_f32_32x32x16_bf16 v[240:255], a[164:167], v[80:83], v[240:255]
  buffer_store_dwordx4 v[40:43], v14, s[40:43], s47 offen offset:0 sc1
  ds_read_b128 v[92:95], v7 offset:8192
  v_cvt_pk_bf16_f32 v46, v236, v237
  v_cvt_pk_bf16_f32 v47, v238, v239
  s_waitcnt lgkmcnt(8)
  v_mfma_f32_32x32x16_bf16 v[208:223], a[168:171], v[84:87], v[208:223]
  buffer_store_dwordx4 v[44:47], v14, s[40:43], s47 offen offset:2048 sc1
  s_waitcnt vmcnt(16)
  ds_read_b64_tr_b16 a[144:145], v4 offset:16384
  ds_read_b64_tr_b16 a[146:147], v4 offset:16896
  v_mfma_f32_32x32x16_bf16 v[240:255], a[172:175], v[84:87], v[240:255]
  ds_read_b128 v[80:83], v6 offset:24576
  ds_read_b64_tr_b16 a[148:149], v4 offset:16640
  ds_read_b64_tr_b16 a[150:151], v4 offset:17152
  s_waitcnt lgkmcnt(8)
  v_mfma_f32_32x32x16_bf16 v[208:223], a[176:179], v[88:91], v[208:223]
  ds_read_b64_tr_b16 a[152:153], v4 offset:18432
  ds_read_b64_tr_b16 a[154:155], v4 offset:18944
  v_xor_b32 v7, 32, v6
  v_mfma_f32_32x32x16_bf16 v[240:255], a[180:183], v[88:91], v[240:255]
  ds_read_b128 v[84:87], v7 offset:24576
  ds_read_b64_tr_b16 a[156:157], v4 offset:18688
  ds_read_b64_tr_b16 a[158:159], v4 offset:19200
  s_waitcnt lgkmcnt(10)
  v_mfma_f32_32x32x16_bf16 v[208:223], a[184:187], v[92:95], v[208:223]
  v_xor_b32 v7, 64, v6
  v_mfma_f32_32x32x16_bf16 v[240:255], a[188:191], v[92:95], v[240:255]
  ds_read_b128 v[88:91], v7 offset:24576
  s_waitcnt lgkmcnt(8)
  v_mfma_f32_32x32x16_bf16 v[208:223], a[192:195], v[80:83], v[208:223]
  v_xor_b32 v7, 96, v6
  v_mfma_f32_32x32x16_bf16 v[240:255], a[196:199], v[80:83], v[240:255]
  ds_read_b128 v[92:95], v7 offset:24576
  s_waitcnt lgkmcnt(4)
  v_mfma_f32_32x32x16_bf16 v[208:223], a[200:203], v[84:87], v[208:223]
  s_waitcnt vmcnt(12)
  ds_read_b64_tr_b16 a[160:161], v4 offset:32768
  ds_read_b64_tr_b16 a[162:163], v4 offset:33280
  v_xor_b32 v7, 128, v6
  v_mfma_f32_32x32x16_bf16 v[240:255], a[204:207], v[84:87], v[240:255]
  ds_read_b128 v[80:83], v7 offset:24576
  ds_read_b64_tr_b16 a[164:165], v4 offset:33024
  ds_read_b64_tr_b16 a[166:167], v4 offset:33536
  s_waitcnt lgkmcnt(6)
  v_mfma_f32_32x32x16_bf16 v[208:223], a[208:211], v[88:91], v[208:223]
  ds_read_b64_tr_b16 a[168:169], v4 offset:34816
  ds_read_b64_tr_b16 a[170:171], v4 offset:35328
  v_xor_b32 v7, 160, v6
  v_mfma_f32_32x32x16_bf16 v[240:255], a[212:215], v[88:91], v[240:255]
  ds_read_b128 v[84:87], v7 offset:24576
  ds_read_b64_tr_b16 a[172:173], v4 offset:35072
  ds_read_b64_tr_b16 a[174:175], v4 offset:35584
  s_waitcnt lgkmcnt(10)
  v_mfma_f32_32x32x16_bf16 v[208:223], a[216:219], v[92:95], v[208:223]
  v_xor_b32 v7, 192, v6
  v_mfma_f32_32x32x16_bf16 v[240:255], a[220:223], v[92:95], v[240:255]
  ds_read_b128 v[88:91], v7 offset:24576
  s_waitcnt lgkmcnt(8)
  v_mfma_f32_32x32x16_bf16 v[208:223], a[224:227], v[80:83], v[208:223]
  v_xor_b32 v7, 224, v6
  v_mfma_f32_32x32x16_bf16 v[240:255], a[228:231], v[80:83], v[240:255]
  ds_read_b128 v[92:95], v7 offset:24576
  s_waitcnt lgkmcnt(4)
  v_mfma_f32_32x32x16_bf16 v[208:223], a[232:235], v[84:87], v[208:223]
  s_waitcnt vmcnt(8)
  ds_read_b64_tr_b16 a[176:177], v4 offset:49152
  ds_read_b64_tr_b16 a[178:179], v4 offset:49664
  v_mfma_f32_32x32x16_bf16 v[240:255], a[236:239], v[84:87], v[240:255]
  ds_read_b128 v[80:83], v6 offset:40960
  ds_read_b64_tr_b16 a[180:181], v4 offset:49408
  ds_read_b64_tr_b16 a[182:183], v4 offset:49920
  s_waitcnt lgkmcnt(6)
  v_mfma_f32_32x32x16_bf16 v[208:223], a[240:243], v[88:91], v[208:223]
  ds_read_b64_tr_b16 a[184:185], v4 offset:51200
  ds_read_b64_tr_b16 a[186:187], v4 offset:51712
  v_xor_b32 v7, 32, v6
  v_mfma_f32_32x32x16_bf16 v[240:255], a[244:247], v[88:91], v[240:255]
  ds_read_b128 v[84:87], v7 offset:40960
  ds_read_b64_tr_b16 a[188:189], v4 offset:51456
  ds_read_b64_tr_b16 a[190:191], v4 offset:51968
  s_waitcnt lgkmcnt(10)
  v_mfma_f32_32x32x16_bf16 v[208:223], a[248:251], v[92:95], v[208:223]
  v_xor_b32 v7, 64, v6
  v_mfma_f32_32x32x16_bf16 v[240:255], a[252:255], v[92:95], v[240:255]
  ds_read_b128 v[88:91], v7 offset:40960
  s_waitcnt lgkmcnt(8)
  v_mfma_f32_32x32x16_bf16 v[208:223], a[0:3], v[80:83], v[208:223]
  v_xor_b32 v7, 96, v6
  v_mfma_f32_32x32x16_bf16 v[240:255], a[4:7], v[80:83], v[240:255]
  ds_read_b128 v[92:95], v7 offset:40960
  s_waitcnt lgkmcnt(4)
  v_mfma_f32_32x32x16_bf16 v[208:223], a[8:11], v[84:87], v[208:223]
  s_waitcnt vmcnt(4)
  ds_read_b64_tr_b16 a[192:193], v5 offset:0
  ds_read_b64_tr_b16 a[194:195], v5 offset:512
  v_xor_b32 v7, 128, v6
  v_mfma_f32_32x32x16_bf16 v[240:255], a[12:15], v[84:87], v[240:255]
  ds_read_b128 v[80:83], v7 offset:40960
  ds_read_b64_tr_b16 a[196:197], v5 offset:256
  ds_read_b64_tr_b16 a[198:199], v5 offset:768
  s_waitcnt lgkmcnt(6)
  v_mfma_f32_32x32x16_bf16 v[208:223], a[16:19], v[88:91], v[208:223]
  ds_read_b64_tr_b16 a[200:201], v5 offset:2048
  ds_read_b64_tr_b16 a[202:203], v5 offset:2560
  v_xor_b32 v7, 160, v6
  v_mfma_f32_32x32x16_bf16 v[240:255], a[20:23], v[88:91], v[240:255]
  ds_read_b128 v[84:87], v7 offset:40960
  ds_read_b64_tr_b16 a[204:205], v5 offset:2304
  ds_read_b64_tr_b16 a[206:207], v5 offset:2816
  s_waitcnt lgkmcnt(10)
  v_mfma_f32_32x32x16_bf16 v[208:223], a[24:27], v[92:95], v[208:223]
  v_xor_b32 v7, 192, v6
  v_mfma_f32_32x32x16_bf16 v[240:255], a[28:31], v[92:95], v[240:255]
  ds_read_b128 v[88:91], v7 offset:40960
  s_waitcnt lgkmcnt(8)
  v_mfma_f32_32x32x16_bf16 v[208:223], a[32:35], v[80:83], v[208:223]
  v_xor_b32 v7, 224, v6
  v_mfma_f32_32x32x16_bf16 v[240:255], a[36:39], v[80:83], v[240:255]
  ds_read_b128 v[92:95], v7 offset:40960
  s_waitcnt lgkmcnt(4)
  v_mfma_f32_32x32x16_bf16 v[208:223], a[40:43], v[84:87], v[208:223]
  v_mfma_f32_32x32x16_bf16 v[240:255], a[44:47], v[84:87], v[240:255]
  ds_read_b128 v[80:83], v6 offset:57344
  s_waitcnt lgkmcnt(2)
  v_mfma_f32_32x32x16_bf16 v[208:223], a[48:51], v[88:91], v[208:223]
  v_xor_b32 v7, 32, v6
  v_mfma_f32_32x32x16_bf16 v[240:255], a[52:55], v[88:91], v[240:255]
  ds_read_b128 v[84:87], v7 offset:57344
  s_waitcnt lgkmcnt(2)
  v_mfma_f32_32x32x16_bf16 v[208:223], a[56:59], v[92:95], v[208:223]
  s_waitcnt vmcnt(0)
  s_barrier
  s_add_u32 s50, s59, 0
  s_mov_b64 exec, s[68:69]
  buffer_store_dword v29, v28, s[36:39], s50 offen sc1
  s_mov_b64 exec, -1
  v_xor_b32 v7, 64, v6
  v_mfma_f32_32x32x16_bf16 v[240:255], a[60:63], v[92:95], v[240:255]
  ds_read_b128 v[88:91], v7 offset:57344
  s_waitcnt lgkmcnt(2)
  v_mfma_f32_32x32x16_bf16 v[208:223], a[64:67], v[80:83], v[208:223]
  v_xor_b32 v7, 96, v6
  v_mfma_f32_32x32x16_bf16 v[240:255], a[68:71], v[80:83], v[240:255]
  ds_read_b128 v[92:95], v7 offset:57344
  s_waitcnt lgkmcnt(2)
  v_mfma_f32_32x32x16_bf16 v[208:223], a[72:75], v[84:87], v[208:223]
  v_xor_b32 v7, 128, v6
  v_mfma_f32_32x32x16_bf16 v[240:255], a[76:79], v[84:87], v[240:255]
  ds_read_b128 v[80:83], v7 offset:57344
  s_waitcnt lgkmcnt(2)
  v_mfma_f32_32x32x16_bf16 v[208:223], a[80:83], v[88:91], v[208:223]
  v_xor_b32 v7, 160, v6
  v_mfma_f32_32x32x16_bf16 v[240:255], a[84:87], v[88:91], v[240:255]
  ds_read_b128 v[84:87], v7 offset:57344
  s_waitcnt lgkmcnt(2)
  v_mfma_f32_32x32x16_bf16 v[208:223], a[88:91], v[92:95], v[208:223]
  v_xor_b32 v7, 192, v6
  v_mfma_f32_32x32x16_bf16 v[240:255], a[92:95], v[92:95], v[240:255]
  ds_read_b128 v[88:91], v7 offset:57344
  s_waitcnt lgkmcnt(2)
  v_mfma_f32_32x32x16_bf16 v[208:223], a[96:99], v[80:83], v[208:223]
  v_xor_b32 v7, 224, v6
  v_mfma_f32_32x32x16_bf16 v[240:255], a[100:103], v[80:83], v[240:255]
  ds_read_b128 v[92:95], v7 offset:57344
  s_waitcnt lgkmcnt(2)
  v_mfma_f32_32x32x16_bf16 v[208:223], a[104:107], v[84:87], v[208:223]
  v_mfma_f32_32x32x16_bf16 v[240:255], a[108:111], v[84:87], v[240:255]
  s_add_u32 s50, s63, 0
  s_mov_b64 exec, 0xff
  buffer_load_dword v30, v24, s[36:39], s50 offen sc1
  s_mov_b64 exec, -1
  s_waitcnt lgkmcnt(1)
  v_mfma_f32_32x32x16_bf16 v[208:223], a[112:115], v[88:91], v[208:223]
  v_mfma_f32_32x32x16_bf16 v[240:255], a[116:119], v[88:91], v[240:255]
  s_waitcnt lgkmcnt(0)
  v_mfma_f32_32x32x16_bf16 v[208:223], a[120:123], v[92:95], v[208:223]
  v_mfma_f32_32x32x16_bf16 v[240:255], a[124:127], v[92:95], v[240:255]
  s_nop 3
  v_cvt_pk_bf16_f32 v32, v208, v209
  v_cvt_pk_bf16_f32 v33, v210, v211
  v_cvt_pk_bf16_f32 v34, v212, v213
  v_cvt_pk_bf16_f32 v35, v214, v215
  buffer_store_dwordx4 v[32:35], v14, s[40:43], s64 offen offset:1024 sc1
  v_cvt_pk_bf16_f32 v36, v216, v217
  v_cvt_pk_bf16_f32 v37, v218, v219
  v_cvt_pk_bf16_f32 v38, v220, v221
  v_cvt_pk_bf16_f32 v39, v222, v223
  buffer_store_dwordx4 v[36:39], v14, s[40:43], s64 offen offset:3072 sc1
  v_cvt_pk_bf16_f32 v40, v240, v241
  v_cvt_pk_bf16_f32 v41, v242, v243
  v_cvt_pk_bf16_f32 v42, v244, v245
  v_cvt_pk_bf16_f32 v43, v246, v247
  buffer_store_dwordx4 v[40:43], v14, s[40:43], s47 offen offset:1024 sc1
  v_cvt_pk_bf16_f32 v44, v248, v249
  v_cvt_pk_bf16_f32 v45, v250, v251
  v_cvt_pk_bf16_f32 v46, v252, v253
  v_cvt_pk_bf16_f32 v47, v254, v255
  buffer_store_dwordx4 v[44:47], v14, s[40:43], s47 offen offset:3072 sc1
  v_lshlrev_b32 v192, 16, v112
  v_and_b32 v193, 0xffff0000, v112
  v_lshlrev_b32 v194, 16, v113
  v_and_b32 v195, 0xffff0000, v113
  v_lshlrev_b32 v196, 16, v114
  v_and_b32 v197, 0xffff0000, v114
  v_lshlrev_b32 v198, 16, v115
  v_and_b32 v199, 0xffff0000, v115
  v_lshlrev_b32 v200, 16, v116
  v_and_b32 v201, 0xffff0000, v116
  v_lshlrev_b32 v202, 16, v117
  v_and_b32 v203, 0xffff0000, v117
  v_lshlrev_b32 v204, 16, v118
  v_and_b32 v205, 0xffff0000, v118
  v_lshlrev_b32 v206, 16, v119
  v_and_b32 v207, 0xffff0000, v119
  v_lshlrev_b32 v208, 16, v120
  v_and_b32 v209, 0xffff0000, v120
  v_lshlrev_b32 v210, 16, v121
  v_and_b32 v211, 0xffff0000, v121
  v_lshlrev_b32 v212, 16, v122
  v_and_b32 v213, 0xffff0000, v122
  v_lshlrev_b32 v214, 16, v123
  v_and_b32 v215, 0xffff0000, v123
  v_mov_b32 v7, 0x3f803f80
  buffer_load_dwordx4 v[64:67], v13, s[28:31], s57 offen offset:0
  buffer_load_dwordx4 v[68:71], v13, s[28:31], s57 offen offset:32
  buffer_load_dwordx4 v[72:75], v13, s[28:31], s57 offen offset:64
  buffer_load_dwordx4 v[76:79], v13, s[28:31], s57 offen offset:96
  s_mov_b64 exec, 0xff
  s_waitcnt vmcnt(8)
  v_cmp_ne_u32 vcc, 1, v30
  s_mov_b64 exec, -1
  s_cmp_eq_u64 vcc, 0
  s_cbranch_scc1 k2_rk0
  s_add_u32 s56, s63, 0
  s_mov_b32 s50, 0
  s_mov_b64 exec, 0xff
k2_ap0:
  buffer_load_dword v3, v24, s[36:39], s56 offen sc1
  s_add_u32 s50, s50, 1
  s_waitcnt vmcnt(0)
  v_cmp_ne_u32 vcc, 1, v3
  s_cmp_gt_u32 s50, 0x80000
  s_cbranch_scc1 k2_ad0
  s_nop 2
  s_cbranch_vccnz k2_ap0
k2_ad0:
  s_mov_b64 exec, -1
k2_rk0:
  s_mov_b32 s50, 0x0
  buffer_load_dwordx4 v[128:131], v15, s[40:43], s50 offen offset:0 sc1
  s_mov_b32 s50, 0x200000
  buffer_load_dwordx4 v[132:135], v15, s[40:43], s50 offen offset:0 sc1
  s_mov_b32 s50, 0x400000
  buffer_load_dwordx4 v[136:139], v15, s[40:43], s50 offen offset:0 sc1
  s_mov_b32 s50, 0x600000
  buffer_load_dwordx4 v[140:143], v15, s[40:43], s50 offen offset:0 sc1
  s_mov_b32 s50, 0x800000
  buffer_load_dwordx4 v[144:147], v15, s[40:43], s50 offen offset:0 sc1
  s_mov_b32 s50, 0xa00000
  buffer_load_dwordx4 v[148:151], v15, s[40:43], s50 offen offset:0 sc1
  s_mov_b32 s50, 0xc00000
  buffer_load_dwordx4 v[152:155], v15, s[40:43], s50 offen offset:0 sc1
  s_mov_b32 s50, 0xe00000
  buffer_load_dwordx4 v[156:159], v15, s[40:43], s50 offen offset:0 sc1
  s_waitcnt vmcnt(12)
  s_barrier
  s_add_u32 s50, s59, 4096
  s_mov_b64 exec, s[68:69]
  buffer_store_dword v29, v28, s[36:39], s50 offen sc1
  s_mov_b64 exec, -1
  s_waitcnt lgkmcnt(0)
  s_add_u32 m0, s51, 81920
  s_nop 0
  buffer_load_dwordx4 v8, s[20:23], s52 offen lds
  s_add_u32 m0, s51, 82944
  s_nop 0
  buffer_load_dwordx4 v9, s[20:23], s52 offen lds
  s_add_u32 m0, s51, 83968
  s_add_u32 s52, s52, 57344
  buffer_load_dwordx4 v8, s[20:23], s52 offen lds
  s_add_u32 m0, s51, 84992
  s_nop 0
  buffer_load_dwordx4 v9, s[20:23], s52 offen lds
  s_add_u32 s52, s52, 57344
  s_add_u32 m0, s51, 0
  s_nop 0
  buffer_load_dwordx4 v8, s[20:23], s52 offen lds
  s_add_u32 m0, s51, 1024
  s_nop 0
  buffer_load_dwordx4 v9, s[20:23], s52 offen lds
  s_add_u32 m0, s51, 2048
  s_add_u32 s52, s52, 57344
  buffer_load_dwordx4 v8, s[20:23], s52 offen lds
  s_add_u32 m0, s51, 3072
  s_nop 0
  buffer_load_dwordx4 v9, s[20:23], s52 offen lds
  s_add_u32 s52, s52, 57344
  s_add_u32 m0, s51, 16384
  s_nop 0
  buffer_load_dwordx4 v8, s[20:23], s52 offen lds
  s_add_u32 m0, s51, 17408
  s_nop 0
  buffer_load_dwordx4 v9, s[20:23], s52 offen lds
  s_add_u32 m0, s51, 18432
  s_add_u32 s52, s52, 57344
  buffer_load_dwordx4 v8, s[20:23], s52 offen lds
  s_add_u32 m0, s51, 19456
  s_nop 0
  buffer_load_dwordx4 v9, s[20:23], s52 offen lds
  s_add_u32 s52, s52, 57344
  s_add_u32 m0, s51, 32768
  s_nop 0
  buffer_load_dwordx4 v8, s[20:23], s52 offen lds
  s_add_u32 m0, s51, 33792
  s_nop 0
  buffer_load_dwordx4 v9, s[20:23], s52 offen lds
  s_add_u32 m0, s51, 34816
  s_add_u32 s52, s52, 57344
  buffer_load_dwordx4 v8, s[20:23], s52 offen lds
  s_add_u32 m0, s51, 35840
  s_nop 0
  buffer_load_dwordx4 v9, s[20:23], s52 offen lds
  s_add_u32 s52, s52, 57344
  s_add_u32 m0, s51, 49152
  s_nop 0
  buffer_load_dwordx4 v8, s[20:23], s52 offen lds
  s_add_u32 m0, s51, 50176
  s_nop 0
  buffer_load_dwordx4 v9, s[20:23], s52 offen lds
  s_add_u32 m0, s51, 51200
  s_add_u32 s52, s52, 57344
  buffer_load_dwordx4 v8, s[20:23], s52 offen lds
  s_add_u32 m0, s51, 52224
  s_nop 0
  buffer_load_dwordx4 v9, s[20:23], s52 offen lds
  s_add_u32 s52, s52, 57344
  s_add_u32 m0, s51, 65536
  s_nop 0
  buffer_load_dwordx4 v8, s[20:23], s52 offen lds
  s_add_u32 m0, s51, 66560
  s_nop 0
  buffer_load_dwordx4 v9, s[20:23], s52 offen lds
  s_add_u32 m0, s51, 67584
  s_add_u32 s52, s52, 57344
  buffer_load_dwordx4 v8, s[20:23], s52 offen lds
  s_add_u32 m0, s51, 68608
  s_nop 0
  buffer_load_dwordx4 v9, s[20:23], s52 offen lds
  s_add_u32 s52, s52, 57344
  v_lshlrev_b32 v216, 16, v96
  v_and_b32 v217, 0xffff0000, v96
  v_lshlrev_b32 v218, 16, v97
  v_and_b32 v219, 0xffff0000, v97
  v_lshlrev_b32 v220, 16, v98
  v_and_b32 v221, 0xffff0000, v98
  v_lshlrev_b32 v222, 16, v99
  v_and_b32 v223, 0xffff0000, v99
  s_waitcnt vmcnt(32)
  v_lshlrev_b32 v32, 16, v128
  v_and_b32 v33, 0xffff0000, v128
  v_lshlrev_b32 v34, 16, v129
  v_and_b32 v35, 0xffff0000, v129
  v_lshlrev_b32 v36, 16, v130
  v_and_b32 v37, 0xffff0000, v130
  v_lshlrev_b32 v38, 16, v131
  v_and_b32 v39, 0xffff0000, v131
  s_waitcnt vmcnt(31)
  v_lshlrev_b32 v48, 16, v132
  v_and_b32 v49, 0xffff0000, v132
  v_pk_add_f32 v[32:33], v[32:33], v[48:49]
  v_lshlrev_b32 v50, 16, v133
  v_and_b32 v51, 0xffff0000, v133
  v_pk_add_f32 v[34:35], v[34:35], v[50:51]
  v_lshlrev_b32 v52, 16, v134
  v_and_b32 v53, 0xffff0000, v134
  v_pk_add_f32 v[36:37], v[36:37], v[52:53]
  v_lshlrev_b32 v54, 16, v135
  v_and_b32 v55, 0xffff0000, v135
  v_pk_add_f32 v[38:39], v[38:39], v[54:55]
  s_waitcnt vmcnt(30)
  v_lshlrev_b32 v48, 16, v136
  v_and_b32 v49, 0xffff0000, v136
  v_pk_add_f32 v[32:33], v[32:33], v[48:49]
  v_lshlrev_b32 v50, 16, v137
  v_and_b32 v51, 0xffff0000, v137
  v_pk_add_f32 v[34:35], v[34:35], v[50:51]
  v_lshlrev_b32 v52, 16, v138
  v_and_b32 v53, 0xffff0000, v138
  v_pk_add_f32 v[36:37], v[36:37], v[52:53]
  v_lshlrev_b32 v54, 16, v139
  v_and_b32 v55, 0xffff0000, v139
  v_pk_add_f32 v[38:39], v[38:39], v[54:55]
  s_waitcnt vmcnt(29)
  v_lshlrev_b32 v48, 16, v140
  v_and_b32 v49, 0xffff0000, v140
  v_pk_add_f32 v[32:33], v[32:33], v[48:49]
  v_lshlrev_b32 v50, 16, v141
  v_and_b32 v51, 0xffff0000, v141
  v_pk_add_f32 v[34:35], v[34:35], v[50:51]
  v_lshlrev_b32 v52, 16, v142
  v_and_b32 v53, 0xffff0000, v142
  v_pk_add_f32 v[36:37], v[36:37], v[52:53]
  v_lshlrev_b32 v54, 16, v143
  v_and_b32 v55, 0xffff0000, v143
  v_pk_add_f32 v[38:39], v[38:39], v[54:55]
  s_waitcnt vmcnt(28)
  v_lshlrev_b32 v48, 16, v144
  v_and_b32 v49, 0xffff0000, v144
  v_pk_add_f32 v[32:33], v[32:33], v[48:49]
  v_lshlrev_b32 v50, 16, v145
  v_and_b32 v51, 0xffff0000, v145
  v_pk_add_f32 v[34:35], v[34:35], v[50:51]
  v_lshlrev_b32 v52, 16, v146
  v_and_b32 v53, 0xffff0000, v146
  v_pk_add_f32 v[36:37], v[36:37], v[52:53]
  v_lshlrev_b32 v54, 16, v147
  v_and_b32 v55, 0xffff0000, v147
  v_pk_add_f32 v[38:39], v[38:39], v[54:55]
  s_waitcnt vmcnt(27)
  v_lshlrev_b32 v48, 16, v148
  v_and_b32 v49, 0xffff0000, v148
  v_pk_add_f32 v[32:33], v[32:33], v[48:49]
  v_lshlrev_b32 v50, 16, v149
  v_and_b32 v51, 0xffff0000, v149
  v_pk_add_f32 v[34:35], v[34:35], v[50:51]
  v_lshlrev_b32 v52, 16, v150
  v_and_b32 v53, 0xffff0000, v150
  v_pk_add_f32 v[36:37], v[36:37], v[52:53]
  v_lshlrev_b32 v54, 16, v151
  v_and_b32 v55, 0xffff0000, v151
  v_pk_add_f32 v[38:39], v[38:39], v[54:55]
  s_waitcnt vmcnt(26)
  v_lshlrev_b32 v48, 16, v152
  v_and_b32 v49, 0xffff0000, v152
  v_pk_add_f32 v[32:33], v[32:33], v[48:49]
  v_lshlrev_b32 v50, 16, v153
  v_and_b32 v51, 0xffff0000, v153
  v_pk_add_f32 v[34:35], v[34:35], v[50:51]
  v_lshlrev_b32 v52, 16, v154
  v_and_b32 v53, 0xffff0000, v154
  v_pk_add_f32 v[36:37], v[36:37], v[52:53]
  v_lshlrev_b32 v54, 16, v155
  v_and_b32 v55, 0xffff0000, v155
  v_pk_add_f32 v[38:39], v[38:39], v[54:55]
  s_waitcnt vmcnt(25)
  v_lshlrev_b32 v48, 16, v156
  v_and_b32 v49, 0xffff0000, v156
  v_pk_add_f32 v[32:33], v[32:33], v[48:49]
  v_lshlrev_b32 v50, 16, v157
  v_and_b32 v51, 0xffff0000, v157
  v_pk_add_f32 v[34:35], v[34:35], v[50:51]
  v_lshlrev_b32 v52, 16, v158
  v_and_b32 v53, 0xffff0000, v158
  v_pk_add_f32 v[36:37], v[36:37], v[52:53]
  v_lshlrev_b32 v54, 16, v159
  v_and_b32 v55, 0xffff0000, v159
  v_pk_add_f32 v[38:39], v[38:39], v[54:55]
  v_cvt_pk_bf16_f32 v48, v32, v33
  v_cvt_pk_bf16_f32 v49, v34, v35
  v_cvt_pk_bf16_f32 v50, v36, v37
  v_cvt_pk_bf16_f32 v51, v38, v39
  v_lshlrev_b32 v32, 16, v48
  v_and_b32 v33, 0xffff0000, v48
  v_lshlrev_b32 v34, 16, v49
  v_and_b32 v35, 0xffff0000, v49
  v_lshlrev_b32 v36, 16, v50
  v_and_b32 v37, 0xffff0000, v50
  v_lshlrev_b32 v38, 16, v51
  v_and_b32 v39, 0xffff0000, v51
  v_pk_mul_f32 v[32:33], v[32:33], v[192:193]
  v_pk_mul_f32 v[34:35], v[34:35], v[194:195]
  v_pk_mul_f32 v[36:37], v[36:37], v[196:197]
  v_pk_mul_f32 v[38:39], v[38:39], v[198:199]
  v_cvt_pk_bf16_f32 v48, v32, v33
  v_cvt_pk_bf16_f32 v49, v34, v35
  v_cvt_pk_bf16_f32 v50, v36, v37
  v_cvt_pk_bf16_f32 v51, v38, v39
  v_lshlrev_b32 v32, 16, v48
  v_and_b32 v33, 0xffff0000, v48
  v_lshlrev_b32 v34, 16, v49
  v_and_b32 v35, 0xffff0000, v49
  v_lshlrev_b32 v36, 16, v50
  v_and_b32 v37, 0xffff0000, v50
  v_lshlrev_b32 v38, 16, v51
  v_and_b32 v39, 0xffff0000, v51
  v_pk_add_f32 v[32:33], v[32:33], v[216:217]
  v_pk_add_f32 v[34:35], v[34:35], v[218:219]
  v_pk_add_f32 v[36:37], v[36:37], v[220:221]
  v_pk_add_f32 v[38:39], v[38:39], v[222:223]
  v_cvt_pk_bf16_f32 v96, v32, v33
  v_cvt_pk_bf16_f32 v97, v34, v35
  v_cvt_pk_bf16_f32 v98, v36, v37
  v_cvt_pk_bf16_f32 v99, v38, v39
  v_dot2_f32_bf16 v22, v96, v7, 0
  v_dot2_f32_bf16 v23, v96, v96, 0
  v_dot2_f32_bf16 v22, v97, v7, v22
  v_dot2_f32_bf16 v23, v97, v97, v23
  v_dot2_f32_bf16 v22, v98, v7, v22
  v_dot2_f32_bf16 v23, v98, v98, v23
  v_dot2_f32_bf16 v22, v99, v7, v22
  v_dot2_f32_bf16 v23, v99, v99, v23
  v_lshlrev_b32 v32, 16, v96
  v_and_b32 v33, 0xffff0000, v96
  v_lshlrev_b32 v34, 16, v97
  v_and_b32 v35, 0xffff0000, v97
  v_lshlrev_b32 v36, 16, v98
  v_and_b32 v37, 0xffff0000, v98
  v_lshlrev_b32 v38, 16, v99
  v_and_b32 v39, 0xffff0000, v99
  v_add_f32 v22, v22, v22 row_ror:4 row_mask:0xf bank_mask:0xf
  v_add_f32 v23, v23, v23 row_ror:4 row_mask:0xf bank_mask:0xf
  s_nop 0
  v_add_f32 v22, v22, v22 row_ror:8 row_mask:0xf bank_mask:0xf
  v_add_f32 v23, v23, v23 row_ror:8 row_mask:0xf bank_mask:0xf
  v_mov_b32 v228, v22
  v_mov_b32 v229, v23
  s_nop 0
  v_permlane16_swap_b32 v228, v22
  v_permlane16_swap_b32 v229, v23
  v_add_f32 v22, v22, v228
  v_add_f32 v23, v23, v229
  v_mov_b32 v228, v22
  v_mov_b32 v229, v23
  s_nop 0
  v_permlane32_swap_b32 v228, v22
  v_permlane32_swap_b32 v229, v23
  v_add_f32 v22, v22, v228
  v_add_f32 v23, v23, v229
  ds_write_b64 v21, v[22:23] offset:8192
  s_waitcnt lgkmcnt(0)
  s_barrier
  ds_read_b128 v[228:231], v19 offset:8192
  ds_read_b128 v[232:235], v19 offset:8208
  s_add_u32 s50, s63, 4096
  s_mov_b64 exec, 0xff
  buffer_load_dword v30, v24, s[36:39], s50 offen sc1
  s_mov_b64 exec, -1
  s_waitcnt lgkmcnt(1)
  v_pk_add_f32 v[228:229], v[228:229], v[230:231]
  s_waitcnt lgkmcnt(0)
  v_pk_add_f32 v[232:233], v[232:233], v[234:235]
  v_pk_add_f32 v[228:229], v[228:229], v[232:233]
  v_mul_f32 v224, 0x3b000000, v228
  v_mul_f32 v230, v224, v228
  v_sub_f32 v226, v229, v230
  v_max_f32 v226, 0, v226
  v_mul_f32 v226, 0x3b000000, v226
  v_cvt_pk_bf16_f32 v226, v226, v226
  v_lshlrev_b32 v226, 16, v226
  v_add_f32 v226, 0x3727c5ac, v226
  v_cvt_pk_bf16_f32 v226, v226, v226
  v_lshlrev_b32 v226, 16, v226
  v_sqrt_f32 v226, v226
  s_nop 0
  v_cvt_pk_bf16_f32 v226, v226, v226
  v_lshlrev_b32 v226, 16, v226
  v_rcp_f32 v226, v226
  v_cvt_pk_bf16_f32 v224, v224, v224
  v_lshlrev_b32 v224, 16, v224
  v_pk_add_f32 v[32:33], v[32:33], v[224:225] op_sel_hi:[1,0] neg_lo:[0,1] neg_hi:[0,1]
  v_pk_add_f32 v[34:35], v[34:35], v[224:225] op_sel_hi:[1,0] neg_lo:[0,1] neg_hi:[0,1]
  v_pk_add_f32 v[36:37], v[36:37], v[224:225] op_sel_hi:[1,0] neg_lo:[0,1] neg_hi:[0,1]
  v_pk_add_f32 v[38:39], v[38:39], v[224:225] op_sel_hi:[1,0] neg_lo:[0,1] neg_hi:[0,1]
  v_cvt_pk_bf16_f32 v48, v32, v33
  v_cvt_pk_bf16_f32 v49, v34, v35
  v_cvt_pk_bf16_f32 v50, v36, v37
  v_cvt_pk_bf16_f32 v51, v38, v39
  v_lshlrev_b32 v32, 16, v48
  v_and_b32 v33, 0xffff0000, v48
  v_lshlrev_b32 v34, 16, v49
  v_and_b32 v35, 0xffff0000, v49
  v_lshlrev_b32 v36, 16, v50
  v_and_b32 v37, 0xffff0000, v50
  v_lshlrev_b32 v38, 16, v51
  v_and_b32 v39, 0xffff0000, v51
  v_pk_mul_f32 v[32:33], v[32:33], v[226:227] op_sel_hi:[1,0]
  v_pk_mul_f32 v[34:35], v[34:35], v[226:227] op_sel_hi:[1,0]
  v_pk_mul_f32 v[36:37], v[36:37], v[226:227] op_sel_hi:[1,0]
  v_pk_mul_f32 v[38:39], v[38:39], v[226:227] op_sel_hi:[1,0]
  v_cvt_pk_bf16_f32 v48, v32, v33
  v_cvt_pk_bf16_f32 v49, v34, v35
  v_cvt_pk_bf16_f32 v50, v36, v37
  v_cvt_pk_bf16_f32 v51, v38, v39
  v_lshlrev_b32 v32, 16, v48
  v_and_b32 v33, 0xffff0000, v48
  v_lshlrev_b32 v34, 16, v49
  v_and_b32 v35, 0xffff0000, v49
  v_lshlrev_b32 v36, 16, v50
  v_and_b32 v37, 0xffff0000, v50
  v_lshlrev_b32 v38, 16, v51
  v_and_b32 v39, 0xffff0000, v51
  v_pk_mul_f32 v[32:33], v[32:33], v[208:209]
  v_pk_mul_f32 v[34:35], v[34:35], v[210:211]
  v_pk_mul_f32 v[36:37], v[36:37], v[212:213]
  v_pk_mul_f32 v[38:39], v[38:39], v[214:215]
  v_cvt_pk_bf16_f32 v48, v32, v33
  v_cvt_pk_bf16_f32 v49, v34, v35
  v_cvt_pk_bf16_f32 v50, v36, v37
  v_cvt_pk_bf16_f32 v51, v38, v39
  v_lshlrev_b32 v32, 16, v48
  v_and_b32 v33, 0xffff0000, v48
  v_lshlrev_b32 v34, 16, v49
  v_and_b32 v35, 0xffff0000, v49
  v_lshlrev_b32 v36, 16, v50
  v_and_b32 v37, 0xffff0000, v50
  v_lshlrev_b32 v38, 16, v51
  v_and_b32 v39, 0xffff0000, v51
  v_pk_add_f32 v[32:33], v[32:33], v[200:201]
  v_pk_add_f32 v[34:35], v[34:35], v[202:203]
  v_pk_add_f32 v[36:37], v[36:37], v[204:205]
  v_pk_add_f32 v[38:39], v[38:39], v[206:207]
  v_cvt_pk_bf16_f32 v56, v32, v33
  v_cvt_pk_bf16_f32 v57, v34, v35
  v_cvt_pk_bf16_f32 v58, v36, v37
  v_cvt_pk_bf16_f32 v59, v38, v39
  s_add_u32 s50, s58, 0
  buffer_store_dwordx4 v[56:59], v18, s[36:39], s50 offen sc1
  s_mov_b64 exec, 0xff
  s_waitcnt vmcnt(1)
  v_cmp_ne_u32 vcc, 1, v30
  s_mov_b64 exec, -1
  s_cmp_eq_u64 vcc, 0
  s_cbranch_scc1 k2_rk1
  s_add_u32 s56, s63, 4096
  s_mov_b32 s50, 0
  s_mov_b64 exec, 0xff
k2_ap1:
  buffer_load_dword v3, v24, s[36:39], s56 offen sc1
  s_add_u32 s50, s50, 1
  s_waitcnt vmcnt(0)
  v_cmp_ne_u32 vcc, 1, v3
  s_cmp_gt_u32 s50, 0x80000
  s_cbranch_scc1 k2_ad1
  s_nop 2
  s_cbranch_vccnz k2_ap1
k2_ad1:
  s_mov_b64 exec, -1
k2_rk1:
  s_mov_b32 s50, 0x0
  buffer_load_dwordx4 v[160:163], v15, s[40:43], s50 offen offset:1024 sc1
  s_mov_b32 s50, 0x200000
  buffer_load_dwordx4 v[164:167], v15, s[40:43], s50 offen offset:1024 sc1
  s_mov_b32 s50, 0x400000
  buffer_load_dwordx4 v[168:171], v15, s[40:43], s50 offen offset:1024 sc1
  s_mov_b32 s50, 0x600000
  buffer_load_dwordx4 v[172:175], v15, s[40:43], s50 offen offset:1024 sc1
  s_mov_b32 s50, 0x800000
  buffer_load_dwordx4 v[176:179], v15, s[40:43], s50 offen offset:1024 sc1
  s_mov_b32 s50, 0xa00000
  buffer_load_dwordx4 v[180:183], v15, s[40:43], s50 offen offset:1024 sc1
  s_mov_b32 s50, 0xc00000
  buffer_load_dwordx4 v[184:187], v15, s[40:43], s50 offen offset:1024 sc1
  s_mov_b32 s50, 0xe00000
  buffer_load_dwordx4 v[188:191], v15, s[40:43], s50 offen offset:1024 sc1
  ds_read_b64_tr_b16 a[208:209], v5 offset:16384
  ds_read_b64_tr_b16 a[210:211], v5 offset:16896
  ds_read_b64_tr_b16 a[212:213], v5 offset:16640
  ds_read_b64_tr_b16 a[214:215], v5 offset:17152
  ds_read_b64_tr_b16 a[216:217], v5 offset:18432
  ds_read_b64_tr_b16 a[218:219], v5 offset:18944
  ds_read_b64_tr_b16 a[220:221], v5 offset:18688
  ds_read_b64_tr_b16 a[222:223], v5 offset:19200
  ds_read_b64_tr_b16 a[224:225], v4 offset:0
  ds_read_b64_tr_b16 a[226:227], v4 offset:512
  ds_read_b64_tr_b16 a[228:229], v4 offset:256
  ds_read_b64_tr_b16 a[230:231], v4 offset:768
  ds_read_b64_tr_b16 a[232:233], v4 offset:2048
  ds_read_b64_tr_b16 a[234:235], v4 offset:2560
  ds_read_b64_tr_b16 a[236:237], v4 offset:2304
  ds_read_b64_tr_b16 a[238:239], v4 offset:2816
  ds_read_b64_tr_b16 a[240:241], v4 offset:16384
  ds_read_b64_tr_b16 a[242:243], v4 offset:16896
  ds_read_b64_tr_b16 a[244:245], v4 offset:16640
  ds_read_b64_tr_b16 a[246:247], v4 offset:17152
  ds_read_b64_tr_b16 a[248:249], v4 offset:18432
  ds_read_b64_tr_b16 a[250:251], v4 offset:18944
  ds_read_b64_tr_b16 a[252:253], v4 offset:18688
  ds_read_b64_tr_b16 a[254:255], v4 offset:19200
  ds_read_b64_tr_b16 a[0:1], v4 offset:32768
  ds_read_b64_tr_b16 a[2:3], v4 offset:33280
  ds_read_b64_tr_b16 a[4:5], v4 offset:33024
  ds_read_b64_tr_b16 a[6:7], v4 offset:33536
  ds_read_b64_tr_b16 a[8:9], v4 offset:34816
  ds_read_b64_tr_b16 a[10:11], v4 offset:35328
  ds_read_b64_tr_b16 a[12:13], v4 offset:35072
  ds_read_b64_tr_b16 a[14:15], v4 offset:35584
  ds_read_b64_tr_b16 a[16:17], v4 offset:49152
  ds_read_b64_tr_b16 a[18:19], v4 offset:49664
  ds_read_b64_tr_b16 a[20:21], v4 offset:49408
  ds_read_b64_tr_b16 a[22:23], v4 offset:49920
  ds_read_b64_tr_b16 a[24:25], v4 offset:51200
  ds_read_b64_tr_b16 a[26:27], v4 offset:51712
  ds_read_b64_tr_b16 a[28:29], v4 offset:51456
  ds_read_b64_tr_b16 a[30:31], v4 offset:51968
  ds_read_b64_tr_b16 a[32:33], v5 offset:0
  ds_read_b64_tr_b16 a[34:35], v5 offset:512
  ds_read_b64_tr_b16 a[36:37], v5 offset:256
  ds_read_b64_tr_b16 a[38:39], v5 offset:768
  ds_read_b64_tr_b16 a[40:41], v5 offset:2048
  ds_read_b64_tr_b16 a[42:43], v5 offset:2560
  ds_read_b64_tr_b16 a[44:45], v5 offset:2304
  ds_read_b64_tr_b16 a[46:47], v5 offset:2816
  s_waitcnt vmcnt(8)
  s_barrier
  s_add_u32 s50, s59, 8192
  s_mov_b64 exec, s[68:69]
  buffer_store_dword v29, v28, s[36:39], s50 offen sc1
  s_mov_b64 exec, -1
  s_waitcnt lgkmcnt(0)
  s_add_u32 m0, s51, 81920
  s_nop 0
  buffer_load_dwordx4 v8, s[20:23], s52 offen lds
  s_add_u32 m0, s51, 82944
  s_nop 0
  buffer_load_dwordx4 v9, s[20:23], s52 offen lds
  s_add_u32 m0, s51, 83968
  s_add_u32 s52, s52, 57344
  buffer_load_dwordx4 v8, s[20:23], s52 offen lds
  s_add_u32 m0, s51, 84992
  s_nop 0
  buffer_load_dwordx4 v9, s[20:23], s52 offen lds
  s_add_u32 s52, s52, 57344
  s_add_u32 m0, s51, 0
  s_nop 0
  buffer_load_dwordx4 v8, s[20:23], s52 offen lds
  s_add_u32 m0, s51, 1024
  s_nop 0
  buffer_load_dwordx4 v9, s[20:23], s52 offen lds
  s_add_u32 m0, s51, 2048
  s_add_u32 s52, s52, 57344
  buffer_load_dwordx4 v8, s[20:23], s52 offen lds
  s_add_u32 m0, s51, 3072
  s_nop 0
  buffer_load_dwordx4 v9, s[20:23], s52 offen lds
  s_add_u32 s52, s52, 57344
  s_add_u32 m0, s51, 16384
  s_nop 0
  buffer_load_dwordx4 v8, s[20:23], s52 offen lds
  s_add_u32 m0, s51, 17408
  s_nop 0
  buffer_load_dwordx4 v9, s[20:23], s52 offen lds
  s_add_u32 m0, s51, 18432
  s_add_u32 s52, s52, 57344
  buffer_load_dwordx4 v8, s[20:23], s52 offen lds
  s_add_u32 m0, s51, 19456
  s_nop 0
  buffer_load_dwordx4 v9, s[20:23], s52 offen lds
  s_add_u32 s52, s52, 57344
  s_add_u32 m0, s51, 32768
  s_nop 0
  buffer_load_dwordx4 v8, s[20:23], s52 offen lds
  s_add_u32 m0, s51, 33792
  s_nop 0
  buffer_load_dwordx4 v9, s[20:23], s52 offen lds
  s_add_u32 m0, s51, 34816
  s_add_u32 s52, s52, 57344
  buffer_load_dwordx4 v8, s[20:23], s52 offen lds
  s_add_u32 m0, s51, 35840
  s_nop 0
  buffer_load_dwordx4 v9, s[20:23], s52 offen lds
  s_add_u32 s52, s52, 57344
  s_add_u32 m0, s51, 49152
  s_nop 0
  buffer_load_dwordx4 v8, s[20:23], s52 offen lds
  s_add_u32 m0, s51, 50176
  s_nop 0
  buffer_load_dwordx4 v9, s[20:23], s52 offen lds
  s_add_u32 m0, s51, 51200
  s_add_u32 s52, s52, 57344
  buffer_load_dwordx4 v8, s[20:23], s52 offen lds
  s_add_u32 m0, s51, 52224
  s_nop 0
  buffer_load_dwordx4 v9, s[20:23], s52 offen lds
  s_add_u32 s52, s52, 57344
  s_add_u32 m0, s51, 65536
  s_nop 0
  buffer_load_dwordx4 v10, s[24:27], s54 offen lds
  s_add_u32 m0, s51, 66560
  s_nop 0
  buffer_load_dwordx4 v11, s[24:27], s54 offen lds
  s_add_u32 m0, s51, 67584
  s_add_u32 s54, s54, 16384
  buffer_load_dwordx4 v10, s[24:27], s54 offen lds
  s_add_u32 m0, s51, 68608
  s_nop 0
  buffer_load_dwordx4 v11, s[24:27], s54 offen lds
  s_add_u32 s54, s54, 16384
  v_lshlrev_b32 v216, 16, v100
  v_and_b32 v217, 0xffff0000, v100
  v_lshlrev_b32 v218, 16, v101
  v_and_b32 v219, 0xffff0000, v101
  v_lshlrev_b32 v220, 16, v102
  v_and_b32 v221, 0xffff0000, v102
  v_lshlrev_b32 v222, 16, v103
  v_and_b32 v223, 0xffff0000, v103
  s_waitcnt vmcnt(32)
  v_lshlrev_b32 v32, 16, v160
  v_and_b32 v33, 0xffff0000, v160
  v_lshlrev_b32 v34, 16, v161
  v_and_b32 v35, 0xffff0000, v161
  v_lshlrev_b32 v36, 16, v162
  v_and_b32 v37, 0xffff0000, v162
  v_lshlrev_b32 v38, 16, v163
  v_and_b32 v39, 0xffff0000, v163
  s_waitcnt vmcnt(31)
  v_lshlrev_b32 v48, 16, v164
  v_and_b32 v49, 0xffff0000, v164
  v_pk_add_f32 v[32:33], v[32:33], v[48:49]
  v_lshlrev_b32 v50, 16, v165
  v_and_b32 v51, 0xffff0000, v165
  v_pk_add_f32 v[34:35], v[34:35], v[50:51]
  v_lshlrev_b32 v52, 16, v166
  v_and_b32 v53, 0xffff0000, v166
  v_pk_add_f32 v[36:37], v[36:37], v[52:53]
  v_lshlrev_b32 v54, 16, v167
  v_and_b32 v55, 0xffff0000, v167
  v_pk_add_f32 v[38:39], v[38:39], v[54:55]
  s_waitcnt vmcnt(30)
  v_lshlrev_b32 v48, 16, v168
  v_and_b32 v49, 0xffff0000, v168
  v_pk_add_f32 v[32:33], v[32:33], v[48:49]
  v_lshlrev_b32 v50, 16, v169
  v_and_b32 v51, 0xffff0000, v169
  v_pk_add_f32 v[34:35], v[34:35], v[50:51]
  v_lshlrev_b32 v52, 16, v170
  v_and_b32 v53, 0xffff0000, v170
  v_pk_add_f32 v[36:37], v[36:37], v[52:53]
  v_lshlrev_b32 v54, 16, v171
  v_and_b32 v55, 0xffff0000, v171
  v_pk_add_f32 v[38:39], v[38:39], v[54:55]
  s_waitcnt vmcnt(29)
  v_lshlrev_b32 v48, 16, v172
  v_and_b32 v49, 0xffff0000, v172
  v_pk_add_f32 v[32:33], v[32:33], v[48:49]
  v_lshlrev_b32 v50, 16, v173
  v_and_b32 v51, 0xffff0000, v173
  v_pk_add_f32 v[34:35], v[34:35], v[50:51]
  v_lshlrev_b32 v52, 16, v174
  v_and_b32 v53, 0xffff0000, v174
  v_pk_add_f32 v[36:37], v[36:37], v[52:53]
  v_lshlrev_b32 v54, 16, v175
  v_and_b32 v55, 0xffff0000, v175
  v_pk_add_f32 v[38:39], v[38:39], v[54:55]
  s_waitcnt vmcnt(28)
  v_lshlrev_b32 v48, 16, v176
  v_and_b32 v49, 0xffff0000, v176
  v_pk_add_f32 v[32:33], v[32:33], v[48:49]
  v_lshlrev_b32 v50, 16, v177
  v_and_b32 v51, 0xffff0000, v177
  v_pk_add_f32 v[34:35], v[34:35], v[50:51]
  v_lshlrev_b32 v52, 16, v178
  v_and_b32 v53, 0xffff0000, v178
  v_pk_add_f32 v[36:37], v[36:37], v[52:53]
  v_lshlrev_b32 v54, 16, v179
  v_and_b32 v55, 0xffff0000, v179
  v_pk_add_f32 v[38:39], v[38:39], v[54:55]
  s_waitcnt vmcnt(27)
  v_lshlrev_b32 v48, 16, v180
  v_and_b32 v49, 0xffff0000, v180
  v_pk_add_f32 v[32:33], v[32:33], v[48:49]
  v_lshlrev_b32 v50, 16, v181
  v_and_b32 v51, 0xffff0000, v181
  v_pk_add_f32 v[34:35], v[34:35], v[50:51]
  v_lshlrev_b32 v52, 16, v182
  v_and_b32 v53, 0xffff0000, v182
  v_pk_add_f32 v[36:37], v[36:37], v[52:53]
  v_lshlrev_b32 v54, 16, v183
  v_and_b32 v55, 0xffff0000, v183
  v_pk_add_f32 v[38:39], v[38:39], v[54:55]
  s_waitcnt vmcnt(26)
  v_lshlrev_b32 v48, 16, v184
  v_and_b32 v49, 0xffff0000, v184
  v_pk_add_f32 v[32:33], v[32:33], v[48:49]
  v_lshlrev_b32 v50, 16, v185
  v_and_b32 v51, 0xffff0000, v185
  v_pk_add_f32 v[34:35], v[34:35], v[50:51]
  v_lshlrev_b32 v52, 16, v186
  v_and_b32 v53, 0xffff0000, v186
  v_pk_add_f32 v[36:37], v[36:37], v[52:53]
  v_lshlrev_b32 v54, 16, v187
  v_and_b32 v55, 0xffff0000, v187
  v_pk_add_f32 v[38:39], v[38:39], v[54:55]
  s_waitcnt vmcnt(25)
  v_lshlrev_b32 v48, 16, v188
  v_and_b32 v49, 0xffff0000, v188
  v_pk_add_f32 v[32:33], v[32:33], v[48:49]
  v_lshlrev_b32 v50, 16, v189
  v_and_b32 v51, 0xffff0000, v189
  v_pk_add_f32 v[34:35], v[34:35], v[50:51]
  v_lshlrev_b32 v52, 16, v190
  v_and_b32 v53, 0xffff0000, v190
  v_pk_add_f32 v[36:37], v[36:37], v[52:53]
  v_lshlrev_b32 v54, 16, v191
  v_and_b32 v55, 0xffff0000, v191
  v_pk_add_f32 v[38:39], v[38:39], v[54:55]
  v_cvt_pk_bf16_f32 v48, v32, v33
  v_cvt_pk_bf16_f32 v49, v34, v35
  v_cvt_pk_bf16_f32 v50, v36, v37
  v_cvt_pk_bf16_f32 v51, v38, v39
  v_lshlrev_b32 v32, 16, v48
  v_and_b32 v33, 0xffff0000, v48
  v_lshlrev_b32 v34, 16, v49
  v_and_b32 v35, 0xffff0000, v49
  v_lshlrev_b32 v36, 16, v50
  v_and_b32 v37, 0xffff0000, v50
  v_lshlrev_b32 v38, 16, v51
  v_and_b32 v39, 0xffff0000, v51
  v_pk_mul_f32 v[32:33], v[32:33], v[192:193]
  v_pk_mul_f32 v[34:35], v[34:35], v[194:195]
  v_pk_mul_f32 v[36:37], v[36:37], v[196:197]
  v_pk_mul_f32 v[38:39], v[38:39], v[198:199]
  v_cvt_pk_bf16_f32 v48, v32, v33
  v_cvt_pk_bf16_f32 v49, v34, v35
  v_cvt_pk_bf16_f32 v50, v36, v37
  v_cvt_pk_bf16_f32 v51, v38, v39
  v_lshlrev_b32 v32, 16, v48
  v_and_b32 v33, 0xffff0000, v48
  v_lshlrev_b32 v34, 16, v49
  v_and_b32 v35, 0xffff0000, v49
  v_lshlrev_b32 v36, 16, v50
  v_and_b32 v37, 0xffff0000, v50
  v_lshlrev_b32 v38, 16, v51
  v_and_b32 v39, 0xffff0000, v51
  v_pk_add_f32 v[32:33], v[32:33], v[216:217]
  v_pk_add_f32 v[34:35], v[34:35], v[218:219]
  v_pk_add_f32 v[36:37], v[36:37], v[220:221]
  v_pk_add_f32 v[38:39], v[38:39], v[222:223]
  v_cvt_pk_bf16_f32 v100, v32, v33
  v_cvt_pk_bf16_f32 v101, v34, v35
  v_cvt_pk_bf16_f32 v102, v36, v37
  v_cvt_pk_bf16_f32 v103, v38, v39
  v_dot2_f32_bf16 v22, v100, v7, 0
  v_dot2_f32_bf16 v23, v100, v100, 0
  v_dot2_f32_bf16 v22, v101, v7, v22
  v_dot2_f32_bf16 v23, v101, v101, v23
  v_dot2_f32_bf16 v22, v102, v7, v22
  v_dot2_f32_bf16 v23, v102, v102, v23
  v_dot2_f32_bf16 v22, v103, v7, v22
  v_dot2_f32_bf16 v23, v103, v103, v23
  v_lshlrev_b32 v32, 16, v100
  v_and_b32 v33, 0xffff0000, v100
  v_lshlrev_b32 v34, 16, v101
  v_and_b32 v35, 0xffff0000, v101
  v_lshlrev_b32 v36, 16, v102
  v_and_b32 v37, 0xffff0000, v102
  v_lshlrev_b32 v38, 16, v103
  v_and_b32 v39, 0xffff0000, v103
  v_add_f32 v22, v22, v22 row_ror:4 row_mask:0xf bank_mask:0xf
  v_add_f32 v23, v23, v23 row_ror:4 row_mask:0xf bank_mask:0xf
  s_nop 0
  v_add_f32 v22, v22, v22 row_ror:8 row_mask:0xf bank_mask:0xf
  v_add_f32 v23, v23, v23 row_ror:8 row_mask:0xf bank_mask:0xf
  v_mov_b32 v228, v22
  v_mov_b32 v229, v23
  s_nop 0
  v_permlane16_swap_b32 v228, v22
  v_permlane16_swap_b32 v229, v23
  v_add_f32 v22, v22, v228
  v_add_f32 v23, v23, v229
  v_mov_b32 v228, v22
  v_mov_b32 v229, v23
  s_nop 0
  v_permlane32_swap_b32 v228, v22
  v_permlane32_swap_b32 v229, v23
  v_add_f32 v22, v22, v228
  v_add_f32 v23, v23, v229
  ds_write_b64 v21, v[22:23] offset:8320
  s_waitcnt lgkmcnt(0)
  s_barrier
  ds_read_b128 v[228:231], v19 offset:8320
  ds_read_b128 v[232:235], v19 offset:8336
  s_waitcnt lgkmcnt(1)
  v_pk_add_f32 v[228:229], v[228:229], v[230:231]
  s_waitcnt lgkmcnt(0)
  v_pk_add_f32 v[232:233], v[232:233], v[234:235]
  v_pk_add_f32 v[228:229], v[228:229], v[232:233]
  v_mul_f32 v224, 0x3b000000, v228
  v_mul_f32 v230, v224, v228
  v_sub_f32 v226, v229, v230
  v_max_f32 v226, 0, v226
  v_mul_f32 v226, 0x3b000000, v226
  v_cvt_pk_bf16_f32 v226, v226, v226
  v_lshlrev_b32 v226, 16, v226
  v_add_f32 v226, 0x3727c5ac, v226
  v_cvt_pk_bf16_f32 v226, v226, v226
  v_lshlrev_b32 v226, 16, v226
  v_sqrt_f32 v226, v226
  s_nop 0
  v_cvt_pk_bf16_f32 v226, v226, v226
  v_lshlrev_b32 v226, 16, v226
  v_rcp_f32 v226, v226
  v_cvt_pk_bf16_f32 v224, v224, v224
  v_lshlrev_b32 v224, 16, v224
  v_pk_add_f32 v[32:33], v[32:33], v[224:225] op_sel_hi:[1,0] neg_lo:[0,1] neg_hi:[0,1]
  v_pk_add_f32 v[34:35], v[34:35], v[224:225] op_sel_hi:[1,0] neg_lo:[0,1] neg_hi:[0,1]
  v_pk_add_f32 v[36:37], v[36:37], v[224:225] op_sel_hi:[1,0] neg_lo:[0,1] neg_hi:[0,1]
  v_pk_add_f32 v[38:39], v[38:39], v[224:225] op_sel_hi:[1,0] neg_lo:[0,1] neg_hi:[0,1]
  v_cvt_pk_bf16_f32 v48, v32, v33
  v_cvt_pk_bf16_f32 v49, v34, v35
  v_cvt_pk_bf16_f32 v50, v36, v37
  v_cvt_pk_bf16_f32 v51, v38, v39
  v_lshlrev_b32 v32, 16, v48
  v_and_b32 v33, 0xffff0000, v48
  v_lshlrev_b32 v34, 16, v49
  v_and_b32 v35, 0xffff0000, v49
  v_lshlrev_b32 v36, 16, v50
  v_and_b32 v37, 0xffff0000, v50
  v_lshlrev_b32 v38, 16, v51
  v_and_b32 v39, 0xffff0000, v51
  v_pk_mul_f32 v[32:33], v[32:33], v[226:227] op_sel_hi:[1,0]
  v_pk_mul_f32 v[34:35], v[34:35], v[226:227] op_sel_hi:[1,0]
  v_pk_mul_f32 v[36:37], v[36:37], v[226:227] op_sel_hi:[1,0]
  v_pk_mul_f32 v[38:39], v[38:39], v[226:227] op_sel_hi:[1,0]
  v_cvt_pk_bf16_f32 v48, v32, v33
  v_cvt_pk_bf16_f32 v49, v34, v35
  v_cvt_pk_bf16_f32 v50, v36, v37
  v_cvt_pk_bf16_f32 v51, v38, v39
  v_lshlrev_b32 v32, 16, v48
  v_and_b32 v33, 0xffff0000, v48
  v_lshlrev_b32 v34, 16, v49
  v_and_b32 v35, 0xffff0000, v49
  v_lshlrev_b32 v36, 16, v50
  v_and_b32 v37, 0xffff0000, v50
  v_lshlrev_b32 v38, 16, v51
  v_and_b32 v39, 0xffff0000, v51
  v_pk_mul_f32 v[32:33], v[32:33], v[208:209]
  v_pk_mul_f32 v[34:35], v[34:35], v[210:211]
  v_pk_mul_f32 v[36:37], v[36:37], v[212:213]
  v_pk_mul_f32 v[38:39], v[38:39], v[214:215]
  v_cvt_pk_bf16_f32 v48, v32, v33
  v_cvt_pk_bf16_f32 v49, v34, v35
  v_cvt_pk_bf16_f32 v50, v36, v37
  v_cvt_pk_bf16_f32 v51, v38, v39
  v_lshlrev_b32 v32, 16, v48
  v_and_b32 v33, 0xffff0000, v48
  v_lshlrev_b32 v34, 16, v49
  v_and_b32 v35, 0xffff0000, v49
  v_lshlrev_b32 v36, 16, v50
  v_and_b32 v37, 0xffff0000, v50
  v_lshlrev_b32 v38, 16, v51
  v_and_b32 v39, 0xffff0000, v51
  v_pk_add_f32 v[32:33], v[32:33], v[200:201]
  v_pk_add_f32 v[34:35], v[34:35], v[202:203]
  v_pk_add_f32 v[36:37], v[36:37], v[204:205]
  v_pk_add_f32 v[38:39], v[38:39], v[206:207]
  v_cvt_pk_bf16_f32 v56, v32, v33
  v_cvt_pk_bf16_f32 v57, v34, v35
  v_cvt_pk_bf16_f32 v58, v36, v37
  v_cvt_pk_bf16_f32 v59, v38, v39
  s_add_u32 s50, s58, 8192
  buffer_store_dwordx4 v[56:59], v18, s[36:39], s50 offen sc1
  s_add_u32 s50, s63, 8192
  s_mov_b64 exec, 0xff
  buffer_load_dword v30, v24, s[36:39], s50 offen sc1
  s_mov_b64 exec, -1
  s_add_u32 s64, s64, 16769024
  s_add_u32 s47, s47, 16769024
  v_lshlrev_b32 v192, 16, v64
  v_and_b32 v193, 0xffff0000, v64
  v_lshlrev_b32 v194, 16, v65
  v_and_b32 v195, 0xffff0000, v65
  v_lshlrev_b32 v196, 16, v66
  v_and_b32 v197, 0xffff0000, v66
  v_lshlrev_b32 v198, 16, v67
  v_and_b32 v199, 0xffff0000, v67
  v_lshlrev_b32 v200, 16, v68
  v_and_b32 v201, 0xffff0000, v68
  v_lshlrev_b32 v202, 16, v69
  v_and_b32 v203, 0xffff0000, v69
  v_lshlrev_b32 v204, 16, v70
  v_and_b32 v205, 0xffff0000, v70
  v_lshlrev_b32 v206, 16, v71
  v_and_b32 v207, 0xffff0000, v71
  v_lshlrev_b32 v208, 16, v72
  v_and_b32 v209, 0xffff0000, v72
  v_lshlrev_b32 v210, 16, v73
  v_and_b32 v211, 0xffff0000, v73
  v_lshlrev_b32 v212, 16, v74
  v_and_b32 v213, 0xffff0000, v74
  v_lshlrev_b32 v214, 16, v75
  v_and_b32 v215, 0xffff0000, v75
  v_lshlrev_b32 v216, 16, v76
  v_and_b32 v217, 0xffff0000, v76
  v_lshlrev_b32 v218, 16, v77
  v_and_b32 v219, 0xffff0000, v77
  v_lshlrev_b32 v220, 16, v78
  v_and_b32 v221, 0xffff0000, v78
  v_lshlrev_b32 v222, 16, v79
  v_and_b32 v223, 0xffff0000, v79
  s_waitcnt vmcnt(1)
  s_barrier
  s_add_u32 s50, s59, 12288
  s_mov_b64 exec, s[68:69]
  buffer_store_dword v29, v28, s[36:39], s50 offen sc1
  s_mov_b64 exec, -1
  s_cmp_eq_u32 s46, 7
  s_cbranch_scc0 k2_ffn
  s_add_u32 s50, s59, 16384
  s_mov_b64 exec, s[68:69]
  buffer_store_dword v29, v28, s[36:39], s50 offen sc1
  s_mov_b64 exec, -1
  s_add_u32 s50, s59, 20480
  s_mov_b64 exec, s[68:69]
  buffer_store_dword v29, v28, s[36:39], s50 offen sc1
  s_mov_b64 exec, -1
  s_waitcnt vmcnt(0)
  v_mov_b32 v30, 0
  s_branch k2_ffd
k2_ffn:
  s_and_b32 s50, s44, 1
  s_lshl_b32 s50, s50, 7
  s_lshr_b32 s56, s44, 1
  s_lshl_b32 s56, s56, 14
  s_or_b32 s50, s50, s56
  v_xor_b32 v2, s50, v6
  v_xor_b32 v25, 0, v2
  v_xor_b32 v26, 32, v2
  v_xor_b32 v27, 64, v2
  v_xor_b32 v23, 96, v2
  s_lshl_b32 s48, s44, 11
  s_add_u32 s57, s58, s48
  s_mov_b64 exec, 0xff
  s_waitcnt vmcnt(1)
  v_cmp_ne_u32 vcc, 1, v30
  s_mov_b64 exec, -1
  s_cmp_eq_u64 vcc, 0
  s_cbranch_scc1 k2_rk2
  s_add_u32 s56, s63, 8192
  s_mov_b32 s50, 0
  s_mov_b64 exec, 0xff
k2_ap2:
  buffer_load_dword v3, v24, s[36:39], s56 offen sc1
  s_add_u32 s50, s50, 1
  s_waitcnt vmcnt(0)
  v_cmp_ne_u32 vcc, 1, v3
  s_cmp_gt_u32 s50, 0x80000
  s_cbranch_scc1 k2_ad2
  s_nop 2
  s_cbranch_vccnz k2_ap2
k2_ad2:
  s_mov_b64 exec, -1
k2_rk2:
  s_add_u32 m0, s48, 0
  s_add_u32 s50, s57, 0
  buffer_load_dwordx4 v20, s[36:39], s50 offen sc1 lds
  buffer_load_dwordx4 v20, s[36:39], s50 offen offset:1024 sc1 lds
  s_add_u32 m0, s48, 16384
  s_add_u32 s50, s57, 16384
  buffer_load_dwordx4 v20, s[36:39], s50 offen sc1 lds
  buffer_load_dwordx4 v20, s[36:39], s50 offen offset:1024 sc1 lds
  s_add_u32 m0, s48, 32768
  s_add_u32 s50, s57, 32768
  buffer_load_dwordx4 v20, s[36:39], s50 offen sc1 lds
  buffer_load_dwordx4 v20, s[36:39], s50 offen offset:1024 sc1 lds
  s_add_u32 m0, s48, 49152
  s_add_u32 s50, s57, 49152
  buffer_load_dwordx4 v20, s[36:39], s50 offen sc1 lds
  buffer_load_dwordx4 v20, s[36:39], s50 offen offset:1024 sc1 lds
  s_waitcnt vmcnt(0)
  s_barrier
  ds_read_b128 v[80:83], v6 offset:0
  v_xor_b32 v7, 32, v6
  ds_read_b128 v[84:87], v7 offset:0
  v_xor_b32 v7, 64, v6
  ds_read_b128 v[88:91], v7 offset:0
  s_waitcnt lgkmcnt(2)
  v_mfma_f32_32x32x16_bf16 v[128:143], a[128:131], v[80:83], v[192:207]
  ds_read_b64_tr_b16 a[48:49], v5 offset:16384
  ds_read_b64_tr_b16 a[50:51], v5 offset:16896
  v_xor_b32 v7, 96, v6
  v_mfma_f32_32x32x16_bf16 v[144:159], a[132:135], v[80:83], v[208:223]
  ds_read_b128 v[92:95], v7 offset:0
  ds_read_b64_tr_b16 a[52:53], v5 offset:16640
  ds_read_b64_tr_b16 a[54:55], v5 offset:17152
  s_waitcnt lgkmcnt(6)
  v_mfma_f32_32x32x16_bf16 v[128:143], a[136:139], v[84:87], v[128:143]
  ds_read_b64_tr_b16 a[56:57], v5 offset:18432
  ds_read_b64_tr_b16 a[58:59], v5 offset:18944
  v_xor_b32 v7, 128, v6
  v_mfma_f32_32x32x16_bf16 v[144:159], a[140:143], v[84:87], v[144:159]
  ds_read_b128 v[80:83], v7 offset:0
  ds_read_b64_tr_b16 a[60:61], v5 offset:18688
  ds_read_b64_tr_b16 a[62:63], v5 offset:19200
  s_waitcnt lgkmcnt(10)
  v_mfma_f32_32x32x16_bf16 v[128:143], a[144:147], v[88:91], v[128:143]
  ds_read_b64_tr_b16 a[64:65], v4 offset:0
  ds_read_b64_tr_b16 a[66:67], v4 offset:512
  s_waitcnt lgkmcnt(2)
  s_add_u32 m0, s51, 81920
  s_nop 0
  buffer_load_dwordx4 v10, s[24:27], s54 offen lds
  v_xor_b32 v7, 160, v6
  v_mfma_f32_32x32x16_bf16 v[144:159], a[148:151], v[88:91], v[144:159]
  ds_read_b128 v[84:87], v7 offset:0
  ds_read_b64_tr_b16 a[68:69], v4 offset:256
  ds_read_b64_tr_b16 a[70:71], v4 offset:768
  s_add_u32 m0, s51, 82944
  s_nop 0
  buffer_load_dwordx4 v11, s[24:27], s54 offen lds
  v_mfma_f32_32x32x16_bf16 v[128:143], a[152:155], v[92:95], v[128:143]
  ds_read_b64_tr_b16 a[72:73], v4 offset:2048
  ds_read_b64_tr_b16 a[74:75], v4 offset:2560
  s_add_u32 m0, s51, 83968
  s_add_u32 s54, s54, 16384
  buffer_load_dwordx4 v10, s[24:27], s54 offen lds
  v_xor_b32 v7, 192, v6
  v_mfma_f32_32x32x16_bf16 v[144:159], a[156:159], v[92:95], v[144:159]
  ds_read_b128 v[88:91], v7 offset:0
  ds_read_b64_tr_b16 a[76:77], v4 offset:2304
  ds_read_b64_tr_b16 a[78:79], v4 offset:2816
  s_add_u32 m0, s51, 84992
  s_nop 0
  buffer_load_dwordx4 v11, s[24:27], s54 offen lds
  s_add_u32 s54, s54, 16384
  v_mfma_f32_32x32x16_bf16 v[128:143], a[160:163], v[80:83], v[128:143]
  ds_read_b64_tr_b16 a[80:81], v4 offset:16384
  ds_read_b64_tr_b16 a[82:83], v4 offset:16896
  v_xor_b32 v7, 224, v6
  v_mfma_f32_32x32x16_bf16 v[144:159], a[164:167], v[80:83], v[144:159]
  ds_read_b128 v[92:95], v7 offset:0
  ds_read_b64_tr_b16 a[84:85], v4 offset:16640
  ds_read_b64_tr_b16 a[86:87], v4 offset:17152
  s_waitcnt lgkmcnt(12)
  v_mfma_f32_32x32x16_bf16 v[128:143], a[168:171], v[84:87], v[128:143]
  ds_read_b64_tr_b16 a[88:89], v4 offset:18432
  ds_read_b64_tr_b16 a[90:91], v4 offset:18944
  v_mfma_f32_32x32x16_bf16 v[144:159], a[172:175], v[84:87], v[144:159]
  ds_read_b128 v[80:83], v6 offset:16384
  ds_read_b64_tr_b16 a[92:93], v4 offset:18688
  ds_read_b64_tr_b16 a[94:95], v4 offset:19200
  s_waitcnt lgkmcnt(12)
  v_mfma_f32_32x32x16_bf16 v[128:143], a[176:179], v[88:91], v[128:143]
  ds_read_b64_tr_b16 a[96:97], v4 offset:32768
  ds_read_b64_tr_b16 a[98:99], v4 offset:33280
  s_waitcnt lgkmcnt(12)
  s_add_u32 m0, s51, 0
  s_nop 0
  buffer_load_dwordx4 v10, s[24:27], s54 offen lds
  v_xor_b32 v7, 32, v6
  v_mfma_f32_32x32x16_bf16 v[144:159], a[180:183], v[88:91], v[144:159]
  ds_read_b128 v[84:87], v7 offset:16384
  ds_read_b64_tr_b16 a[100:101], v4 offset:33024
  ds_read_b64_tr_b16 a[102:103], v4 offset:33536
  s_add_u32 m0, s51, 1024
  s_nop 0
  buffer_load_dwordx4 v11, s[24:27], s54 offen lds
  s_waitcnt lgkmcnt(12)
  v_mfma_f32_32x32x16_bf16 v[128:143], a[184:187], v[92:95], v[128:143]
  ds_read_b64_tr_b16 a[104:105], v4 offset:34816
  ds_read_b64_tr_b16 a[106:107], v4 offset:35328
  s_add_u32 m0, s51, 2048
  s_add_u32 s54, s54, 16384
  buffer_load_dwordx4 v10, s[24:27], s54 offen lds
  v_xor_b32 v7, 64, v6
  v_mfma_f32_32x32x16_bf16 v[144:159], a[188:191], v[92:95], v[144:159]
  ds_read_b128 v[88:91], v7 offset:16384
  ds_read_b64_tr_b16 a[108:109], v4 offset:35072
  ds_read_b64_tr_b16 a[110:111], v4 offset:35584
  s_add_u32 m0, s51, 3072
  s_nop 0
  buffer_load_dwordx4 v11, s[24:27], s54 offen lds
  s_add_u32 s54, s54, 16384
  s_waitcnt lgkmcnt(12)
  v_mfma_f32_32x32x16_bf16 v[128:143], a[192:195], v[80:83], v[128:143]
  ds_read_b64_tr_b16 a[112:113], v4 offset:49152
  ds_read_b64_tr_b16 a[114:115], v4 offset:49664
  v_xor_b32 v7, 96, v6
  v_mfma_f32_32x32x16_bf16 v[144:159], a[196:199], v[80:83], v[144:159]
  ds_read_b128 v[92:95], v7 offset:16384
  ds_read_b64_tr_b16 a[116:117], v4 offset:49408
  ds_read_b64_tr_b16 a[118:119], v4 offset:49920
  s_waitcnt lgkmcnt(12)
  v_mfma_f32_32x32x16_bf16 v[128:143], a[200:203], v[84:87], v[128:143]
  ds_read_b64_tr_b16 a[120:121], v4 offset:51200
  ds_read_b64_tr_b16 a[122:123], v4 offset:51712
  v_xor_b32 v7, 128, v6
  v_mfma_f32_32x32x16_bf16 v[144:159], a[204:207], v[84:87], v[144:159]
  ds_read_b128 v[80:83], v7 offset:16384
  ds_read_b64_tr_b16 a[124:125], v4 offset:51456
  ds_read_b64_tr_b16 a[126:127], v4 offset:51968
  s_waitcnt lgkmcnt(12)
  v_mfma_f32_32x32x16_bf16 v[128:143], a[208:211], v[88:91], v[128:143]
  s_add_u32 m0, s51, 16384
  s_nop 0
  buffer_load_dwordx4 v10, s[24:27], s54 offen lds
  s_add_u32 s50, s63, 12288
  s_mov_b64 exec, 0xff
  buffer_load_dword v30, v24, s[36:39], s50 offen sc1
  s_mov_b64 exec, -1
  v_xor_b32 v7, 160, v6
  v_mfma_f32_32x32x16_bf16 v[144:159], a[212:215], v[88:91], v[144:159]
  ds_read_b128 v[84:87], v7 offset:16384
  s_add_u32 m0, s51, 17408
  s_nop 0
  buffer_load_dwordx4 v11, s[24:27], s54 offen lds
  s_waitcnt lgkmcnt(8)
  v_mfma_f32_32x32x16_bf16 v[128:143], a[216:219], v[92:95], v[128:143]
  s_add_u32 m0, s51, 18432
  s_add_u32 s54, s54, 16384
  buffer_load_dwordx4 v10, s[24:27], s54 offen lds
  v_xor_b32 v7, 192, v6
  v_mfma_f32_32x32x16_bf16 v[144:159], a[220:223], v[92:95], v[144:159]
  ds_read_b128 v[88:91], v7 offset:16384
  s_add_u32 m0, s51, 19456
  s_nop 0
  buffer_load_dwordx4 v11, s[24:27], s54 offen lds
  s_add_u32 s54, s54, 16384
  s_waitcnt lgkmcnt(4)
  v_mfma_f32_32x32x16_bf16 v[128:143], a[224:227], v[80:83], v[128:143]
  v_xor_b32 v7, 224, v6
  v_mfma_f32_32x32x16_bf16 v[144:159], a[228:231], v[80:83], v[144:159]
  ds_read_b128 v[92:95], v7 offset:16384
  s_waitcnt lgkmcnt(2)
  v_mfma_f32_32x32x16_bf16 v[128:143], a[232:235], v[84:87], v[128:143]
  v_mfma_f32_32x32x16_bf16 v[144:159], a[236:239], v[84:87], v[144:159]
  ds_read_b128 v[80:83], v6 offset:32768
  s_waitcnt lgkmcnt(2)
  v_mfma_f32_32x32x16_bf16 v[128:143], a[240:243], v[88:91], v[128:143]
  s_add_u32 m0, s51, 32768
  s_nop 0
  buffer_load_dwordx4 v10, s[24:27], s54 offen lds
  v_xor_b32 v7, 32, v6
  v_mfma_f32_32x32x16_bf16 v[144:159], a[244:247], v[88:91], v[144:159]
  ds_read_b128 v[84:87], v7 offset:32768
  s_add_u32 m0, s51, 33792
  s_nop 0
  buffer_load_dwordx4 v11, s[24:27], s54 offen lds
  s_waitcnt lgkmcnt(2)
  v_mfma_f32_32x32x16_bf16 v[128:143], a[248:251], v[92:95], v[128:143]
  s_add_u32 m0, s51, 34816
  s_add_u32 s54, s54, 16384
  buffer_load_dwordx4 v10, s[24:27], s54 offen lds
  v_xor_b32 v7, 64, v6
  v_mfma_f32_32x32x16_bf16 v[144:159], a[252:255], v[92:95], v[144:159]
  ds_read_b128 v[88:91], v7 offset:32768
  s_add_u32 m0, s51, 35840
  s_nop 0
  buffer_load_dwordx4 v11, s[24:27], s54 offen lds
  s_add_u32 s54, s54, 16384
  s_waitcnt lgkmcnt(2)
  v_mfma_f32_32x32x16_bf16 v[128:143], a[0:3], v[80:83], v[128:143]
  v_xor_b32 v7, 96, v6
  v_mfma_f32_32x32x16_bf16 v[144:159], a[4:7], v[80:83], v[144:159]
  ds_read_b128 v[92:95], v7 offset:32768
  s_waitcnt lgkmcnt(2)
  v_mfma_f32_32x32x16_bf16 v[128:143], a[8:11], v[84:87], v[128:143]
  v_xor_b32 v7, 128, v6
  v_mfma_f32_32x32x16_bf16 v[144:159], a[12:15], v[84:87], v[144:159]
  ds_read_b128 v[80:83], v7 offset:32768
  s_waitcnt lgkmcnt(2)
  v_mfma_f32_32x32x16_bf16 v[128:143], a[16:19], v[88:91], v[128:143]
  s_add_u32 m0, s51, 49152
  s_nop 0
  buffer_load_dwordx4 v10, s[24:27], s54 offen lds
  s_mov_b64 exec, 0xff
  s_waitcnt vmcnt(8)
  v_cmp_ne_u32 vcc, 1, v30
  s_mov_b64 exec, -1
  s_cmp_eq_u64 vcc, 0
  s_cselect_b64 s[74:75], -1, 0
  v_xor_b32 v7, 160, v6
  v_mfma_f32_32x32x16_bf16 v[144:159], a[20:23], v[88:91], v[144:159]
  ds_read_b128 v[84:87], v7 offset:32768
  s_add_u32 m0, s51, 50176
  s_nop 0
  buffer_load_dwordx4 v11, s[24:27], s54 offen lds
  s_mov_b64 exec, s[74:75]
  s_add_u32 m0, s48, 8192
  s_add_u32 s50, s57, 8192
  buffer_load_dwordx4 v20, s[36:39], s50 offen sc1 lds
  buffer_load_dwordx4 v20, s[36:39], s50 offen offset:1024 sc1 lds
  s_mov_b64 exec, -1
  s_waitcnt lgkmcnt(2)
  v_mfma_f32_32x32x16_bf16 v[128:143], a[24:27], v[92:95], v[128:143]
  s_add_u32 m0, s51, 51200
  s_add_u32 s54, s54, 16384
  buffer_load_dwordx4 v10, s[24:27], s54 offen lds
  s_mov_b64 exec, s[74:75]
  s_add_u32 m0, s48, 24576
  s_add_u32 s50, s57, 24576
  buffer_load_dwordx4 v20, s[36:39], s50 offen sc1 lds
  buffer_load_dwordx4 v20, s[36:39], s50 offen offset:1024 sc1 lds
  s_mov_b64 exec, -1
  v_xor_b32 v7, 192, v6
  v_mfma_f32_32x32x16_bf16 v[144:159], a[28:31], v[92:95], v[144:159]
  ds_read_b128 v[88:91], v7 offset:32768
  s_add_u32 m0, s51, 52224
  s_nop 0
  buffer_load_dwordx4 v11, s[24:27], s54 offen lds
  s_add_u32 s54, s54, 16384
  s_mov_b64 exec, s[74:75]
  s_add_u32 m0, s48, 40960
  s_add_u32 s50, s57, 40960
  buffer_load_dwordx4 v20, s[36:39], s50 offen sc1 lds
  buffer_load_dwordx4 v20, s[36:39], s50 offen offset:1024 sc1 lds
  s_mov_b64 exec, -1
  s_waitcnt lgkmcnt(2)
  v_mfma_f32_32x32x16_bf16 v[128:143], a[32:35], v[80:83], v[128:143]
  s_mov_b64 exec, s[74:75]
  s_add_u32 m0, s48, 57344
  s_add_u32 s50, s57, 57344
  buffer_load_dwordx4 v20, s[36:39], s50 offen sc1 lds
  buffer_load_dwordx4 v20, s[36:39], s50 offen offset:1024 sc1 lds
  s_mov_b64 exec, -1
  v_xor_b32 v7, 224, v6
  v_mfma_f32_32x32x16_bf16 v[144:159], a[36:39], v[80:83], v[144:159]
  ds_read_b128 v[92:95], v7 offset:32768
  s_waitcnt lgkmcnt(2)
  v_mfma_f32_32x32x16_bf16 v[128:143], a[40:43], v[84:87], v[128:143]
  v_mfma_f32_32x32x16_bf16 v[144:159], a[44:47], v[84:87], v[144:159]
  ds_read_b128 v[80:83], v6 offset:49152
  s_waitcnt lgkmcnt(2)
  v_mfma_f32_32x32x16_bf16 v[128:143], a[48:51], v[88:91], v[128:143]
  v_xor_b32 v7, 32, v6
  v_mfma_f32_32x32x16_bf16 v[144:159], a[52:55], v[88:91], v[144:159]
  ds_read_b128 v[84:87], v7 offset:49152
  s_waitcnt lgkmcnt(2)
  v_mfma_f32_32x32x16_bf16 v[128:143], a[56:59], v[92:95], v[128:143]
  v_xor_b32 v7, 64, v6
  v_mfma_f32_32x32x16_bf16 v[144:159], a[60:63], v[92:95], v[144:159]
  ds_read_b128 v[88:91], v7 offset:49152
  s_waitcnt lgkmcnt(2)
  v_mfma_f32_32x32x16_bf16 v[128:143], a[64:67], v[80:83], v[128:143]
  v_xor_b32 v7, 96, v6
  v_mfma_f32_32x32x16_bf16 v[144:159], a[68:71], v[80:83], v[144:159]
  ds_read_b128 v[92:95], v7 offset:49152
  s_waitcnt lgkmcnt(2)
  v_mfma_f32_32x32x16_bf16 v[128:143], a[72:75], v[84:87], v[128:143]
  v_xor_b32 v7, 128, v6
  v_mfma_f32_32x32x16_bf16 v[144:159], a[76:79], v[84:87], v[144:159]
  ds_read_b128 v[80:83], v7 offset:49152
  s_waitcnt lgkmcnt(2)
  v_mfma_f32_32x32x16_bf16 v[128:143], a[80:83], v[88:91], v[128:143]
  v_xor_b32 v7, 160, v6
  v_mfma_f32_32x32x16_bf16 v[144:159], a[84:87], v[88:91], v[144:159]
  ds_read_b128 v[84:87], v7 offset:49152
  s_waitcnt lgkmcnt(2)
  v_mfma_f32_32x32x16_bf16 v[128:143], a[88:91], v[92:95], v[128:143]
  v_xor_b32 v7, 192, v6
  v_mfma_f32_32x32x16_bf16 v[144:159], a[92:95], v[92:95], v[144:159]
  ds_read_b128 v[88:91], v7 offset:49152
  s_waitcnt lgkmcnt(2)
  v_mfma_f32_32x32x16_bf16 v[128:143], a[96:99], v[80:83], v[128:143]
  v_xor_b32 v7, 224, v6
  v_mfma_f32_32x32x16_bf16 v[144:159], a[100:103], v[80:83], v[144:159]
  ds_read_b128 v[92:95], v7 offset:49152
  s_waitcnt lgkmcnt(2)
  v_mfma_f32_32x32x16_bf16 v[128:143], a[104:107], v[84:87], v[128:143]
  v_mfma_f32_32x32x16_bf16 v[144:159], a[108:111], v[84:87], v[144:159]
  s_waitcnt lgkmcnt(1)
  v_mfma_f32_32x32x16_bf16 v[128:143], a[112:115], v[88:91], v[128:143]
  v_mfma_f32_32x32x16_bf16 v[144:159], a[116:119], v[88:91], v[144:159]
  s_waitcnt lgkmcnt(0)
  v_mfma_f32_32x32x16_bf16 v[128:143], a[120:123], v[92:95], v[128:143]
  v_mfma_f32_32x32x16_bf16 v[144:159], a[124:127], v[92:95], v[144:159]
  s_cmp_lg_u32 s74, 0
  s_cbranch_scc1 k2_h1ok
  s_add_u32 s56, s63, 12288
  s_mov_b32 s50, 0
  s_mov_b64 exec, 0xff
k2_ap3:
  buffer_load_dword v3, v24, s[36:39], s56 offen sc1
  s_add_u32 s50, s50, 1
  s_waitcnt vmcnt(0)
  v_cmp_ne_u32 vcc, 1, v3
  s_cmp_gt_u32 s50, 0x80000
  s_cbranch_scc1 k2_ad3
  s_nop 2
  s_cbranch_vccnz k2_ap3
k2_ad3:
  s_mov_b64 exec, -1
  s_add_u32 m0, s48, 8192
  s_add_u32 s50, s57, 8192
  buffer_load_dwordx4 v20, s[36:39], s50 offen sc1 lds
  buffer_load_dwordx4 v20, s[36:39], s50 offen offset:1024 sc1 lds
  s_add_u32 m0, s48, 24576
  s_add_u32 s50, s57, 24576
  buffer_load_dwordx4 v20, s[36:39], s50 offen sc1 lds
  buffer_load_dwordx4 v20, s[36:39], s50 offen offset:1024 sc1 lds
  s_add_u32 m0, s48, 40960
  s_add_u32 s50, s57, 40960
  buffer_load_dwordx4 v20, s[36:39], s50 offen sc1 lds
  buffer_load_dwordx4 v20, s[36:39], s50 offen offset:1024 sc1 lds
  s_add_u32 m0, s48, 57344
  s_add_u32 s50, s57, 57344
  buffer_load_dwordx4 v20, s[36:39], s50 offen sc1 lds
  buffer_load_dwordx4 v20, s[36:39], s50 offen offset:1024 sc1 lds
  s_waitcnt vmcnt(0)
k2_h1ok:
  s_waitcnt vmcnt(0)
  s_barrier
  ds_read_b128 v[80:83], v6 offset:8192
  v_xor_b32 v7, 32, v6
  ds_read_b128 v[84:87], v7 offset:8192
  v_xor_b32 v7, 64, v6
  ds_read_b128 v[88:91], v7 offset:8192
  s_waitcnt lgkmcnt(2)
  v_mfma_f32_32x32x16_bf16 v[160:175], a[128:131], v[80:83], v[192:207]
  v_xor_b32 v7, 96, v6
  v_mfma_f32_32x32x16_bf16 v[176:191], a[132:135], v[80:83], v[208:223]
  ds_read_b128 v[92:95], v7 offset:8192
  s_waitcnt lgkmcnt(2)
  v_mfma_f32_32x32x16_bf16 v[160:175], a[136:139], v[84:87], v[160:175]
  v_xor_b32 v7, 128, v6
  v_max_f32 v128, 0, v128
  v_max_f32 v129, 0, v129
  v_max_f32 v130, 0, v130
  v_max_f32 v131, 0, v131
  v_mfma_f32_32x32x16_bf16 v[176:191], a[140:143], v[84:87], v[176:191]
  ds_read_b128 v[80:83], v7 offset:8192
  v_max_f32 v132, 0, v132
  v_max_f32 v133, 0, v133
  v_max_f32 v134, 0, v134
  v_max_f32 v135, 0, v135
  s_waitcnt lgkmcnt(2)
  v_mfma_f32_32x32x16_bf16 v[160:175], a[144:147], v[88:91], v[160:175]
  ds_read_b64_tr_b16 a[128:129], v5 offset:0
  ds_read_b64_tr_b16 a[130:131], v5 offset:512
  v_xor_b32 v7, 160, v6
  v_max_f32 v136, 0, v136
  v_max_f32 v137, 0, v137
  v_mfma_f32_32x32x16_bf16 v[176:191], a[148:151], v[88:91], v[176:191]
  ds_read_b128 v[84:87], v7 offset:8192
  ds_read_b64_tr_b16 a[132:133], v5 offset:256
  ds_read_b64_tr_b16 a[134:135], v5 offset:768
  v_max_f32 v138, 0, v138
  v_max_f32 v139, 0, v139
  s_waitcnt lgkmcnt(6)
  v_mfma_f32_32x32x16_bf16 v[160:175], a[152:155], v[92:95], v[160:175]
  ds_read_b64_tr_b16 a[136:137], v5 offset:2048
  ds_read_b64_tr_b16 a[138:139], v5 offset:2560
  v_xor_b32 v7, 192, v6
  v_max_f32 v140, 0, v140
  v_max_f32 v141, 0, v141
  v_mfma_f32_32x32x16_bf16 v[176:191], a[156:159], v[92:95], v[176:191]
  ds_read_b128 v[88:91], v7 offset:8192
  ds_read_b64_tr_b16 a[140:141], v5 offset:2304
  ds_read_b64_tr_b16 a[142:143], v5 offset:2816
  v_max_f32 v142, 0, v142
  v_max_f32 v143, 0, v143
  s_waitcnt lgkmcnt(10)
  v_mfma_f32_32x32x16_bf16 v[160:175], a[160:163], v[80:83], v[160:175]
  ds_read_b64_tr_b16 a[144:145], v5 offset:16384
  ds_read_b64_tr_b16 a[146:147], v5 offset:16896
  s_waitcnt lgkmcnt(2)
  s_add_u32 m0, s51, 65536
  s_nop 0
  buffer_load_dwordx4 v10, s[24:27], s54 offen lds
  v_xor_b32 v7, 224, v6
  v_mfma_f32_32x32x16_bf16 v[176:191], a[164:167], v[80:83], v[176:191]
  ds_read_b128 v[92:95], v7 offset:8192
  ds_read_b64_tr_b16 a[148:149], v5 offset:16640
  ds_read_b64_tr_b16 a[150:151], v5 offset:17152
  s_add_u32 m0, s51, 66560
  s_nop 0
  buffer_load_dwordx4 v11, s[24:27], s54 offen lds
  v_mfma_f32_32x32x16_bf16 v[160:175], a[168:171], v[84:87], v[160:175]
  ds_read_b64_tr_b16 a[152:153], v5 offset:18432
  ds_read_b64_tr_b16 a[154:155], v5 offset:18944
  s_add_u32 m0, s51, 67584
  s_add_u32 s54, s54, 16384
  buffer_load_dwordx4 v10, s[24:27], s54 offen lds
  v_mfma_f32_32x32x16_bf16 v[176:191], a[172:175], v[84:87], v[176:191]
  ds_read_b128 v[80:83], v6 offset:24576
  ds_read_b64_tr_b16 a[156:157], v5 offset:18688
  ds_read_b64_tr_b16 a[158:159], v5 offset:19200
  s_add_u32 m0, s51, 68608
  s_nop 0
  buffer_load_dwordx4 v11, s[24:27], s54 offen lds
  s_add_u32 s54, s54, 16384
  v_mfma_f32_32x32x16_bf16 v[160:175], a[176:179], v[88:91], v[160:175]
  ds_read_b64_tr_b16 a[160:161], v4 offset:0
  ds_read_b64_tr_b16 a[162:163], v4 offset:512
  v_xor_b32 v7, 32, v6
  v_mul_f32 v128, v128, v128
  v_mul_f32 v129, v129, v129
  v_mfma_f32_32x32x16_bf16 v[176:191], a[180:183], v[88:91], v[176:191]
  ds_read_b128 v[84:87], v7 offset:24576
  ds_read_b64_tr_b16 a[164:165], v4 offset:256
  ds_read_b64_tr_b16 a[166:167], v4 offset:768
  v_mul_f32 v130, v130, v130
  v_mul_f32 v131, v131, v131
  s_waitcnt lgkmcnt(12)
  v_mfma_f32_32x32x16_bf16 v[160:175], a[184:187], v[92:95], v[160:175]
  ds_read_b64_tr_b16 a[168:169], v4 offset:2048
  ds_read_b64_tr_b16 a[170:171], v4 offset:2560
  v_xor_b32 v7, 64, v6
  v_mul_f32 v132, v132, v132
  v_mul_f32 v133, v133, v133
  v_mfma_f32_32x32x16_bf16 v[176:191], a[188:191], v[92:95], v[176:191]
  ds_read_b128 v[88:91], v7 offset:24576
  ds_read_b64_tr_b16 a[172:173], v4 offset:2304
  ds_read_b64_tr_b16 a[174:175], v4 offset:2816
  v_mul_f32 v134, v134, v134
  v_mul_f32 v135, v135, v135
  s_waitcnt lgkmcnt(12)
  v_mfma_f32_32x32x16_bf16 v[160:175], a[192:195], v[80:83], v[160:175]
  ds_read_b64_tr_b16 a[176:177], v4 offset:16384
  ds_read_b64_tr_b16 a[178:179], v4 offset:16896
  s_waitcnt lgkmcnt(12)
  s_add_u32 m0, s51, 81920
  s_nop 0
  buffer_load_dwordx4 v10, s[24:27], s54 offen lds
  v_xor_b32 v7, 96, v6
  v_mfma_f32_32x32x16_bf16 v[176:191], a[196:199], v[80:83], v[176:191]
  ds_read_b128 v[92:95], v7 offset:24576
  ds_read_b64_tr_b16 a[180:181], v4 offset:16640
  ds_read_b64_tr_b16 a[182:183], v4 offset:17152
  s_add_u32 m0, s51, 82944
  s_nop 0
  buffer_load_dwordx4 v11, s[24:27], s54 offen lds
  s_waitcnt lgkmcnt(12)
  v_mfma_f32_32x32x16_bf16 v[160:175], a[200:203], v[84:87], v[160:175]
  ds_read_b64_tr_b16 a[184:185], v4 offset:18432
  ds_read_b64_tr_b16 a[186:187], v4 offset:18944
  s_add_u32 m0, s51, 83968
  s_add_u32 s54, s54, 16384
  buffer_load_dwordx4 v10, s[24:27], s54 offen lds
  v_xor_b32 v7, 128, v6
  v_mfma_f32_32x32x16_bf16 v[176:191], a[204:207], v[84:87], v[176:191]
  ds_read_b128 v[80:83], v7 offset:24576
  ds_read_b64_tr_b16 a[188:189], v4 offset:18688
  ds_read_b64_tr_b16 a[190:191], v4 offset:19200
  s_add_u32 m0, s51, 84992
  s_nop 0
  buffer_load_dwordx4 v11, s[24:27], s54 offen lds
  s_add_u32 s54, s54, 16384
  s_waitcnt lgkmcnt(12)
  v_mfma_f32_32x32x16_bf16 v[160:175], a[208:211], v[88:91], v[160:175]
  ds_read_b64_tr_b16 a[192:193], v4 offset:32768
  ds_read_b64_tr_b16 a[194:195], v4 offset:33280
  v_xor_b32 v7, 160, v6
  v_mul_f32 v136, v136, v136
  v_mul_f32 v137, v137, v137
  v_mfma_f32_32x32x16_bf16 v[176:191], a[212:215], v[88:91], v[176:191]
  ds_read_b128 v[84:87], v7 offset:24576
  ds_read_b64_tr_b16 a[196:197], v4 offset:33024
  ds_read_b64_tr_b16 a[198:199], v4 offset:33536
  v_mul_f32 v138, v138, v138
  v_mul_f32 v139, v139, v139
  s_waitcnt lgkmcnt(12)
  v_mfma_f32_32x32x16_bf16 v[160:175], a[216:219], v[92:95], v[160:175]
  ds_read_b64_tr_b16 a[200:201], v4 offset:34816
  ds_read_b64_tr_b16 a[202:203], v4 offset:35328
  v_xor_b32 v7, 192, v6
  v_mul_f32 v140, v140, v140
  v_mul_f32 v141, v141, v141
  v_mfma_f32_32x32x16_bf16 v[176:191], a[220:223], v[92:95], v[176:191]
  ds_read_b128 v[88:91], v7 offset:24576
  ds_read_b64_tr_b16 a[204:205], v4 offset:35072
  ds_read_b64_tr_b16 a[206:207], v4 offset:35584
  v_mul_f32 v142, v142, v142
  v_mul_f32 v143, v143, v143
  s_waitcnt lgkmcnt(12)
  v_mfma_f32_32x32x16_bf16 v[160:175], a[224:227], v[80:83], v[160:175]
  ds_read_b64_tr_b16 a[208:209], v4 offset:49152
  ds_read_b64_tr_b16 a[210:211], v4 offset:49664
  s_add_u32 m0, s51, 0
  s_sub_u32 s54, s54, 262016
  buffer_load_dwordx4 v10, s[24:27], s54 offen lds
  v_xor_b32 v7, 224, v6
  v_mfma_f32_32x32x16_bf16 v[176:191], a[228:231], v[80:83], v[176:191]
  ds_read_b128 v[92:95], v7 offset:24576
  ds_read_b64_tr_b16 a[212:213], v4 offset:49408
  ds_read_b64_tr_b16 a[214:215], v4 offset:49920
  s_add_u32 m0, s51, 1024
  s_nop 0
  buffer_load_dwordx4 v11, s[24:27], s54 offen lds
  s_waitcnt lgkmcnt(12)
  v_mfma_f32_32x32x16_bf16 v[160:175], a[232:235], v[84:87], v[160:175]
  ds_read_b64_tr_b16 a[216:217], v4 offset:51200
  ds_read_b64_tr_b16 a[218:219], v4 offset:51712
  s_add_u32 m0, s51, 2048
  s_add_u32 s54, s54, 16384
  buffer_load_dwordx4 v10, s[24:27], s54 offen lds
  v_mfma_f32_32x32x16_bf16 v[176:191], a[236:239], v[84:87], v[176:191]
  ds_read_b128 v[80:83], v6 offset:40960
  ds_read_b64_tr_b16 a[220:221], v4 offset:51456
  ds_read_b64_tr_b16 a[222:223], v4 offset:51968
  s_add_u32 m0, s51, 3072
  s_nop 0
  buffer_load_dwordx4 v11, s[24:27], s54 offen lds
  s_add_u32 s54, s54, 16384
  s_waitcnt lgkmcnt(12)
  v_mfma_f32_32x32x16_bf16 v[160:175], a[240:243], v[88:91], v[160:175]
  v_xor_b32 v7, 32, v6
  v_cvt_pk_bf16_f32 v128, v128, v129
  v_cvt_pk_bf16_f32 v129, v130, v131
  v_cvt_pk_bf16_f32 v130, v132, v133
  v_cvt_pk_bf16_f32 v131, v134, v135
  v_mfma_f32_32x32x16_bf16 v[176:191], a[244:247], v[88:91], v[176:191]
  ds_read_b128 v[84:87], v7 offset:40960
  v_cvt_pk_bf16_f32 v132, v136, v137
  v_cvt_pk_bf16_f32 v133, v138, v139
  v_cvt_pk_bf16_f32 v134, v140, v141
  s_waitcnt lgkmcnt(8)
  v_mfma_f32_32x32x16_bf16 v[160:175], a[248:251], v[92:95], v[160:175]
  v_xor_b32 v7, 64, v6
  v_cvt_pk_bf16_f32 v135, v142, v143
  v_max_f32 v144, 0, v144
  v_max_f32 v145, 0, v145
  v_max_f32 v146, 0, v146
  v_mfma_f32_32x32x16_bf16 v[176:191], a[252:255], v[92:95], v[176:191]
  ds_read_b128 v[88:91], v7 offset:40960
  v_max_f32 v147, 0, v147
  v_max_f32 v148, 0, v148
  v_max_f32 v149, 0, v149
  v_max_f32 v150, 0, v150
  s_waitcnt lgkmcnt(4)
  v_mfma_f32_32x32x16_bf16 v[160:175], a[0:3], v[80:83], v[160:175]
  s_add_u32 m0, s51, 16384
  s_nop 0
  buffer_load_dwordx4 v10, s[24:27], s54 offen lds
  v_xor_b32 v7, 96, v6
  v_max_f32 v151, 0, v151
  v_mfma_f32_32x32x16_bf16 v[176:191], a[4:7], v[80:83], v[176:191]
  ds_read_b128 v[92:95], v7 offset:40960
  s_add_u32 m0, s51, 17408
  s_nop 0
  buffer_load_dwordx4 v11, s[24:27], s54 offen lds
  v_max_f32 v152, 0, v152
  s_waitcnt lgkmcnt(2)
  v_mfma_f32_32x32x16_bf16 v[160:175], a[8:11], v[84:87], v[160:175]
  s_add_u32 m0, s51, 18432
  s_add_u32 s54, s54, 16384
  buffer_load_dwordx4 v10, s[24:27], s54 offen lds
  v_xor_b32 v7, 128, v6
  v_max_f32 v153, 0, v153
  v_max_f32 v154, 0, v154
  v_mfma_f32_32x32x16_bf16 v[176:191], a[12:15], v[84:87], v[176:191]
  ds_read_b128 v[80:83], v7 offset:40960
  s_add_u32 m0, s51, 19456
  s_nop 0
  buffer_load_dwordx4 v11, s[24:27], s54 offen lds
  s_add_u32 s54, s54, 16384
  v_max_f32 v155, 0, v155
  s_waitcnt lgkmcnt(2)
  v_mfma_f32_32x32x16_bf16 v[160:175], a[16:19], v[88:91], v[160:175]
  v_xor_b32 v7, 160, v6
  v_max_f32 v156, 0, v156
  v_max_f32 v157, 0, v157
  v_max_f32 v158, 0, v158
  v_max_f32 v159, 0, v159
  v_mfma_f32_32x32x16_bf16 v[176:191], a[20:23], v[88:91], v[176:191]
  ds_read_b128 v[84:87], v7 offset:40960
  v_mul_f32 v144, v144, v144
  v_mul_f32 v145, v145, v145
  v_mul_f32 v146, v146, v146
  v_mul_f32 v147, v147, v147
  s_waitcnt lgkmcnt(2)
  v_mfma_f32_32x32x16_bf16 v[160:175], a[24:27], v[92:95], v[160:175]
  v_xor_b32 v7, 192, v6
  v_mul_f32 v148, v148, v148
  v_mul_f32 v149, v149, v149
  v_mul_f32 v150, v150, v150
  v_mul_f32 v151, v151, v151
  v_mfma_f32_32x32x16_bf16 v[176:191], a[28:31], v[92:95], v[176:191]
  ds_read_b128 v[88:91], v7 offset:40960
  v_mul_f32 v152, v152, v152
  v_mul_f32 v153, v153, v153
  v_mul_f32 v154, v154, v154
  v_mul_f32 v155, v155, v155
  s_waitcnt lgkmcnt(2)
  v_mfma_f32_32x32x16_bf16 v[160:175], a[32:35], v[80:83], v[160:175]
  s_add_u32 m0, s51, 32768
  s_nop 0
  buffer_load_dwordx4 v10, s[24:27], s54 offen lds
  v_xor_b32 v7, 224, v6
  v_mul_f32 v156, v156, v156
  v_mfma_f32_32x32x16_bf16 v[176:191], a[36:39], v[80:83], v[176:191]
  ds_read_b128 v[92:95], v7 offset:40960
  s_add_u32 m0, s51, 33792
  s_nop 0
  buffer_load_dwordx4 v11, s[24:27], s54 offen lds
  v_mul_f32 v157, v157, v157
  v_mul_f32 v158, v158, v158
  s_waitcnt lgkmcnt(2)
  v_mfma_f32_32x32x16_bf16 v[160:175], a[40:43], v[84:87], v[160:175]
  s_add_u32 m0, s51, 34816
  s_add_u32 s54, s54, 16384
  buffer_load_dwordx4 v10, s[24:27], s54 offen lds
  v_mul_f32 v159, v159, v159
  v_cvt_pk_bf16_f32 v144, v144, v145
  v_mfma_f32_32x32x16_bf16 v[176:191], a[44:47], v[84:87], v[176:191]
  ds_read_b128 v[80:83], v6 offset:57344
  s_add_u32 m0, s51, 35840
  s_nop 0
  buffer_load_dwordx4 v11, s[24:27], s54 offen lds
  s_add_u32 s54, s54, 16384
  v_cvt_pk_bf16_f32 v145, v146, v147
  s_waitcnt lgkmcnt(2)
  v_mfma_f32_32x32x16_bf16 v[160:175], a[48:51], v[88:91], v[160:175]
  s_waitcnt vmcnt(16)
  ds_read_b64_tr_b16 a[224:225], v5 offset:0
  ds_read_b64_tr_b16 a[226:227], v5 offset:512
  v_xor_b32 v7, 32, v6
  v_cvt_pk_bf16_f32 v146, v148, v149
  v_mfma_f32_32x32x16_bf16 v[176:191], a[52:55], v[88:91], v[176:191]
  ds_read_b128 v[84:87], v7 offset:57344
  ds_read_b64_tr_b16 a[228:229], v5 offset:256
  ds_read_b64_tr_b16 a[230:231], v5 offset:768
  v_cvt_pk_bf16_f32 v147, v150, v151
  v_cvt_pk_bf16_f32 v148, v152, v153
  s_waitcnt lgkmcnt(6)
  v_mfma_f32_32x32x16_bf16 v[160:175], a[56:59], v[92:95], v[160:175]
  ds_read_b64_tr_b16 a[232:233], v5 offset:2048
  ds_read_b64_tr_b16 a[234:235], v5 offset:2560
  v_xor_b32 v7, 64, v6
  v_cvt_pk_bf16_f32 v149, v154, v155
  v_mfma_f32_32x32x16_bf16 v[176:191], a[60:63], v[92:95], v[176:191]
  ds_read_b128 v[88:91], v7 offset:57344
  ds_read_b64_tr_b16 a[236:237], v5 offset:2304
  ds_read_b64_tr_b16 a[238:239], v5 offset:2816
  v_cvt_pk_bf16_f32 v150, v156, v157
  v_cvt_pk_bf16_f32 v151, v158, v159
  s_waitcnt lgkmcnt(10)
  v_mfma_f32_32x32x16_bf16 v[160:175], a[64:67], v[80:83], v[160:175]
  v_xor_b32 v7, 96, v6
  v_mfma_f32_32x32x16_bf16 v[176:191], a[68:71], v[80:83], v[176:191]
  ds_read_b128 v[92:95], v7 offset:57344
  s_waitcnt lgkmcnt(8)
  v_mfma_f32_32x32x16_bf16 v[160:175], a[72:75], v[84:87], v[160:175]
  v_xor_b32 v7, 128, v6
  v_mfma_f32_32x32x16_bf16 v[176:191], a[76:79], v[84:87], v[176:191]
  ds_read_b128 v[80:83], v7 offset:57344
  s_waitcnt lgkmcnt(4)
  v_mfma_f32_32x32x16_bf16 v[160:175], a[80:83], v[88:91], v[160:175]
  s_waitcnt vmcnt(12)
  ds_read_b64_tr_b16 a[240:241], v5 offset:16384
  ds_read_b64_tr_b16 a[242:243], v5 offset:16896
  ds_write_b128 v25, v[128:131] offset:0
  ds_write_b128 v26, v[132:135] offset:0
  ds_write_b128 v27, v[144:147] offset:0
  ds_write_b128 v23, v[148:151] offset:0
  v_xor_b32 v7, 160, v6
  v_mfma_f32_32x32x16_bf16 v[176:191], a[84:87], v[88:91], v[176:191]
  ds_read_b128 v[84:87], v7 offset:57344
  ds_read_b64_tr_b16 a[244:245], v5 offset:16640
  ds_read_b64_tr_b16 a[246:247], v5 offset:17152
  s_waitcnt lgkmcnt(10)
  v_mfma_f32_32x32x16_bf16 v[160:175], a[88:91], v[92:95], v[160:175]
  ds_read_b64_tr_b16 a[248:249], v5 offset:18432
  ds_read_b64_tr_b16 a[250:251], v5 offset:18944
  s_add_u32 m0, s51, 49152
  s_nop 0
  buffer_load_dwordx4 v10, s[24:27], s54 offen lds
  v_xor_b32 v7, 192, v6
  v_mfma_f32_32x32x16_bf16 v[176:191], a[92:95], v[92:95], v[176:191]
  ds_read_b128 v[88:91], v7 offset:57344
  ds_read_b64_tr_b16 a[252:253], v5 offset:18688
  ds_read_b64_tr_b16 a[254:255], v5 offset:19200
  s_add_u32 m0, s51, 50176
  s_nop 0
  buffer_load_dwordx4 v11, s[24:27], s54 offen lds
  s_waitcnt lgkmcnt(14)
  v_mfma_f32_32x32x16_bf16 v[160:175], a[96:99], v[80:83], v[160:175]
  s_add_u32 m0, s51, 51200
  s_add_u32 s54, s54, 16384
  buffer_load_dwordx4 v10, s[24:27], s54 offen lds
  v_xor_b32 v7, 224, v6
  v_mfma_f32_32x32x16_bf16 v[176:191], a[100:103], v[80:83], v[176:191]
  ds_read_b128 v[92:95], v7 offset:57344
  s_add_u32 m0, s51, 52224
  s_nop 0
  buffer_load_dwordx4 v11, s[24:27], s54 offen lds
  s_add_u32 s54, s54, 16384
  s_waitcnt lgkmcnt(8)
  v_mfma_f32_32x32x16_bf16 v[160:175], a[104:107], v[84:87], v[160:175]
  v_mfma_f32_32x32x16_bf16 v[176:191], a[108:111], v[84:87], v[176:191]
  s_waitcnt lgkmcnt(0)
  s_barrier
  ds_read_b128 v[80:83], v6 offset:0
  v_mfma_f32_32x32x16_bf16 v[160:175], a[112:115], v[88:91], v[160:175]
  s_waitcnt vmcnt(12)
  ds_read_b64_tr_b16 a[0:1], v4 offset:0
  ds_read_b64_tr_b16 a[2:3], v4 offset:512
  v_xor_b32 v7, 32, v6
  v_mfma_f32_32x32x16_bf16 v[176:191], a[116:119], v[88:91], v[176:191]
  ds_read_b128 v[84:87], v7 offset:0
  ds_read_b64_tr_b16 a[4:5], v4 offset:256
  ds_read_b64_tr_b16 a[6:7], v4 offset:768
  v_mfma_f32_32x32x16_bf16 v[160:175], a[120:123], v[92:95], v[160:175]
  ds_read_b64_tr_b16 a[8:9], v4 offset:2048
  ds_read_b64_tr_b16 a[10:11], v4 offset:2560
  s_add_u32 m0, s51, 65536
  s_nop 0
  buffer_load_dwordx4 v10, s[24:27], s54 offen lds
  v_xor_b32 v7, 64, v6
  v_mfma_f32_32x32x16_bf16 v[176:191], a[124:127], v[92:95], v[176:191]
  ds_read_b128 v[88:91], v7 offset:0
  ds_read_b64_tr_b16 a[12:13], v4 offset:2304
  ds_read_b64_tr_b16 a[14:15], v4 offset:2816
  s_add_u32 m0, s51, 66560
  s_nop 0
  buffer_load_dwordx4 v11, s[24:27], s54 offen lds
  s_waitcnt lgkmcnt(10)
  v_mfma_f32_32x32x16_bf16 v[192:207], a[128:131], v[80:83], 0
  s_add_u32 m0, s51, 67584
  s_add_u32 s54, s54, 16384
  buffer_load_dwordx4 v10, s[24:27], s54 offen lds
  v_xor_b32 v7, 96, v6
  v_mfma_f32_32x32x16_bf16 v[208:223], a[132:135], v[80:83], 0
  ds_read_b128 v[92:95], v7 offset:0
  s_add_u32 m0, s51, 68608
  s_nop 0
  buffer_load_dwordx4 v11, s[24:27], s54 offen lds
  s_add_u32 s54, s54, 16384
  s_waitcnt lgkmcnt(8)
  v_mfma_f32_32x32x16_bf16 v[192:207], a[136:139], v[84:87], v[192:207]
  v_xor_b32 v7, 128, v6
  v_mfma_f32_32x32x16_bf16 v[208:223], a[140:143], v[84:87], v[208:223]
  ds_read_b128 v[80:83], v7 offset:0
  s_waitcnt lgkmcnt(4)
  v_mfma_f32_32x32x16_bf16 v[192:207], a[144:147], v[88:91], v[192:207]
  s_waitcnt vmcnt(12)
  ds_read_b64_tr_b16 a[16:17], v4 offset:16384
  ds_read_b64_tr_b16 a[18:19], v4 offset:16896
  v_xor_b32 v7, 160, v6
  v_max_f32 v160, 0, v160
  v_mfma_f32_32x32x16_bf16 v[208:223], a[148:151], v[88:91], v[208:223]
  ds_read_b128 v[84:87], v7 offset:0
  ds_read_b64_tr_b16 a[20:21], v4 offset:16640
  ds_read_b64_tr_b16 a[22:23], v4 offset:17152
  v_max_f32 v161, 0, v161
  v_max_f32 v162, 0, v162
  s_waitcnt lgkmcnt(6)
  v_mfma_f32_32x32x16_bf16 v[192:207], a[152:155], v[92:95], v[192:207]
  ds_read_b64_tr_b16 a[24:25], v4 offset:18432
  ds_read_b64_tr_b16 a[26:27], v4 offset:18944
  s_add_u32 m0, s51, 81920
  s_nop 0
  buffer_load_dwordx4 v10, s[24:27], s54 offen lds
  v_xor_b32 v7, 192, v6
  v_mfma_f32_32x32x16_bf16 v[208:223], a[156:159], v[92:95], v[208:223]
  ds_read_b128 v[88:91], v7 offset:0
  ds_read_b64_tr_b16 a[28:29], v4 offset:18688
  ds_read_b64_tr_b16 a[30:31], v4 offset:19200
  s_add_u32 m0, s51, 82944
  s_nop 0
  buffer_load_dwordx4 v11, s[24:27], s54 offen lds
  s_waitcnt lgkmcnt(10)
  v_mfma_f32_32x32x16_bf16 v[192:207], a[160:163], v[80:83], v[192:207]
  s_add_u32 m0, s51, 83968
  s_add_u32 s54, s54, 16384
  buffer_load_dwordx4 v10, s[24:27], s54 offen lds
  v_xor_b32 v7, 224, v6
  v_max_f32 v163, 0, v163
  v_mfma_f32_32x32x16_bf16 v[208:223], a[164:167], v[80:83], v[208:223]
  ds_read_b128 v[92:95], v7 offset:0
  s_add_u32 m0, s51, 84992
  s_nop 0
  buffer_load_dwordx4 v11, s[24:27], s54 offen lds
  s_add_u32 s54, s54, 16384
  v_max_f32 v164, 0, v164
  s_waitcnt lgkmcnt(8)
  v_mfma_f32_32x32x16_bf16 v[192:207], a[168:171], v[84:87], v[192:207]
  v_max_f32 v165, 0, v165
  v_max_f32 v166, 0, v166
  v_max_f32 v167, 0, v167
  v_max_f32 v168, 0, v168
  v_mfma_f32_32x32x16_bf16 v[208:223], a[172:175], v[84:87], v[208:223]
  ds_read_b128 v[80:83], v6 offset:16384
  v_max_f32 v169, 0, v169
  v_max_f32 v170, 0, v170
  v_max_f32 v171, 0, v171
  v_max_f32 v172, 0, v172
  s_waitcnt lgkmcnt(4)
  v_mfma_f32_32x32x16_bf16 v[192:207], a[176:179], v[88:91], v[192:207]
  s_waitcnt vmcnt(12)
  ds_read_b64_tr_b16 a[32:33], v4 offset:32768
  ds_read_b64_tr_b16 a[34:35], v4 offset:33280
  v_xor_b32 v7, 32, v6
  v_max_f32 v173, 0, v173
  v_mfma_f32_32x32x16_bf16 v[208:223], a[180:183], v[88:91], v[208:223]
  ds_read_b128 v[84:87], v7 offset:16384
  ds_read_b64_tr_b16 a[36:37], v4 offset:33024
  ds_read_b64_tr_b16 a[38:39], v4 offset:33536
  v_max_f32 v174, 0, v174
  v_max_f32 v175, 0, v175
  s_waitcnt lgkmcnt(6)
  v_mfma_f32_32x32x16_bf16 v[192:207], a[184:187], v[92:95], v[192:207]
  ds_read_b64_tr_b16 a[40:41], v4 offset:34816
  ds_read_b64_tr_b16 a[42:43], v4 offset:35328
  s_add_u32 m0, s51, 0
  s_nop 0
  buffer_load_dwordx4 v10, s[24:27], s54 offen lds
  v_xor_b32 v7, 64, v6
  v_mfma_f32_32x32x16_bf16 v[208:223], a[188:191], v[92:95], v[208:223]
  ds_read_b128 v[88:91], v7 offset:16384
  ds_read_b64_tr_b16 a[44:45], v4 offset:35072
  ds_read_b64_tr_b16 a[46:47], v4 offset:35584
  s_add_u32 m0, s51, 1024
  s_nop 0
  buffer_load_dwordx4 v11, s[24:27], s54 offen lds
  s_waitcnt lgkmcnt(10)
  v_mfma_f32_32x32x16_bf16 v[192:207], a[192:195], v[80:83], v[192:207]
  s_add_u32 m0, s51, 2048
  s_add_u32 s54, s54, 16384
  buffer_load_dwordx4 v10, s[24:27], s54 offen lds
  v_xor_b32 v7, 96, v6
  v_mul_f32 v160, v160, v160
  v_mfma_f32_32x32x16_bf16 v[208:223], a[196:199], v[80:83], v[208:223]
  ds_read_b128 v[92:95], v7 offset:16384
  s_add_u32 m0, s51, 3072
  s_nop 0
  buffer_load_dwordx4 v11, s[24:27], s54 offen lds
  s_add_u32 s54, s54, 16384
  v_mul_f32 v161, v161, v161
  s_waitcnt lgkmcnt(8)
  v_mfma_f32_32x32x16_bf16 v[192:207], a[200:203], v[84:87], v[192:207]
  v_xor_b32 v7, 128, v6
  v_mul_f32 v162, v162, v162
  v_mul_f32 v163, v163, v163
  v_mul_f32 v164, v164, v164
  v_mfma_f32_32x32x16_bf16 v[208:223], a[204:207], v[84:87], v[208:223]
  ds_read_b128 v[80:83], v7 offset:16384
  v_mul_f32 v165, v165, v165
  v_mul_f32 v166, v166, v166
  v_mul_f32 v167, v167, v167
  v_mul_f32 v168, v168, v168
  s_waitcnt lgkmcnt(4)
  v_mfma_f32_32x32x16_bf16 v[192:207], a[208:211], v[88:91], v[192:207]
  v_xor_b32 v7, 160, v6
  v_mul_f32 v169, v169, v169
  v_mul_f32 v170, v170, v170
  v_mul_f32 v171, v171, v171
  v_mul_f32 v172, v172, v172
  v_mfma_f32_32x32x16_bf16 v[208:223], a[212:215], v[88:91], v[208:223]
  ds_read_b128 v[84:87], v7 offset:16384
  v_mul_f32 v173, v173, v173
  v_mul_f32 v174, v174, v174
  v_mul_f32 v175, v175, v175
  s_waitcnt lgkmcnt(2)
  v_mfma_f32_32x32x16_bf16 v[192:207], a[216:219], v[92:95], v[192:207]
  s_add_u32 m0, s51, 16384
  s_nop 0
  buffer_load_dwordx4 v10, s[24:27], s54 offen lds
  v_xor_b32 v7, 192, v6
  v_cvt_pk_bf16_f32 v160, v160, v161
  v_mfma_f32_32x32x16_bf16 v[208:223], a[220:223], v[92:95], v[208:223]
  ds_read_b128 v[88:91], v7 offset:16384
  s_add_u32 m0, s51, 17408
  s_nop 0
  buffer_load_dwordx4 v11, s[24:27], s54 offen lds
  v_cvt_pk_bf16_f32 v161, v162, v163
  s_waitcnt lgkmcnt(2)
  v_mfma_f32_32x32x16_bf16 v[192:207], a[224:227], v[80:83], v[192:207]
  s_add_u32 m0, s51, 18432
  s_add_u32 s54, s54, 16384
  buffer_load_dwordx4 v10, s[24:27], s54 offen lds
  v_xor_b32 v7, 224, v6
  v_cvt_pk_bf16_f32 v162, v164, v165
  v_mfma_f32_32x32x16_bf16 v[208:223], a[228:231], v[80:83], v[208:223]
  ds_read_b128 v[92:95], v7 offset:16384
  s_add_u32 m0, s51, 19456
  s_nop 0
  buffer_load_dwordx4 v11, s[24:27], s54 offen lds
  s_add_u32 s54, s54, 16384
  s_waitcnt lgkmcnt(2)
  v_mfma_f32_32x32x16_bf16 v[192:207], a[232:235], v[84:87], v[192:207]
  s_waitcnt vmcnt(16)
  ds_read_b64_tr_b16 a[48:49], v4 offset:49152
  ds_read_b64_tr_b16 a[50:51], v4 offset:49664
  v_cvt_pk_bf16_f32 v163, v166, v167
  v_cvt_pk_bf16_f32 v164, v168, v169
  v_mfma_f32_32x32x16_bf16 v[208:223], a[236:239], v[84:87], v[208:223]
  ds_read_b128 v[80:83], v6 offset:0
  ds_read_b64_tr_b16 a[52:53], v4 offset:49408
  ds_read_b64_tr_b16 a[54:55], v4 offset:49920
  v_cvt_pk_bf16_f32 v165, v170, v171
  v_cvt_pk_bf16_f32 v166, v172, v173
  s_waitcnt lgkmcnt(6)
  v_mfma_f32_32x32x16_bf16 v[192:207], a[240:243], v[88:91], v[192:207]
  ds_read_b64_tr_b16 a[56:57], v4 offset:51200
  ds_read_b64_tr_b16 a[58:59], v4 offset:51712
  v_xor_b32 v7, 32, v6
  v_cvt_pk_bf16_f32 v167, v174, v175
  v_mfma_f32_32x32x16_bf16 v[208:223], a[244:247], v[88:91], v[208:223]
  ds_read_b128 v[84:87], v7 offset:0
  ds_read_b64_tr_b16 a[60:61], v4 offset:51456
  ds_read_b64_tr_b16 a[62:63], v4 offset:51968
  v_max_f32 v176, 0, v176
  v_max_f32 v177, 0, v177
  s_waitcnt lgkmcnt(10)
  v_mfma_f32_32x32x16_bf16 v[192:207], a[248:251], v[92:95], v[192:207]
  v_xor_b32 v7, 64, v6
  v_max_f32 v178, 0, v178
  v_max_f32 v179, 0, v179
  v_max_f32 v180, 0, v180
  v_mfma_f32_32x32x16_bf16 v[208:223], a[252:255], v[92:95], v[208:223]
  ds_read_b128 v[88:91], v7 offset:0
  v_max_f32 v181, 0, v181
  v_max_f32 v182, 0, v182
  v_max_f32 v183, 0, v183
  v_max_f32 v184, 0, v184
  s_waitcnt lgkmcnt(8)
  v_mfma_f32_32x32x16_bf16 v[224:239], a[0:3], v[80:83], 0
  v_xor_b32 v7, 96, v6
  v_max_f32 v185, 0, v185
  v_max_f32 v186, 0, v186
  v_max_f32 v187, 0, v187
  v_max_f32 v188, 0, v188
  v_mfma_f32_32x32x16_bf16 v[240:255], a[4:7], v[80:83], 0
  ds_read_b128 v[92:95], v7 offset:0
  v_max_f32 v189, 0, v189
  v_max_f32 v190, 0, v190
  v_max_f32 v191, 0, v191
  v_mul_f32 v176, v176, v176
  s_waitcnt lgkmcnt(4)
  v_mfma_f32_32x32x16_bf16 v[224:239], a[8:11], v[84:87], v[224:239]
  s_waitcnt vmcnt(12)
  ds_read_b64_tr_b16 a[64:65], v5 offset:0
  ds_read_b64_tr_b16 a[66:67], v5 offset:512
  v_xor_b32 v7, 128, v6
  v_mul_f32 v177, v177, v177
  v_mfma_f32_32x32x16_bf16 v[240:255], a[12:15], v[84:87], v[240:255]
  ds_read_b128 v[80:83], v7 offset:0
  ds_read_b64_tr_b16 a[68:69], v5 offset:256
  ds_read_b64_tr_b16 a[70:71], v5 offset:768
  v_mul_f32 v178, v178, v178
  v_mul_f32 v179, v179, v179
  s_waitcnt lgkmcnt(6)
  v_mfma_f32_32x32x16_bf16 v[224:239], a[16:19], v[88:91], v[224:239]
  ds_read_b64_tr_b16 a[72:73], v5 offset:2048
  ds_read_b64_tr_b16 a[74:75], v5 offset:2560
  v_xor_b32 v7, 160, v6
  v_mul_f32 v180, v180, v180
  v_mfma_f32_32x32x16_bf16 v[240:255], a[20:23], v[88:91], v[240:255]
  ds_read_b128 v[84:87], v7 offset:0
  ds_read_b64_tr_b16 a[76:77], v5 offset:2304
  ds_read_b64_tr_b16 a[78:79], v5 offset:2816
  v_mul_f32 v181, v181, v181
  v_mul_f32 v182, v182, v182
  s_waitcnt lgkmcnt(10)
  v_mfma_f32_32x32x16_bf16 v[224:239], a[24:27], v[92:95], v[224:239]
  v_xor_b32 v7, 192, v6
  v_mul_f32 v183, v183, v183
  v_mul_f32 v184, v184, v184
  v_mul_f32 v185, v185, v185
  v_mul_f32 v186, v186, v186
  v_mfma_f32_32x32x16_bf16 v[240:255], a[28:31], v[92:95], v[240:255]
  ds_read_b128 v[88:91], v7 offset:0
  v_mul_f32 v187, v187, v187
  v_mul_f32 v188, v188, v188
  v_mul_f32 v189, v189, v189
  s_waitcnt lgkmcnt(8)
  v_mfma_f32_32x32x16_bf16 v[224:239], a[32:35], v[80:83], v[224:239]
  v_xor_b32 v7, 224, v6
  v_mul_f32 v190, v190, v190
  v_mul_f32 v191, v191, v191
  v_cvt_pk_bf16_f32 v176, v176, v177
  v_cvt_pk_bf16_f32 v177, v178, v179
  v_mfma_f32_32x32x16_bf16 v[240:255], a[36:39], v[80:83], v[240:255]
  ds_read_b128 v[92:95], v7 offset:0
  v_cvt_pk_bf16_f32 v178, v180, v181
  v_cvt_pk_bf16_f32 v179, v182, v183
  v_cvt_pk_bf16_f32 v180, v184, v185
  s_waitcnt lgkmcnt(4)
  v_mfma_f32_32x32x16_bf16 v[224:239], a[40:43], v[84:87], v[224:239]
  s_waitcnt vmcnt(8)
  ds_read_b64_tr_b16 a[80:81], v5 offset:16384
  ds_read_b64_tr_b16 a[82:83], v5 offset:16896
  v_cvt_pk_bf16_f32 v181, v186, v187
  v_cvt_pk_bf16_f32 v182, v188, v189
  v_mfma_f32_32x32x16_bf16 v[240:255], a[44:47], v[84:87], v[240:255]
  ds_read_b128 v[80:83], v6 offset:16384
  ds_read_b64_tr_b16 a[84:85], v5 offset:16640
  ds_read_b64_tr_b16 a[86:87], v5 offset:17152
  v_cvt_pk_bf16_f32 v183, v190, v191
  s_waitcnt lgkmcnt(6)
  v_mfma_f32_32x32x16_bf16 v[224:239], a[48:51], v[88:91], v[224:239]
  ds_read_b64_tr_b16 a[88:89], v5 offset:18432
  ds_read_b64_tr_b16 a[90:91], v5 offset:18944
  v_xor_b32 v7, 32, v6
  v_cvt_pk_bf16_f32 v32, v192, v193
  v_mfma_f32_32x32x16_bf16 v[240:255], a[52:55], v[88:91], v[240:255]
  ds_read_b128 v[84:87], v7 offset:16384
  ds_read_b64_tr_b16 a[92:93], v5 offset:18688
  ds_read_b64_tr_b16 a[94:95], v5 offset:19200
  v_cvt_pk_bf16_f32 v33, v194, v195
  s_waitcnt lgkmcnt(10)
  v_mfma_f32_32x32x16_bf16 v[224:239], a[56:59], v[92:95], v[224:239]
  v_xor_b32 v7, 64, v6
  v_cvt_pk_bf16_f32 v34, v196, v197
  v_cvt_pk_bf16_f32 v35, v198, v199
  v_mfma_f32_32x32x16_bf16 v[240:255], a[60:63], v[92:95], v[240:255]
  ds_read_b128 v[88:91], v7 offset:16384
  buffer_store_dwordx4 v[32:35], v14, s[40:43], s64 offen offset:0 sc1
  v_cvt_pk_bf16_f32 v36, v200, v201
  v_cvt_pk_bf16_f32 v37, v202, v203
  s_waitcnt lgkmcnt(8)
  v_mfma_f32_32x32x16_bf16 v[224:239], a[64:67], v[80:83], v[224:239]
  v_xor_b32 v7, 96, v6
  v_cvt_pk_bf16_f32 v38, v204, v205
  v_cvt_pk_bf16_f32 v39, v206, v207
  v_mfma_f32_32x32x16_bf16 v[240:255], a[68:71], v[80:83], v[240:255]
  ds_read_b128 v[92:95], v7 offset:16384
  buffer_store_dwordx4 v[36:39], v14, s[40:43], s64 offen offset:2048 sc1
  v_cvt_pk_bf16_f32 v40, v208, v209
  v_cvt_pk_bf16_f32 v41, v210, v211
  s_waitcnt lgkmcnt(4)
  v_mfma_f32_32x32x16_bf16 v[224:239], a[72:75], v[84:87], v[224:239]
  s_waitcnt vmcnt(6)
  ds_read_b64_tr_b16 a[96:97], v4 offset:0
  ds_read_b64_tr_b16 a[98:99], v4 offset:512
  ds_write_b128 v25, v[160:163] offset:8192
  ds_write_b128 v26, v[164:167] offset:8192
  ds_write_b128 v27, v[176:179] offset:8192
  ds_write_b128 v23, v[180:183] offset:8192
  v_xor_b32 v7, 128, v6
  v_mfma_f32_32x32x16_bf16 v[240:255], a[76:79], v[84:87], v[240:255]
  ds_read_b128 v[80:83], v7 offset:16384
  ds_read_b64_tr_b16 a[100:101], v4 offset:256
  ds_read_b64_tr_b16 a[102:103], v4 offset:768
  s_waitcnt lgkmcnt(10)
  v_mfma_f32_32x32x16_bf16 v[224:239], a[80:83], v[88:91], v[224:239]
  ds_read_b64_tr_b16 a[104:105], v4 offset:2048
  ds_read_b64_tr_b16 a[106:107], v4 offset:2560
  v_xor_b32 v7, 160, v6
  v_cvt_pk_bf16_f32 v42, v212, v213
  v_mfma_f32_32x32x16_bf16 v[240:255], a[84:87], v[88:91], v[240:255]
  ds_read_b128 v[84:87], v7 offset:16384
  ds_read_b64_tr_b16 a[108:109], v4 offset:2304
  ds_read_b64_tr_b16 a[110:111], v4 offset:2816
  v_cvt_pk_bf16_f32 v43, v214, v215
  s_waitcnt lgkmcnt(14)
  v_mfma_f32_32x32x16_bf16 v[224:239], a[88:91], v[92:95], v[224:239]
  s_waitcnt vmcnt(2)
  ds_read_b64_tr_b16 a[112:113], v4 offset:16384
  ds_read_b64_tr_b16 a[114:115], v4 offset:16896
  v_xor_b32 v7, 192, v6
  v_mfma_f32_32x32x16_bf16 v[240:255], a[92:95], v[92:95], v[240:255]
  ds_read_b128 v[88:91], v7 offset:16384
  ds_read_b64_tr_b16 a[116:117], v4 offset:16640
  ds_read_b64_tr_b16 a[118:119], v4 offset:17152
  buffer_store_dwordx4 v[40:43], v14, s[40:43], s47 offen offset:0 sc1
  s_waitcnt lgkmcnt(5)
  v_mfma_f32_32x32x16_bf16 v[224:239], a[96:99], v[80:83], v[224:239]
  ds_read_b64_tr_b16 a[120:121], v4 offset:18432
  ds_read_b64_tr_b16 a[122:123], v4 offset:18944
  v_xor_b32 v7, 224, v6
  v_cvt_pk_bf16_f32 v44, v216, v217
  v_mfma_f32_32x32x16_bf16 v[240:255], a[100:103], v[80:83], v[240:255]
  ds_read_b128 v[92:95], v7 offset:16384
  ds_read_b64_tr_b16 a[124:125], v4 offset:18688
  ds_read_b64_tr_b16 a[126:127], v4 offset:19200
  v_cvt_pk_bf16_f32 v45, v218, v219
  v_mfma_f32_32x32x16_bf16 v[224:239], a[104:107], v[84:87], v[224:239]
  v_cvt_pk_bf16_f32 v46, v220, v221
  v_cvt_pk_bf16_f32 v47, v222, v223
  v_mfma_f32_32x32x16_bf16 v[240:255], a[108:111], v[84:87], v[240:255]
  buffer_store_dwordx4 v[44:47], v14, s[40:43], s47 offen offset:2048 sc1
  s_waitcnt lgkmcnt(0)
  s_barrier
  ds_read_b128 v[80:83], v6 offset:8192
  s_add_u32 s64, s64, 8192
  s_add_u32 s47, s47, 8192
  v_mfma_f32_32x32x16_bf16 v[224:239], a[112:115], v[88:91], v[224:239]
  v_xor_b32 v7, 32, v6
  v_mfma_f32_32x32x16_bf16 v[240:255], a[116:119], v[88:91], v[240:255]
  ds_read_b128 v[84:87], v7 offset:8192
  v_mfma_f32_32x32x16_bf16 v[224:239], a[120:123], v[92:95], v[224:239]
  v_xor_b32 v7, 64, v6
  v_mfma_f32_32x32x16_bf16 v[240:255], a[124:127], v[92:95], v[240:255]
  ds_read_b128 v[88:91], v7 offset:8192
  s_waitcnt lgkmcnt(2)
  v_mfma_f32_32x32x16_bf16 v[128:143], a[128:131], v[80:83], 0
  v_xor_b32 v7, 96, v6
  v_mfma_f32_32x32x16_bf16 v[144:159], a[132:135], v[80:83], 0
  ds_read_b128 v[92:95], v7 offset:8192
  s_waitcnt lgkmcnt(2)
  v_mfma_f32_32x32x16_bf16 v[128:143], a[136:139], v[84:87], v[128:143]
  v_xor_b32 v7, 128, v6
  v_mfma_f32_32x32x16_bf16 v[144:159], a[140:143], v[84:87], v[144:159]
  ds_read_b128 v[80:83], v7 offset:8192
  s_waitcnt lgkmcnt(2)
  v_mfma_f32_32x32x16_bf16 v[128:143], a[144:147], v[88:91], v[128:143]
  v_xor_b32 v7, 160, v6
  v_cvt_pk_bf16_f32 v32, v224, v225
  v_mfma_f32_32x32x16_bf16 v[144:159], a[148:151], v[88:91], v[144:159]
  ds_read_b128 v[84:87], v7 offset:8192
  v_cvt_pk_bf16_f32 v33, v226, v227
  s_waitcnt lgkmcnt(2)
  v_mfma_f32_32x32x16_bf16 v[128:143], a[152:155], v[92:95], v[128:143]
  v_xor_b32 v7, 192, v6
  v_cvt_pk_bf16_f32 v34, v228, v229
  v_cvt_pk_bf16_f32 v35, v230, v231
  v_mfma_f32_32x32x16_bf16 v[144:159], a[156:159], v[92:95], v[144:159]
  ds_read_b128 v[88:91], v7 offset:8192
  buffer_store_dwordx4 v[32:35], v14, s[40:43], s64 offen offset:0 sc1
  s_waitcnt lgkmcnt(2)
  v_mfma_f32_32x32x16_bf16 v[128:143], a[160:163], v[80:83], v[128:143]
  v_xor_b32 v7, 224, v6
  v_cvt_pk_bf16_f32 v36, v232, v233
  v_mfma_f32_32x32x16_bf16 v[144:159], a[164:167], v[80:83], v[144:159]
  ds_read_b128 v[92:95], v7 offset:8192
  v_cvt_pk_bf16_f32 v37, v234, v235
  v_cvt_pk_bf16_f32 v38, v236, v237
  s_waitcnt lgkmcnt(2)
  v_mfma_f32_32x32x16_bf16 v[128:143], a[168:171], v[84:87], v[128:143]
  v_cvt_pk_bf16_f32 v39, v238, v239
  v_mfma_f32_32x32x16_bf16 v[144:159], a[172:175], v[84:87], v[144:159]
  buffer_store_dwordx4 v[36:39], v14, s[40:43], s64 offen offset:2048 sc1
  ds_read_b128 v[80:83], v6 offset:24576
  v_cvt_pk_bf16_f32 v40, v240, v241
  s_waitcnt lgkmcnt(2)
  v_mfma_f32_32x32x16_bf16 v[128:143], a[176:179], v[88:91], v[128:143]
  v_xor_b32 v7, 32, v6
  v_cvt_pk_bf16_f32 v41, v242, v243
  v_mfma_f32_32x32x16_bf16 v[144:159], a[180:183], v[88:91], v[144:159]
  ds_read_b128 v[84:87], v7 offset:24576
  v_cvt_pk_bf16_f32 v42, v244, v245
  s_waitcnt lgkmcnt(2)
  v_mfma_f32_32x32x16_bf16 v[128:143], a[184:187], v[92:95], v[128:143]
  v_xor_b32 v7, 64, v6
  v_cvt_pk_bf16_f32 v43, v246, v247
  v_mfma_f32_32x32x16_bf16 v[144:159], a[188:191], v[92:95], v[144:159]
  buffer_store_dwordx4 v[40:43], v14, s[40:43], s47 offen offset:0 sc1
  ds_read_b128 v[88:91], v7 offset:24576
  v_cvt_pk_bf16_f32 v44, v248, v249
  s_waitcnt lgkmcnt(2)
  v_mfma_f32_32x32x16_bf16 v[128:143], a[192:195], v[80:83], v[128:143]
  v_xor_b32 v7, 96, v6
  v_cvt_pk_bf16_f32 v45, v250, v251
  v_mfma_f32_32x32x16_bf16 v[144:159], a[196:199], v[80:83], v[144:159]
  ds_read_b128 v[92:95], v7 offset:24576
  v_cvt_pk_bf16_f32 v46, v252, v253
  v_cvt_pk_bf16_f32 v47, v254, v255
  s_waitcnt lgkmcnt(2)
  v_mfma_f32_32x32x16_bf16 v[128:143], a[200:203], v[84:87], v[128:143]
  buffer_store_dwordx4 v[44:47], v14, s[40:43], s47 offen offset:2048 sc1
  v_xor_b32 v7, 128, v6
  v_mfma_f32_32x32x16_bf16 v[144:159], a[204:207], v[84:87], v[144:159]
  ds_read_b128 v[80:83], v7 offset:24576
  s_add_u32 s64, s64, 4294959104
  s_add_u32 s47, s47, 4294959104
  s_waitcnt lgkmcnt(2)
  v_mfma_f32_32x32x16_bf16 v[128:143], a[208:211], v[88:91], v[128:143]
  v_xor_b32 v7, 160, v6
  v_mfma_f32_32x32x16_bf16 v[144:159], a[212:215], v[88:91], v[144:159]
  ds_read_b128 v[84:87], v7 offset:24576
  s_waitcnt lgkmcnt(2)
  v_mfma_f32_32x32x16_bf16 v[128:143], a[216:219], v[92:95], v[128:143]
  v_xor_b32 v7, 192, v6
  v_mfma_f32_32x32x16_bf16 v[144:159], a[220:223], v[92:95], v[144:159]
  ds_read_b128 v[88:91], v7 offset:24576
  s_waitcnt lgkmcnt(2)
  v_mfma_f32_32x32x16_bf16 v[128:143], a[224:227], v[80:83], v[128:143]
  v_xor_b32 v7, 224, v6
  v_mfma_f32_32x32x16_bf16 v[144:159], a[228:231], v[80:83], v[144:159]
  ds_read_b128 v[92:95], v7 offset:24576
  s_waitcnt lgkmcnt(2)
  v_mfma_f32_32x32x16_bf16 v[128:143], a[232:235], v[84:87], v[128:143]
  v_mfma_f32_32x32x16_bf16 v[144:159], a[236:239], v[84:87], v[144:159]
  ds_read_b128 v[80:83], v6 offset:8192
  s_waitcnt lgkmcnt(2)
  v_mfma_f32_32x32x16_bf16 v[128:143], a[240:243], v[88:91], v[128:143]
  v_xor_b32 v7, 32, v6
  v_mfma_f32_32x32x16_bf16 v[144:159], a[244:247], v[88:91], v[144:159]
  ds_read_b128 v[84:87], v7 offset:8192
  s_waitcnt lgkmcnt(2)
  v_mfma_f32_32x32x16_bf16 v[128:143], a[248:251], v[92:95], v[128:143]
  v_xor_b32 v7, 64, v6
  v_mfma_f32_32x32x16_bf16 v[144:159], a[252:255], v[92:95], v[144:159]
  ds_read_b128 v[88:91], v7 offset:8192
  s_waitcnt lgkmcnt(2)
  v_mfma_f32_32x32x16_bf16 v[160:175], a[0:3], v[80:83], 0
  v_xor_b32 v7, 96, v6
  v_mfma_f32_32x32x16_bf16 v[176:191], a[4:7], v[80:83], 0
  ds_read_b128 v[92:95], v7 offset:8192
  s_waitcnt vmcnt(0)
  s_barrier
  s_add_u32 s50, s59, 16384
  s_mov_b64 exec, s[68:69]
  buffer_store_dword v29, v28, s[36:39], s50 offen sc1
  s_mov_b64 exec, -1
  s_waitcnt lgkmcnt(2)
  v_mfma_f32_32x32x16_bf16 v[160:175], a[8:11], v[84:87], v[160:175]
  v_xor_b32 v7, 128, v6
  v_mfma_f32_32x32x16_bf16 v[176:191], a[12:15], v[84:87], v[176:191]
  ds_read_b128 v[80:83], v7 offset:8192
  s_waitcnt lgkmcnt(2)
  v_mfma_f32_32x32x16_bf16 v[160:175], a[16:19], v[88:91], v[160:175]
  v_xor_b32 v7, 160, v6
  v_cvt_pk_bf16_f32 v32, v128, v129
  v_mfma_f32_32x32x16_bf16 v[176:191], a[20:23], v[88:91], v[176:191]
  ds_read_b128 v[84:87], v7 offset:8192
  v_cvt_pk_bf16_f32 v33, v130, v131
  s_waitcnt lgkmcnt(2)
  v_mfma_f32_32x32x16_bf16 v[160:175], a[24:27], v[92:95], v[160:175]
  v_xor_b32 v7, 192, v6
  v_cvt_pk_bf16_f32 v34, v132, v133
  v_cvt_pk_bf16_f32 v35, v134, v135
  v_mfma_f32_32x32x16_bf16 v[176:191], a[28:31], v[92:95], v[176:191]
  ds_read_b128 v[88:91], v7 offset:8192
  buffer_store_dwordx4 v[32:35], v14, s[40:43], s64 offen offset:1024 sc1
  s_waitcnt lgkmcnt(2)
  v_mfma_f32_32x32x16_bf16 v[160:175], a[32:35], v[80:83], v[160:175]
  v_xor_b32 v7, 224, v6
  v_cvt_pk_bf16_f32 v36, v136, v137
  v_mfma_f32_32x32x16_bf16 v[176:191], a[36:39], v[80:83], v[176:191]
  ds_read_b128 v[92:95], v7 offset:8192
  v_cvt_pk_bf16_f32 v37, v138, v139
  v_cvt_pk_bf16_f32 v38, v140, v141
  s_waitcnt lgkmcnt(2)
  v_mfma_f32_32x32x16_bf16 v[160:175], a[40:43], v[84:87], v[160:175]
  v_cvt_pk_bf16_f32 v39, v142, v143
  v_mfma_f32_32x32x16_bf16 v[176:191], a[44:47], v[84:87], v[176:191]
  buffer_store_dwordx4 v[36:39], v14, s[40:43], s64 offen offset:3072 sc1
  ds_read_b128 v[80:83], v6 offset:24576
  v_cvt_pk_bf16_f32 v40, v144, v145
  s_waitcnt lgkmcnt(2)
  v_mfma_f32_32x32x16_bf16 v[160:175], a[48:51], v[88:91], v[160:175]
  v_xor_b32 v7, 32, v6
  v_cvt_pk_bf16_f32 v41, v146, v147
  v_mfma_f32_32x32x16_bf16 v[176:191], a[52:55], v[88:91], v[176:191]
  ds_read_b128 v[84:87], v7 offset:24576
  v_cvt_pk_bf16_f32 v42, v148, v149
  s_waitcnt lgkmcnt(2)
  v_mfma_f32_32x32x16_bf16 v[160:175], a[56:59], v[92:95], v[160:175]
  v_xor_b32 v7, 64, v6
  v_cvt_pk_bf16_f32 v43, v150, v151
  v_mfma_f32_32x32x16_bf16 v[176:191], a[60:63], v[92:95], v[176:191]
  buffer_store_dwordx4 v[40:43], v14, s[40:43], s47 offen offset:1024 sc1
  ds_read_b128 v[88:91], v7 offset:24576
  v_cvt_pk_bf16_f32 v44, v152, v153
  s_waitcnt lgkmcnt(2)
  v_mfma_f32_32x32x16_bf16 v[160:175], a[64:67], v[80:83], v[160:175]
  v_xor_b32 v7, 96, v6
  v_cvt_pk_bf16_f32 v45, v154, v155
  v_mfma_f32_32x32x16_bf16 v[176:191], a[68:71], v[80:83], v[176:191]
  ds_read_b128 v[92:95], v7 offset:24576
  v_cvt_pk_bf16_f32 v46, v156, v157
  v_cvt_pk_bf16_f32 v47, v158, v159
  s_waitcnt lgkmcnt(2)
  v_mfma_f32_32x32x16_bf16 v[160:175], a[72:75], v[84:87], v[160:175]
  buffer_store_dwordx4 v[44:47], v14, s[40:43], s47 offen offset:3072 sc1
  v_xor_b32 v7, 128, v6
  v_mfma_f32_32x32x16_bf16 v[176:191], a[76:79], v[84:87], v[176:191]
  ds_read_b128 v[80:83], v7 offset:24576
  s_add_u32 s64, s64, 8192
  s_add_u32 s47, s47, 8192
  s_waitcnt lgkmcnt(2)
  v_mfma_f32_32x32x16_bf16 v[160:175], a[80:83], v[88:91], v[160:175]
  v_xor_b32 v7, 160, v6
  v_mfma_f32_32x32x16_bf16 v[176:191], a[84:87], v[88:91], v[176:191]
  ds_read_b128 v[84:87], v7 offset:24576
  s_waitcnt lgkmcnt(2)
  v_mfma_f32_32x32x16_bf16 v[160:175], a[88:91], v[92:95], v[160:175]
  v_xor_b32 v7, 192, v6
  v_mfma_f32_32x32x16_bf16 v[176:191], a[92:95], v[92:95], v[176:191]
  ds_read_b128 v[88:91], v7 offset:24576
  s_waitcnt lgkmcnt(2)
  v_mfma_f32_32x32x16_bf16 v[160:175], a[96:99], v[80:83], v[160:175]
  v_xor_b32 v7, 224, v6
  v_mfma_f32_32x32x16_bf16 v[176:191], a[100:103], v[80:83], v[176:191]
  ds_read_b128 v[92:95], v7 offset:24576
  s_waitcnt lgkmcnt(2)
  v_mfma_f32_32x32x16_bf16 v[160:175], a[104:107], v[84:87], v[160:175]
  v_mfma_f32_32x32x16_bf16 v[176:191], a[108:111], v[84:87], v[176:191]
  s_add_u32 s50, s63, 16384
  s_mov_b64 exec, 0xff
  buffer_load_dword v30, v24, s[36:39], s50 offen sc1
  s_mov_b64 exec, -1
  s_waitcnt lgkmcnt(1)
  v_mfma_f32_32x32x16_bf16 v[160:175], a[112:115], v[88:91], v[160:175]
  v_mfma_f32_32x32x16_bf16 v[176:191], a[116:119], v[88:91], v[176:191]
  s_waitcnt lgkmcnt(0)
  v_mfma_f32_32x32x16_bf16 v[160:175], a[120:123], v[92:95], v[160:175]
  v_mfma_f32_32x32x16_bf16 v[176:191], a[124:127], v[92:95], v[176:191]
  s_nop 3
  v_cvt_pk_bf16_f32 v32, v160, v161
  v_cvt_pk_bf16_f32 v33, v162, v163
  v_cvt_pk_bf16_f32 v34, v164, v165
  v_cvt_pk_bf16_f32 v35, v166, v167
  buffer_store_dwordx4 v[32:35], v14, s[40:43], s64 offen offset:1024 sc1
  v_cvt_pk_bf16_f32 v36, v168, v169
  v_cvt_pk_bf16_f32 v37, v170, v171
  v_cvt_pk_bf16_f32 v38, v172, v173
  v_cvt_pk_bf16_f32 v39, v174, v175
  buffer_store_dwordx4 v[36:39], v14, s[40:43], s64 offen offset:3072 sc1
  v_cvt_pk_bf16_f32 v40, v176, v177
  v_cvt_pk_bf16_f32 v41, v178, v179
  v_cvt_pk_bf16_f32 v42, v180, v181
  v_cvt_pk_bf16_f32 v43, v182, v183
  buffer_store_dwordx4 v[40:43], v14, s[40:43], s47 offen offset:1024 sc1
  v_cvt_pk_bf16_f32 v44, v184, v185
  v_cvt_pk_bf16_f32 v45, v186, v187
  v_cvt_pk_bf16_f32 v46, v188, v189
  v_cvt_pk_bf16_f32 v47, v190, v191
  buffer_store_dwordx4 v[44:47], v14, s[40:43], s47 offen offset:3072 sc1
k2_ffd:
  v_lshlrev_b32 v64, 16, v124
  v_and_b32 v65, 0xffff0000, v124
  v_lshlrev_b32 v66, 16, v125
  v_and_b32 v67, 0xffff0000, v125
  v_lshlrev_b32 v68, 16, v126
  v_and_b32 v69, 0xffff0000, v126
  v_lshlrev_b32 v70, 16, v127
  v_and_b32 v71, 0xffff0000, v127
  v_lshlrev_b32 v72, 16, v104
  v_and_b32 v73, 0xffff0000, v104
  v_lshlrev_b32 v74, 16, v105
  v_and_b32 v75, 0xffff0000, v105
  v_lshlrev_b32 v76, 16, v106
  v_and_b32 v77, 0xffff0000, v106
  v_lshlrev_b32 v78, 16, v107
  v_and_b32 v79, 0xffff0000, v107
  s_mov_b64 exec, 0xff
  s_waitcnt vmcnt(4)
  v_cmp_ne_u32 vcc, 1, v30
  s_mov_b64 exec, -1
  s_cmp_eq_u64 vcc, 0
  s_cbranch_scc1 k2_rk4
  s_add_u32 s56, s63, 16384
  s_mov_b32 s50, 0
  s_mov_b64 exec, 0xff
k2_ap4:
  buffer_load_dword v3, v24, s[36:39], s56 offen sc1
  s_add_u32 s50, s50, 1
  s_waitcnt vmcnt(0)
  v_cmp_ne_u32 vcc, 1, v3
  s_cmp_gt_u32 s50, 0x80000
  s_cbranch_scc1 k2_ad4
  s_nop 2
  s_cbranch_vccnz k2_ap4
k2_ad4:
  s_mov_b64 exec, -1
k2_rk4:
  s_mov_b32 s50, 0x1000000
  buffer_load_dwordx4 v[192:195], v15, s[40:43], s50 offen offset:0 sc1
  s_mov_b32 s50, 0x1200000
  buffer_load_dwordx4 v[196:199], v15, s[40:43], s50 offen offset:0 sc1
  s_mov_b32 s50, 0x1400000
  buffer_load_dwordx4 v[200:203], v15, s[40:43], s50 offen offset:0 sc1
  s_mov_b32 s50, 0x1600000
  buffer_load_dwordx4 v[204:207], v15, s[40:43], s50 offen offset:0 sc1
  s_mov_b32 s50, 0x1800000
  buffer_load_dwordx4 v[208:211], v15, s[40:43], s50 offen offset:0 sc1
  s_mov_b32 s50, 0x1a00000
  buffer_load_dwordx4 v[212:215], v15, s[40:43], s50 offen offset:0 sc1
  s_mov_b32 s50, 0x1c00000
  buffer_load_dwordx4 v[216:219], v15, s[40:43], s50 offen offset:0 sc1
  s_waitcnt vmcnt(7)
  s_barrier
  s_add_u32 s50, s59, 20480
  s_mov_b64 exec, s[68:69]
  buffer_store_dword v29, v28, s[36:39], s50 offen sc1
  s_mov_b64 exec, -1
  v_lshlrev_b32 v80, 16, v96
  v_and_b32 v81, 0xffff0000, v96
  v_lshlrev_b32 v82, 16, v97
  v_and_b32 v83, 0xffff0000, v97
  v_lshlrev_b32 v84, 16, v98
  v_and_b32 v85, 0xffff0000, v98
  v_lshlrev_b32 v86, 16, v99
  v_and_b32 v87, 0xffff0000, v99
  s_waitcnt vmcnt(7)
  v_lshlrev_b32 v32, 16, v192
  v_and_b32 v33, 0xffff0000, v192
  v_lshlrev_b32 v34, 16, v193
  v_and_b32 v35, 0xffff0000, v193
  v_lshlrev_b32 v36, 16, v194
  v_and_b32 v37, 0xffff0000, v194
  v_lshlrev_b32 v38, 16, v195
  v_and_b32 v39, 0xffff0000, v195
  s_waitcnt vmcnt(6)
  v_lshlrev_b32 v48, 16, v196
  v_and_b32 v49, 0xffff0000, v196
  v_pk_add_f32 v[32:33], v[32:33], v[48:49]
  v_lshlrev_b32 v50, 16, v197
  v_and_b32 v51, 0xffff0000, v197
  v_pk_add_f32 v[34:35], v[34:35], v[50:51]
  v_lshlrev_b32 v52, 16, v198
  v_and_b32 v53, 0xffff0000, v198
  v_pk_add_f32 v[36:37], v[36:37], v[52:53]
  v_lshlrev_b32 v54, 16, v199
  v_and_b32 v55, 0xffff0000, v199
  v_pk_add_f32 v[38:39], v[38:39], v[54:55]
  s_waitcnt vmcnt(5)
  v_lshlrev_b32 v48, 16, v200
  v_and_b32 v49, 0xffff0000, v200
  v_pk_add_f32 v[32:33], v[32:33], v[48:49]
  v_lshlrev_b32 v50, 16, v201
  v_and_b32 v51, 0xffff0000, v201
  v_pk_add_f32 v[34:35], v[34:35], v[50:51]
  v_lshlrev_b32 v52, 16, v202
  v_and_b32 v53, 0xffff0000, v202
  v_pk_add_f32 v[36:37], v[36:37], v[52:53]
  v_lshlrev_b32 v54, 16, v203
  v_and_b32 v55, 0xffff0000, v203
  v_pk_add_f32 v[38:39], v[38:39], v[54:55]
  s_waitcnt vmcnt(4)
  v_lshlrev_b32 v48, 16, v204
  v_and_b32 v49, 0xffff0000, v204
  v_pk_add_f32 v[32:33], v[32:33], v[48:49]
  v_lshlrev_b32 v50, 16, v205
  v_and_b32 v51, 0xffff0000, v205
  v_pk_add_f32 v[34:35], v[34:35], v[50:51]
  v_lshlrev_b32 v52, 16, v206
  v_and_b32 v53, 0xffff0000, v206
  v_pk_add_f32 v[36:37], v[36:37], v[52:53]
  v_lshlrev_b32 v54, 16, v207
  v_and_b32 v55, 0xffff0000, v207
  v_pk_add_f32 v[38:39], v[38:39], v[54:55]
  s_waitcnt vmcnt(3)
  v_lshlrev_b32 v48, 16, v208
  v_and_b32 v49, 0xffff0000, v208
  v_pk_add_f32 v[32:33], v[32:33], v[48:49]
  v_lshlrev_b32 v50, 16, v209
  v_and_b32 v51, 0xffff0000, v209
  v_pk_add_f32 v[34:35], v[34:35], v[50:51]
  v_lshlrev_b32 v52, 16, v210
  v_and_b32 v53, 0xffff0000, v210
  v_pk_add_f32 v[36:37], v[36:37], v[52:53]
  v_lshlrev_b32 v54, 16, v211
  v_and_b32 v55, 0xffff0000, v211
  v_pk_add_f32 v[38:39], v[38:39], v[54:55]
  s_waitcnt vmcnt(2)
  v_lshlrev_b32 v48, 16, v212
  v_and_b32 v49, 0xffff0000, v212
  v_pk_add_f32 v[32:33], v[32:33], v[48:49]
  v_lshlrev_b32 v50, 16, v213
  v_and_b32 v51, 0xffff0000, v213
  v_pk_add_f32 v[34:35], v[34:35], v[50:51]
  v_lshlrev_b32 v52, 16, v214
  v_and_b32 v53, 0xffff0000, v214
  v_pk_add_f32 v[36:37], v[36:37], v[52:53]
  v_lshlrev_b32 v54, 16, v215
  v_and_b32 v55, 0xffff0000, v215
  v_pk_add_f32 v[38:39], v[38:39], v[54:55]
  s_waitcnt vmcnt(1)
  v_lshlrev_b32 v48, 16, v216
  v_and_b32 v49, 0xffff0000, v216
  v_pk_add_f32 v[32:33], v[32:33], v[48:49]
  v_lshlrev_b32 v50, 16, v217
  v_and_b32 v51, 0xffff0000, v217
  v_pk_add_f32 v[34:35], v[34:35], v[50:51]
  v_lshlrev_b32 v52, 16, v218
  v_and_b32 v53, 0xffff0000, v218
  v_pk_add_f32 v[36:37], v[36:37], v[52:53]
  v_lshlrev_b32 v54, 16, v219
  v_and_b32 v55, 0xffff0000, v219
  v_pk_add_f32 v[38:39], v[38:39], v[54:55]
  v_cvt_pk_bf16_f32 v48, v32, v33
  v_cvt_pk_bf16_f32 v49, v34, v35
  v_cvt_pk_bf16_f32 v50, v36, v37
  v_cvt_pk_bf16_f32 v51, v38, v39
  v_lshlrev_b32 v32, 16, v48
  v_and_b32 v33, 0xffff0000, v48
  v_lshlrev_b32 v34, 16, v49
  v_and_b32 v35, 0xffff0000, v49
  v_lshlrev_b32 v36, 16, v50
  v_and_b32 v37, 0xffff0000, v50
  v_lshlrev_b32 v38, 16, v51
  v_and_b32 v39, 0xffff0000, v51
  v_pk_add_f32 v[32:33], v[32:33], v[72:73]
  v_pk_add_f32 v[34:35], v[34:35], v[74:75]
  v_pk_add_f32 v[36:37], v[36:37], v[76:77]
  v_pk_add_f32 v[38:39], v[38:39], v[78:79]
  v_cvt_pk_bf16_f32 v48, v32, v33
  v_cvt_pk_bf16_f32 v49, v34, v35
  v_cvt_pk_bf16_f32 v50, v36, v37
  v_cvt_pk_bf16_f32 v51, v38, v39
  v_lshlrev_b32 v32, 16, v48
  v_and_b32 v33, 0xffff0000, v48
  v_lshlrev_b32 v34, 16, v49
  v_and_b32 v35, 0xffff0000, v49
  v_lshlrev_b32 v36, 16, v50
  v_and_b32 v37, 0xffff0000, v50
  v_lshlrev_b32 v38, 16, v51
  v_and_b32 v39, 0xffff0000, v51
  v_pk_mul_f32 v[32:33], v[32:33], v[64:65]
  v_pk_mul_f32 v[34:35], v[34:35], v[66:67]
  v_pk_mul_f32 v[36:37], v[36:37], v[68:69]
  v_pk_mul_f32 v[38:39], v[38:39], v[70:71]
  v_cvt_pk_bf16_f32 v48, v32, v33
  v_cvt_pk_bf16_f32 v49, v34, v35
  v_cvt_pk_bf16_f32 v50, v36, v37
  v_cvt_pk_bf16_f32 v51, v38, v39
  v_lshlrev_b32 v32, 16, v48
  v_and_b32 v33, 0xffff0000, v48
  v_lshlrev_b32 v34, 16, v49
  v_and_b32 v35, 0xffff0000, v49
  v_lshlrev_b32 v36, 16, v50
  v_and_b32 v37, 0xffff0000, v50
  v_lshlrev_b32 v38, 16, v51
  v_and_b32 v39, 0xffff0000, v51
  v_pk_add_f32 v[32:33], v[32:33], v[80:81]
  v_pk_add_f32 v[34:35], v[34:35], v[82:83]
  v_pk_add_f32 v[36:37], v[36:37], v[84:85]
  v_pk_add_f32 v[38:39], v[38:39], v[86:87]
  v_cvt_pk_bf16_f32 v56, v32, v33
  v_cvt_pk_bf16_f32 v57, v34, v35
  v_cvt_pk_bf16_f32 v58, v36, v37
  v_cvt_pk_bf16_f32 v59, v38, v39
  s_mov_b32 s50, 0
  buffer_store_dwordx4 v[56:59], v16, s[88:91], s50 offen
  s_add_u32 s56, s63, 20480
  s_mov_b32 s50, 0
  s_mov_b64 exec, 0xff
k2_ap5:
  buffer_load_dword v3, v24, s[36:39], s56 offen sc1
  s_add_u32 s50, s50, 1
  s_waitcnt vmcnt(0)
  v_cmp_ne_u32 vcc, 1, v3
  s_cmp_gt_u32 s50, 0x80000
  s_cbranch_scc1 k2_ad5
  s_nop 2
  s_cbranch_vccnz k2_ap5
k2_ad5:
  s_mov_b64 exec, -1
  s_mov_b32 s50, 0x1000000
  buffer_load_dwordx4 v[192:195], v15, s[40:43], s50 offen offset:1024 sc1
  s_mov_b32 s50, 0x1200000
  buffer_load_dwordx4 v[196:199], v15, s[40:43], s50 offen offset:1024 sc1
  s_mov_b32 s50, 0x1400000
  buffer_load_dwordx4 v[200:203], v15, s[40:43], s50 offen offset:1024 sc1
  s_mov_b32 s50, 0x1600000
  buffer_load_dwordx4 v[204:207], v15, s[40:43], s50 offen offset:1024 sc1
  s_mov_b32 s50, 0x1800000
  buffer_load_dwordx4 v[208:211], v15, s[40:43], s50 offen offset:1024 sc1
  s_mov_b32 s50, 0x1a00000
  buffer_load_dwordx4 v[212:215], v15, s[40:43], s50 offen offset:1024 sc1
  s_mov_b32 s50, 0x1c00000
  buffer_load_dwordx4 v[216:219], v15, s[40:43], s50 offen offset:1024 sc1
  v_lshlrev_b32 v80, 16, v100
  v_and_b32 v81, 0xffff0000, v100
  v_lshlrev_b32 v82, 16, v101
  v_and_b32 v83, 0xffff0000, v101
  v_lshlrev_b32 v84, 16, v102
  v_and_b32 v85, 0xffff0000, v102
  v_lshlrev_b32 v86, 16, v103
  v_and_b32 v87, 0xffff0000, v103
  s_waitcnt vmcnt(6)
  v_lshlrev_b32 v32, 16, v192
  v_and_b32 v33, 0xffff0000, v192
  v_lshlrev_b32 v34, 16, v193
  v_and_b32 v35, 0xffff0000, v193
  v_lshlrev_b32 v36, 16, v194
  v_and_b32 v37, 0xffff0000, v194
  v_lshlrev_b32 v38, 16, v195
  v_and_b32 v39, 0xffff0000, v195
  s_waitcnt vmcnt(5)
  v_lshlrev_b32 v48, 16, v196
  v_and_b32 v49, 0xffff0000, v196
  v_pk_add_f32 v[32:33], v[32:33], v[48:49]
  v_lshlrev_b32 v50, 16, v197
  v_and_b32 v51, 0xffff0000, v197
  v_pk_add_f32 v[34:35], v[34:35], v[50:51]
  v_lshlrev_b32 v52, 16, v198
  v_and_b32 v53, 0xffff0000, v198
  v_pk_add_f32 v[36:37], v[36:37], v[52:53]
  v_lshlrev_b32 v54, 16, v199
  v_and_b32 v55, 0xffff0000, v199
  v_pk_add_f32 v[38:39], v[38:39], v[54:55]
  s_waitcnt vmcnt(4)
  v_lshlrev_b32 v48, 16, v200
  v_and_b32 v49, 0xffff0000, v200
  v_pk_add_f32 v[32:33], v[32:33], v[48:49]
  v_lshlrev_b32 v50, 16, v201
  v_and_b32 v51, 0xffff0000, v201
  v_pk_add_f32 v[34:35], v[34:35], v[50:51]
  v_lshlrev_b32 v52, 16, v202
  v_and_b32 v53, 0xffff0000, v202
  v_pk_add_f32 v[36:37], v[36:37], v[52:53]
  v_lshlrev_b32 v54, 16, v203
  v_and_b32 v55, 0xffff0000, v203
  v_pk_add_f32 v[38:39], v[38:39], v[54:55]
  s_waitcnt vmcnt(3)
  v_lshlrev_b32 v48, 16, v204
  v_and_b32 v49, 0xffff0000, v204
  v_pk_add_f32 v[32:33], v[32:33], v[48:49]
  v_lshlrev_b32 v50, 16, v205
  v_and_b32 v51, 0xffff0000, v205
  v_pk_add_f32 v[34:35], v[34:35], v[50:51]
  v_lshlrev_b32 v52, 16, v206
  v_and_b32 v53, 0xffff0000, v206
  v_pk_add_f32 v[36:37], v[36:37], v[52:53]
  v_lshlrev_b32 v54, 16, v207
  v_and_b32 v55, 0xffff0000, v207
  v_pk_add_f32 v[38:39], v[38:39], v[54:55]
  s_waitcnt vmcnt(2)
  v_lshlrev_b32 v48, 16, v208
  v_and_b32 v49, 0xffff0000, v208
  v_pk_add_f32 v[32:33], v[32:33], v[48:49]
  v_lshlrev_b32 v50, 16, v209
  v_and_b32 v51, 0xffff0000, v209
  v_pk_add_f32 v[34:35], v[34:35], v[50:51]
  v_lshlrev_b32 v52, 16, v210
  v_and_b32 v53, 0xffff0000, v210
  v_pk_add_f32 v[36:37], v[36:37], v[52:53]
  v_lshlrev_b32 v54, 16, v211
  v_and_b32 v55, 0xffff0000, v211
  v_pk_add_f32 v[38:39], v[38:39], v[54:55]
  s_waitcnt vmcnt(1)
  v_lshlrev_b32 v48, 16, v212
  v_and_b32 v49, 0xffff0000, v212
  v_pk_add_f32 v[32:33], v[32:33], v[48:49]
  v_lshlrev_b32 v50, 16, v213
  v_and_b32 v51, 0xffff0000, v213
  v_pk_add_f32 v[34:35], v[34:35], v[50:51]
  v_lshlrev_b32 v52, 16, v214
  v_and_b32 v53, 0xffff0000, v214
  v_pk_add_f32 v[36:37], v[36:37], v[52:53]
  v_lshlrev_b32 v54, 16, v215
  v_and_b32 v55, 0xffff0000, v215
  v_pk_add_f32 v[38:39], v[38:39], v[54:55]
  s_waitcnt vmcnt(0)
  v_lshlrev_b32 v48, 16, v216
  v_and_b32 v49, 0xffff0000, v216
  v_pk_add_f32 v[32:33], v[32:33], v[48:49]
  v_lshlrev_b32 v50, 16, v217
  v_and_b32 v51, 0xffff0000, v217
  v_pk_add_f32 v[34:35], v[34:35], v[50:51]
  v_lshlrev_b32 v52, 16, v218
  v_and_b32 v53, 0xffff0000, v218
  v_pk_add_f32 v[36:37], v[36:37], v[52:53]
  v_lshlrev_b32 v54, 16, v219
  v_and_b32 v55, 0xffff0000, v219
  v_pk_add_f32 v[38:39], v[38:39], v[54:55]
  v_cvt_pk_bf16_f32 v48, v32, v33
  v_cvt_pk_bf16_f32 v49, v34, v35
  v_cvt_pk_bf16_f32 v50, v36, v37
  v_cvt_pk_bf16_f32 v51, v38, v39
  v_lshlrev_b32 v32, 16, v48
  v_and_b32 v33, 0xffff0000, v48
  v_lshlrev_b32 v34, 16, v49
  v_and_b32 v35, 0xffff0000, v49
  v_lshlrev_b32 v36, 16, v50
  v_and_b32 v37, 0xffff0000, v50
  v_lshlrev_b32 v38, 16, v51
  v_and_b32 v39, 0xffff0000, v51
  v_pk_add_f32 v[32:33], v[32:33], v[72:73]
  v_pk_add_f32 v[34:35], v[34:35], v[74:75]
  v_pk_add_f32 v[36:37], v[36:37], v[76:77]
  v_pk_add_f32 v[38:39], v[38:39], v[78:79]
  v_cvt_pk_bf16_f32 v48, v32, v33
  v_cvt_pk_bf16_f32 v49, v34, v35
  v_cvt_pk_bf16_f32 v50, v36, v37
  v_cvt_pk_bf16_f32 v51, v38, v39
  v_lshlrev_b32 v32, 16, v48
  v_and_b32 v33, 0xffff0000, v48
  v_lshlrev_b32 v34, 16, v49
  v_and_b32 v35, 0xffff0000, v49
  v_lshlrev_b32 v36, 16, v50
  v_and_b32 v37, 0xffff0000, v50
  v_lshlrev_b32 v38, 16, v51
  v_and_b32 v39, 0xffff0000, v51
  v_pk_mul_f32 v[32:33], v[32:33], v[64:65]
  v_pk_mul_f32 v[34:35], v[34:35], v[66:67]
  v_pk_mul_f32 v[36:37], v[36:37], v[68:69]
  v_pk_mul_f32 v[38:39], v[38:39], v[70:71]
  v_cvt_pk_bf16_f32 v48, v32, v33
  v_cvt_pk_bf16_f32 v49, v34, v35
  v_cvt_pk_bf16_f32 v50, v36, v37
  v_cvt_pk_bf16_f32 v51, v38, v39
  v_lshlrev_b32 v32, 16, v48
  v_and_b32 v33, 0xffff0000, v48
  v_lshlrev_b32 v34, 16, v49
  v_and_b32 v35, 0xffff0000, v49
  v_lshlrev_b32 v36, 16, v50
  v_and_b32 v37, 0xffff0000, v50
  v_lshlrev_b32 v38, 16, v51
  v_and_b32 v39, 0xffff0000, v51
  v_pk_add_f32 v[32:33], v[32:33], v[80:81]
  v_pk_add_f32 v[34:35], v[34:35], v[82:83]
  v_pk_add_f32 v[36:37], v[36:37], v[84:85]
  v_pk_add_f32 v[38:39], v[38:39], v[86:87]
  v_cvt_pk_bf16_f32 v56, v32, v33
  v_cvt_pk_bf16_f32 v57, v34, v35
  v_cvt_pk_bf16_f32 v58, v36, v37
  v_cvt_pk_bf16_f32 v59, v38, v39
  s_mov_b32 s50, 32768
  buffer_store_dwordx4 v[56:59], v16, s[88:91], s50 offen
k2_end:
  s_endpgm
k2_fb:
  s_waitcnt vmcnt(0) lgkmcnt(0)
  s_mov_b32 s60, 1
  s_sub_u32 s54, s54, 131072
  s_sub_u32 s53, s53, 425984
  v_add_u32 v6, 49152, v6
  v_mov_b32 v16, v15
  v_xor_b32 v17, 32, v16
  v_mov_b32 v23, 0xff800000
  v_mov_b32 v24, 0xff800000
  s_mov_b32 s48, 0
  s_mov_b32 s55, 0
k2_fbl:
  s_barrier
  s_add_u32 m0, s48, s51
  s_nop 0
  buffer_load_dwordx4 v12, s[24:27], s54 offen lds
  s_add_u32 m0, m0, 1024
  s_add_u32 s61, s54, 4096
  buffer_load_dwordx4 v12, s[24:27], s61 offen lds
  s_add_u32 m0, m0, 1024
  s_nop 0
  buffer_load_dwordx4 v13, s[28:31], s54 offen lds
  s_add_u32 m0, m0, 1024
  s_nop 0
  buffer_load_dwordx4 v14, s[28:31], s54 offen lds
  s_add_u32 s54, s54, 8192
  s_waitcnt vmcnt(0)
  s_barrier
  ds_read_b128 a[64:67], v16 offset:0
  ds_read_b128 a[68:71], v17 offset:0
  ds_read_b128 a[72:75], v16 offset:4096
  ds_read_b128 a[76:79], v17 offset:4096
  ds_read_b128 a[80:83], v16 offset:8192
  ds_read_b128 a[84:87], v17 offset:8192
  ds_read_b128 a[88:91], v16 offset:12288
  ds_read_b128 a[92:95], v17 offset:12288
  s_waitcnt lgkmcnt(0)
  v_mfma_f32_32x32x16_bf16 v[32:47], a[64:67], a[0:3], 0
  v_mfma_f32_32x32x16_bf16 v[32:47], a[68:71], a[4:7], v[32:47]
  v_mfma_f32_32x32x16_bf16 v[32:47], a[72:75], a[8:11], v[32:47]
  v_mfma_f32_32x32x16_bf16 v[32:47], a[76:79], a[12:15], v[32:47]
  v_mfma_f32_32x32x16_bf16 v[32:47], a[80:83], a[16:19], v[32:47]
  v_mfma_f32_32x32x16_bf16 v[32:47], a[84:87], a[20:23], v[32:47]
  v_mfma_f32_32x32x16_bf16 v[32:47], a[88:91], a[24:27], v[32:47]
  v_mfma_f32_32x32x16_bf16 v[32:47], a[92:95], a[28:31], v[32:47]
  v_mfma_f32_32x32x16_bf16 v[48:63], a[64:67], a[32:35], 0
  v_mfma_f32_32x32x16_bf16 v[48:63], a[68:71], a[36:39], v[48:63]
  v_mfma_f32_32x32x16_bf16 v[48:63], a[72:75], a[40:43], v[48:63]
  v_mfma_f32_32x32x16_bf16 v[48:63], a[76:79], a[44:47], v[48:63]
  v_mfma_f32_32x32x16_bf16 v[48:63], a[80:83], a[48:51], v[48:63]
  v_mfma_f32_32x32x16_bf16 v[48:63], a[84:87], a[52:55], v[48:63]
  v_mfma_f32_32x32x16_bf16 v[48:63], a[88:91], a[56:59], v[48:63]
  v_mfma_f32_32x32x16_bf16 v[48:63], a[92:95], a[60:63], v[48:63]
  s_nop 15
  v_max3_f32 v23, v23, v32, v33
  v_max3_f32 v23, v23, v34, v35
  v_max3_f32 v23, v23, v36, v37
  v_max3_f32 v23, v23, v38, v39
  v_max3_f32 v23, v23, v40, v41
  v_max3_f32 v23, v23, v42, v43
  v_max3_f32 v23, v23, v44, v45
  v_max3_f32 v23, v23, v46, v47
  v_max3_f32 v24, v24, v48, v49
  v_max3_f32 v24, v24, v50, v51
  v_max3_f32 v24, v24, v52, v53
  v_max3_f32 v24, v24, v54, v55
  v_max3_f32 v24, v24, v56, v57
  v_max3_f32 v24, v24, v58, v59
  v_max3_f32 v24, v24, v60, v61
  v_max3_f32 v24, v24, v62, v63
  s_add_u32 s55, s55, 1
  s_cmp_lt_u32 s55, 16
  s_cbranch_scc1 k2_fbl
  v_mov_b32 v2, v23
  s_nop 1
  v_permlane32_swap_b32 v2, v23
  v_max_f32 v23, v23, v2
  v_mov_b32 v2, v24
  s_nop 1
  v_permlane32_swap_b32 v2, v24
  v_max_f32 v24, v24, v2
  s_sub_u32 s54, s54, 131072
  s_barrier
  s_mov_b32 s48, 32768
  s_add_u32 m0, s48, s51
  s_nop 0
  buffer_load_dwordx4 v12, s[24:27], s54 offen lds
  s_add_u32 m0, m0, 1024
  s_add_u32 s61, s54, 4096
  buffer_load_dwordx4 v12, s[24:27], s61 offen lds
  s_add_u32 m0, m0, 1024
  s_nop 0
  buffer_load_dwordx4 v13, s[28:31], s54 offen lds
  s_add_u32 m0, m0, 1024
  s_nop 0
  buffer_load_dwordx4 v14, s[28:31], s54 offen lds
  s_add_u32 s54, s54, 8192
  s_mov_b32 s48, 49152
  s_add_u32 m0, s48, s51
  s_nop 0
  buffer_load_dwordx4 v12, s[24:27], s54 offen lds
  s_add_u32 m0, m0, 1024
  s_add_u32 s61, s54, 4096
  buffer_load_dwordx4 v12, s[24:27], s61 offen lds
  s_add_u32 m0, m0, 1024
  s_nop 0
  buffer_load_dwordx4 v13, s[28:31], s54 offen lds
  s_add_u32 m0, m0, 1024
  s_nop 0
  buffer_load_dwordx4 v14, s[28:31], s54 offen lds
  s_add_u32 s54, s54, 8192
  s_mov_b32 s48, 65536
  s_add_u32 m0, s48, s51
  s_nop 0
  buffer_load_dwordx4 v12, s[24:27], s54 offen lds
  s_add_u32 m0, m0, 1024
  s_add_u32 s61, s54, 4096
  buffer_load_dwordx4 v12, s[24:27], s61 offen lds
  s_add_u32 m0, m0, 1024
  s_nop 0
  buffer_load_dwordx4 v13, s[28:31], s54 offen lds
  s_add_u32 m0, m0, 1024
  s_nop 0
  buffer_load_dwordx4 v14, s[28:31], s54 offen lds
  s_add_u32 s54, s54, 8192
  s_mov_b32 s48, 81920
  s_add_u32 m0, s48, s51
  s_nop 0
  buffer_load_dwordx4 v12, s[24:27], s54 offen lds
  s_add_u32 m0, m0, 1024
  s_add_u32 s61, s54, 4096
  buffer_load_dwordx4 v12, s[24:27], s61 offen lds
  s_add_u32 m0, m0, 1024
  s_nop 0
  buffer_load_dwordx4 v13, s[28:31], s54 offen lds
  s_add_u32 m0, m0, 1024
  s_nop 0
  buffer_load_dwordx4 v14, s[28:31], s54 offen lds
  s_add_u32 s54, s54, 8192
  s_mov_b32 s48, 0
  s_add_u32 m0, s48, s51
  s_nop 0
  buffer_load_dwordx4 v12, s[24:27], s54 offen lds
  s_add_u32 m0, m0, 1024
  s_add_u32 s61, s54, 4096
  buffer_load_dwordx4 v12, s[24:27], s61 offen lds
  s_add_u32 m0, m0, 1024
  s_nop 0
  buffer_load_dwordx4 v13, s[28:31], s54 offen lds
  s_add_u32 m0, m0, 1024
  s_nop 0
  buffer_load_dwordx4 v14, s[28:31], s54 offen lds
  s_add_u32 s54, s54, 8192
  s_mov_b32 s48, 16384
  s_add_u32 m0, s48, s51
  s_nop 0
  buffer_load_dwordx4 v12, s[24:27], s54 offen lds
  s_add_u32 m0, m0, 1024
  s_add_u32 s61, s54, 4096
  buffer_load_dwordx4 v12, s[24:27], s61 offen lds
  s_add_u32 m0, m0, 1024
  s_nop 0
  buffer_load_dwordx4 v13, s[28:31], s54 offen lds
  s_add_u32 m0, m0, 1024
  s_nop 0
  buffer_load_dwordx4 v14, s[28:31], s54 offen lds
  s_add_u32 s54, s54, 8192
  v_add_u32 v16, 32768, v15
  v_xor_b32 v17, 32, v16
  s_waitcnt vmcnt(0)
  s_barrier
  ds_read_b128 a[64:67], v16 offset:0
  ds_read_b128 a[68:71], v17 offset:0
  ds_read_b128 a[72:75], v16 offset:4096
  ds_read_b128 a[76:79], v17 offset:4096
  ds_read_b128 a[80:83], v16 offset:8192
  ds_read_b128 a[84:87], v17 offset:8192
  ds_read_b128 a[88:91], v16 offset:12288
  ds_read_b128 a[92:95], v17 offset:12288
  s_waitcnt lgkmcnt(0)
  v_mfma_f32_32x32x16_bf16 v[32:47], a[64:67], a[0:3], 0
  v_mfma_f32_32x32x16_bf16 v[32:47], a[68:71], a[4:7], v[32:47]
  v_mfma_f32_32x32x16_bf16 v[32:47], a[72:75], a[8:11], v[32:47]
  v_mfma_f32_32x32x16_bf16 v[32:47], a[76:79], a[12:15], v[32:47]
  v_mfma_f32_32x32x16_bf16 v[32:47], a[80:83], a[16:19], v[32:47]
  v_mfma_f32_32x32x16_bf16 v[32:47], a[84:87], a[20:23], v[32:47]
  v_mfma_f32_32x32x16_bf16 v[32:47], a[88:91], a[24:27], v[32:47]
  v_mfma_f32_32x32x16_bf16 v[32:47], a[92:95], a[28:31], v[32:47]
  v_mfma_f32_32x32x16_bf16 v[48:63], a[64:67], a[32:35], 0
  v_mfma_f32_32x32x16_bf16 v[48:63], a[68:71], a[36:39], v[48:63]
  v_mfma_f32_32x32x16_bf16 v[48:63], a[72:75], a[40:43], v[48:63]
  v_mfma_f32_32x32x16_bf16 v[48:63], a[76:79], a[44:47], v[48:63]
  v_mfma_f32_32x32x16_bf16 v[48:63], a[80:83], a[48:51], v[48:63]
  v_mfma_f32_32x32x16_bf16 v[48:63], a[84:87], a[52:55], v[48:63]
  v_mfma_f32_32x32x16_bf16 v[48:63], a[88:91], a[56:59], v[48:63]
  v_mfma_f32_32x32x16_bf16 v[48:63], a[92:95], a[60:63], v[48:63]
  s_nop 15
  s_branch k2_p2
code_end:
  s_endpgm
.section .rodata,"a"
.p2align 6
.amdhsa_kernel adaLN_cond__sliding_block_cached__dense_activation_squared_relu__prompt_kernel
  .amdhsa_next_free_vgpr 512
  .amdhsa_next_free_sgpr 102
  .amdhsa_accum_offset 256
  .amdhsa_group_segment_fixed_size 0
  .amdhsa_kernarg_size 120
  .amdhsa_user_sgpr_count 2
  .amdhsa_user_sgpr_kernarg_segment_ptr 1
  .amdhsa_system_sgpr_workgroup_id_x 1
  .amdhsa_float_denorm_mode_32 3
  .amdhsa_float_denorm_mode_16_64 3
.end_amdhsa_kernel
```
